```python
import torch

def _softmax(x, axis=-1):
    return torch.softmax(x, dim=axis)

def _gelu(x):
    return torch.nn.functional.gelu(x, approximate='tanh')

def _silu(x):
    return torch.nn.functional.silu(x)

def _sigmoid(x):
    return torch.sigmoid(x)

def _layernorm(x, axis=-1, eps=1e-05):
    m = x.mean(dim=axis, keepdim=True)
    v = x.var(dim=axis, keepdim=True, unbiased=False)
    return (x - m) / torch.sqrt(v + eps)

def _scatter_add(tgt, idx, src, axis=0):
    return tgt.clone().index_add_(axis, idx, src)

def _segment_sum(src, seg, n):
    out = torch.zeros((n,) + src.shape[1:], dtype=src.dtype)
    return out.index_add_(0, seg, src)

def _pad(x, pw):
    flat = tuple((v for pair in reversed(pw) for v in pair))
    return torch.nn.functional.pad(x, flat)
kernel_name = 'interleave_layers__memory_aug_recurrent_mem_tr__linear_attn_block__prompt'

def setup_inputs():

    _w = lambda a: (lambda t: t.to(torch.bfloat16) if t.is_floating_point() else t)(torch.as_tensor(a))

    def _A_setup():
        B, S, Dm = (1, 2048, 512)
        H, Dh = (32, 128)
        M, seg = (8, 32)
        seg = min(seg, S)
        S = S // seg * seg
        return {'x': _w((lambda *s: torch.randn(*s, dtype=torch.bfloat16) * 0.05)(B, S, Dm)), 'mem0': _w((lambda *s: torch.randn(*s, dtype=torch.bfloat16) * 0.2)(B, M, Dm)), 'Wq': _w((lambda *s: torch.randn(*s, dtype=torch.bfloat16) * 1.6)(Dm, H, Dh) * Dm ** (-0.5)), 'Wk': _w((lambda *s: torch.randn(*s, dtype=torch.bfloat16) * 1.6)(Dm, H, Dh) * Dm ** (-0.5)), 'Wv': _w((lambda *s: torch.randn(*s, dtype=torch.bfloat16) * 0.2)(Dm, H, Dh) * Dm ** (-0.5)), 'Wo': _w((lambda *s: torch.randn(*s, dtype=torch.bfloat16) * 0.2)(H, Dh, Dm) * (H * Dh) ** (-0.5)), 'seg_len': seg}
    _A_in = _A_setup()

    def _B_setup():
        B, S, D = (1, 2048, 512)
        return {'x': _w((lambda *s: torch.randn(*s, dtype=torch.bfloat16) * 0.05)(B, S, D)), 'wqkv': _w((lambda *s: torch.randn(*s, dtype=torch.bfloat16) * 0.1)(D, 3 * D)), 'wo': _w((lambda *s: torch.randn(*s, dtype=torch.bfloat16) * 0.05)(D, D))}
    _B_in = _B_setup()
    return {'A_x': _A_in['x'], 'A_mem0': _A_in['mem0'], 'A_Wq': _A_in['Wq'], 'A_Wk': _A_in['Wk'], 'A_Wv': _A_in['Wv'], 'A_Wo': _A_in['Wo'], 'A_seg_len': _A_in['seg_len'], 'B_x': _B_in['x'], 'B_wqkv': _B_in['wqkv'], 'B_wo': _B_in['wo']}

def reference(A_x, A_mem0, A_Wq, A_Wk, A_Wv, A_Wo, A_seg_len, B_x, B_wqkv, B_wo):

    def _A_ref(x, mem0, Wq, Wk, Wv, Wo, seg_len):
        B, S, Dm = x.shape
        H, Dh = (Wq.shape[1], Wq.shape[2])
        M = mem0.shape[1]
        scale = Dh ** (-0.5)
        n_seg = S // seg_len
        L = M + seg_len
        idx = torch.arange(L)
        mask = (idx[:, None] < M) | (idx[:, None] >= idx[None, :])
        mem = mem0
        outs = []
        for s in range(n_seg):
            xs = x[:, s * seg_len:(s + 1) * seg_len, :].clone()
            h = torch.concatenate([mem, xs], axis=1)
            q = torch.einsum('btd,dhe->bhte', h, Wq)
            k = torch.einsum('btd,dhe->bhte', h, Wk)
            v = torch.einsum('btd,dhe->bhte', h, Wv)
            scores = torch.einsum('bhqe,bhke->bhqk', q, k) * scale
            scores = torch.where(mask[None, None], scores, -1000000000.0)
            p = _softmax(scores, axis=-1)
            o = torch.einsum('bhqk,bhke->bhqe', p, v)
            o = torch.einsum('bhte,hed->btd', o, Wo)
            mem = o[:, :M, :].clone()
            outs.append(o[:, M:, :])
        return torch.concatenate(outs, axis=1)

    def _B_ref(x, wqkv, wo):
        B, S, D = x.shape
        H = 32
        Dh = D // H
        qkv = (lambda x, *d: x.permute(*d))((x @ wqkv).reshape(B, S, 3, H, Dh), 2, 0, 3, 1, 4)
        q, k, v = (qkv[0], qkv[1], qkv[2])
        phi = lambda t: torch.where(t > 0, t + 1, torch.exp(t)) + 1e-06
        pq, pk = (phi(q), phi(k))
        kv = torch.einsum('bhsd,bhse->bhde', pk, v)
        z = torch.einsum('bhsd->bhd', pk)
        num = torch.einsum('bhqd,bhde->bhqe', pq, kv)
        den = torch.einsum('bhqd,bhd->bhq', pq, z)[..., None] + 1e-06
        o = num / den
        return (lambda x, *d: x.permute(*d))(o, 0, 2, 1, 3).reshape(B, S, D) @ wo
    x = A_x
    x = x + _A_ref(_layernorm(x, axis=-1), A_mem0, A_Wq, A_Wk, A_Wv, A_Wo, A_seg_len)
    x = x + _B_ref(_layernorm(x, axis=-1), B_wqkv, B_wo)
    x = x + _A_ref(_layernorm(x, axis=-1), A_mem0, A_Wq, A_Wk, A_Wv, A_Wo, A_seg_len)
    x = x + _B_ref(_layernorm(x, axis=-1), B_wqkv, B_wo)
    return x
```

```asm
; @launch kernel=prep_kernel grid=(2958,1,1) block=(256,1,1) lds=9216
; @launch kernel=mega_kernel grid=(256,1,1) block=(256,1,1) lds=163840
.amdgcn_target "amdgcn-amd-amdhsa--gfx950"
.text
.globl prep_kernel
.p2align 8
.type prep_kernel,@function
prep_kernel:
    s_cmp_ge_u32 s2, 2958
    s_cbranch_scc1 prep_end
    s_load_dwordx2 s[4:5], s[0:1], 96
    s_load_dwordx4 s[20:23], s[0:1], 0
    s_load_dwordx4 s[24:27], s[0:1], 16
    s_load_dwordx4 s[28:31], s[0:1], 32
    s_load_dwordx4 s[32:35], s[0:1], 64
    s_waitcnt lgkmcnt(0)
    s_and_b32 s5, s5, 0xffff
    s_mov_b32 s6, 268435456
    s_mov_b32 s7, 0x20000
    v_and_b32 v1, 63, v0
    v_lshrrev_b32 v2, 6, v0
    s_cmp_ge_u32 s2, 2446
    s_cbranch_scc1 prep_ln
    s_cmp_ge_u32 s2, 2304
    s_cbranch_scc1 prep_init
    s_mov_b32 s11, 0x20000
    s_cmp_ge_u32 s2, 1536
    s_cbranch_scc1 prep_t_wo
    s_lshr_b32 s16, s2, 9
    s_and_b32 s17, s2, 511
    s_and_b32 s18, s17, 7
    s_lshr_b32 s19, s17, 3
    s_mov_b32 s8, s24
    s_mov_b32 s9, s25
    s_cmp_eq_u32 s16, 1
    s_cselect_b32 s8, s26, s8
    s_cselect_b32 s9, s27, s9
    s_cmp_eq_u32 s16, 2
    s_cselect_b32 s8, s28, s8
    s_cselect_b32 s9, s29, s9
    s_and_b32 s9, s9, 0xffff
    s_mov_b32 s10, 0x400000
    s_mov_b32 s12, 8192
    s_lshl_b32 s13, s18, 19
    s_lshl_b32 s36, s19, 7
    s_add_u32 s13, s13, s36
    s_lshl_b32 s14, s16, 22
    s_lshl_b32 s36, s19, 16
    s_add_u32 s14, s14, s36
    s_lshl_b32 s36, s18, 11
    s_add_u32 s14, s14, s36
    s_add_u32 s14, s14, 0
    s_mov_b32 s15, 16384
    s_branch prep_tr_plain
prep_t_wo:
    s_cmp_ge_u32 s2, 2048
    s_cbranch_scc1 prep_t_bqkv
    s_sub_u32 s17, s2, 1536
    s_and_b32 s18, s17, 63
    s_lshr_b32 s19, s17, 6
    s_mov_b32 s8, s30
    s_and_b32 s9, s31, 0xffff
    s_mov_b32 s10, 0x400000
    s_mov_b32 s12, 1024
    s_lshl_b32 s13, s18, 16
    s_lshl_b32 s36, s19, 7
    s_add_u32 s13, s13, s36
    s_lshl_b32 s14, s19, 19
    s_lshl_b32 s36, s18, 11
    s_add_u32 s14, s14, s36
    s_add_u32 s14, s14, 12582912
    s_mov_b32 s15, 131072
    s_branch prep_tr_perm
prep_t_bqkv:
    s_cmp_ge_u32 s2, 2240
    s_cbranch_scc1 prep_t_bwo
    s_sub_u32 s17, s2, 2048
    s_and_b32 s18, s17, 7
    s_lshr_b32 s19, s17, 3
    s_mov_b32 s8, s32
    s_and_b32 s9, s33, 0xffff
    s_mov_b32 s10, 0x180000
    s_mov_b32 s12, 3072
    s_mul_i32 s13, s18, 196608
    s_lshl_b32 s36, s19, 7
    s_add_u32 s13, s13, s36
    s_lshl_b32 s14, s19, 16
    s_lshl_b32 s36, s18, 11
    s_add_u32 s14, s14, s36
    s_add_u32 s14, s14, 16777216
    s_mov_b32 s15, 16384
    s_branch prep_tr_plain
prep_t_bwo:
    s_sub_u32 s17, s2, 2240
    s_and_b32 s18, s17, 7
    s_lshr_b32 s19, s17, 3
    s_mov_b32 s8, s34
    s_and_b32 s9, s35, 0xffff
    s_mov_b32 s10, 0x80000
    s_mov_b32 s12, 1024
    s_lshl_b32 s13, s18, 16
    s_lshl_b32 s36, s19, 7
    s_add_u32 s13, s13, s36
    s_lshl_b32 s14, s19, 16
    s_lshl_b32 s36, s18, 11
    s_add_u32 s14, s14, s36
    s_add_u32 s14, s14, 18350080
    s_mov_b32 s15, 16384
    s_branch prep_tr_perm
prep_tr_plain:
    v_lshrrev_b32 v3, 3, v0
    v_and_b32 v4, 7, v0
    v_mul_lo_u32 v5, v3, s12
    v_lshl_add_u32 v5, v4, 4, v5
    s_lshl_b32 s36, s12, 5
    s_add_u32 s36, s36, s13
    buffer_load_dwordx4 v[8:11], v5, s[8:11], s13 offen
    buffer_load_dwordx4 v[12:15], v5, s[8:11], s36 offen
    v_mul_u32_u24 v6, 144, v3
    v_lshl_add_u32 v6, v4, 4, v6
    s_waitcnt vmcnt(1)
    ds_write_b128 v6, v[8:11]
    s_waitcnt vmcnt(0)
    ds_write_b128 v6, v[12:15] offset:4608
    s_waitcnt lgkmcnt(0)
    s_barrier
    v_add_u32 v16, 0, v2
    v_lshlrev_b32 v17, 3, v16
    v_mul_u32_u24 v17, 144, v17
    v_lshl_add_u32 v17, v1, 1, v17
    ds_read_u16 v24, v17 offset:0
    ds_read_u16 v25, v17 offset:144
    ds_read_u16 v26, v17 offset:288
    ds_read_u16 v27, v17 offset:432
    ds_read_u16 v28, v17 offset:576
    ds_read_u16 v29, v17 offset:720
    ds_read_u16 v30, v17 offset:864
    ds_read_u16 v31, v17 offset:1008
    v_lshrrev_b32 v19, 4, v1
    v_mul_lo_u32 v19, v19, s15
    v_lshrrev_b32 v18, 2, v16
    v_lshl_add_u32 v19, v18, 10, v19
    v_and_b32 v18, 3, v16
    v_lshl_add_u32 v19, v18, 8, v19
    v_and_b32 v18, 15, v1
    v_lshl_add_u32 v19, v18, 4, v19
    s_waitcnt lgkmcnt(0)
    v_lshl_or_b32 v20, v25, 16, v24
    v_lshl_or_b32 v21, v27, 16, v26
    v_lshl_or_b32 v22, v29, 16, v28
    v_lshl_or_b32 v23, v31, 16, v30
    buffer_store_dwordx4 v[20:23], v19, s[4:7], s14 offen
    s_nop 1
    v_add_u32 v16, 4, v2
    v_lshlrev_b32 v17, 3, v16
    v_mul_u32_u24 v17, 144, v17
    v_lshl_add_u32 v17, v1, 1, v17
    ds_read_u16 v24, v17 offset:0
    ds_read_u16 v25, v17 offset:144
    ds_read_u16 v26, v17 offset:288
    ds_read_u16 v27, v17 offset:432
    ds_read_u16 v28, v17 offset:576
    ds_read_u16 v29, v17 offset:720
    ds_read_u16 v30, v17 offset:864
    ds_read_u16 v31, v17 offset:1008
    v_lshrrev_b32 v19, 4, v1
    v_mul_lo_u32 v19, v19, s15
    v_lshrrev_b32 v18, 2, v16
    v_lshl_add_u32 v19, v18, 10, v19
    v_and_b32 v18, 3, v16
    v_lshl_add_u32 v19, v18, 8, v19
    v_and_b32 v18, 15, v1
    v_lshl_add_u32 v19, v18, 4, v19
    s_waitcnt lgkmcnt(0)
    v_lshl_or_b32 v20, v25, 16, v24
    v_lshl_or_b32 v21, v27, 16, v26
    v_lshl_or_b32 v22, v29, 16, v28
    v_lshl_or_b32 v23, v31, 16, v30
    buffer_store_dwordx4 v[20:23], v19, s[4:7], s14 offen
    s_nop 1
    s_branch prep_end
prep_tr_perm:
    v_lshrrev_b32 v3, 3, v0
    v_and_b32 v4, 7, v0
    v_mul_lo_u32 v5, v3, s12
    v_lshl_add_u32 v5, v4, 4, v5
    s_lshl_b32 s36, s12, 5
    s_add_u32 s36, s36, s13
    buffer_load_dwordx4 v[8:11], v5, s[8:11], s13 offen
    buffer_load_dwordx4 v[12:15], v5, s[8:11], s36 offen
    v_mul_u32_u24 v6, 144, v3
    v_lshl_add_u32 v6, v4, 4, v6
    s_waitcnt vmcnt(1)
    ds_write_b128 v6, v[8:11]
    s_waitcnt vmcnt(0)
    ds_write_b128 v6, v[12:15] offset:4608
    s_waitcnt lgkmcnt(0)
    s_barrier
    v_add_u32 v16, 0, v2
    v_lshrrev_b32 v17, 2, v16
    v_and_b32 v18, 3, v16
    v_lshlrev_b32 v17, 5, v17
    v_lshl_add_u32 v17, v18, 2, v17
    v_mul_u32_u24 v17, 144, v17
    v_lshl_add_u32 v17, v1, 1, v17
    ds_read_u16 v24, v17 offset:0
    ds_read_u16 v25, v17 offset:144
    ds_read_u16 v26, v17 offset:288
    ds_read_u16 v27, v17 offset:432
    ds_read_u16 v28, v17 offset:2304
    ds_read_u16 v29, v17 offset:2448
    ds_read_u16 v30, v17 offset:2592
    ds_read_u16 v31, v17 offset:2736
    v_lshrrev_b32 v19, 4, v1
    v_mul_lo_u32 v19, v19, s15
    v_lshrrev_b32 v18, 2, v16
    v_lshl_add_u32 v19, v18, 10, v19
    v_and_b32 v18, 3, v16
    v_lshl_add_u32 v19, v18, 8, v19
    v_and_b32 v18, 15, v1
    v_lshl_add_u32 v19, v18, 4, v19
    s_waitcnt lgkmcnt(0)
    v_lshl_or_b32 v20, v25, 16, v24
    v_lshl_or_b32 v21, v27, 16, v26
    v_lshl_or_b32 v22, v29, 16, v28
    v_lshl_or_b32 v23, v31, 16, v30
    buffer_store_dwordx4 v[20:23], v19, s[4:7], s14 offen
    s_nop 1
    v_add_u32 v16, 4, v2
    v_lshrrev_b32 v17, 2, v16
    v_and_b32 v18, 3, v16
    v_lshlrev_b32 v17, 5, v17
    v_lshl_add_u32 v17, v18, 2, v17
    v_mul_u32_u24 v17, 144, v17
    v_lshl_add_u32 v17, v1, 1, v17
    ds_read_u16 v24, v17 offset:0
    ds_read_u16 v25, v17 offset:144
    ds_read_u16 v26, v17 offset:288
    ds_read_u16 v27, v17 offset:432
    ds_read_u16 v28, v17 offset:2304
    ds_read_u16 v29, v17 offset:2448
    ds_read_u16 v30, v17 offset:2592
    ds_read_u16 v31, v17 offset:2736
    v_lshrrev_b32 v19, 4, v1
    v_mul_lo_u32 v19, v19, s15
    v_lshrrev_b32 v18, 2, v16
    v_lshl_add_u32 v19, v18, 10, v19
    v_and_b32 v18, 3, v16
    v_lshl_add_u32 v19, v18, 8, v19
    v_and_b32 v18, 15, v1
    v_lshl_add_u32 v19, v18, 4, v19
    s_waitcnt lgkmcnt(0)
    v_lshl_or_b32 v20, v25, 16, v24
    v_lshl_or_b32 v21, v27, 16, v26
    v_lshl_or_b32 v22, v29, 16, v28
    v_lshl_or_b32 v23, v31, 16, v30
    buffer_store_dwordx4 v[20:23], v19, s[4:7], s14 offen
    s_nop 1
    s_branch prep_end
prep_init:
    s_sub_u32 s17, s2, 2304
    s_cmp_ge_u32 s17, 2
    s_cbranch_scc1 prep_fill
    s_mov_b32 s8, s22
    s_and_b32 s9, s23, 0xffff
    s_mov_b32 s10, 8192
    s_mov_b32 s11, 0x20000
    s_lshl_b32 s14, s17, 20
    s_add_u32 s14, s14, 100663296
    v_add_u32 v3, 0, v0
    v_lshrrev_b32 v4, 5, v3
    v_bfe_u32 v5, v3, 3, 2
    v_and_b32 v6, 7, v3
    v_lshlrev_b32 v7, 10, v6
    v_lshl_add_u32 v7, v4, 6, v7
    v_lshl_add_u32 v7, v5, 4, v7
    buffer_load_dwordx4 v[8:11], v7, s[8:11], 0 offen
    v_lshlrev_b32 v12, 4, v3
    s_waitcnt vmcnt(0)
    buffer_store_dwordx4 v[8:11], v12, s[4:7], s14 offen
    s_nop 1
    v_add_u32 v3, 256, v0
    v_lshrrev_b32 v4, 5, v3
    v_bfe_u32 v5, v3, 3, 2
    v_and_b32 v6, 7, v3
    v_lshlrev_b32 v7, 10, v6
    v_lshl_add_u32 v7, v4, 6, v7
    v_lshl_add_u32 v7, v5, 4, v7
    buffer_load_dwordx4 v[8:11], v7, s[8:11], 0 offen
    v_lshlrev_b32 v12, 4, v3
    s_waitcnt vmcnt(0)
    buffer_store_dwordx4 v[8:11], v12, s[4:7], s14 offen
    s_nop 1
    s_branch prep_end
prep_fill:
    s_sub_u32 s17, s17, 2
    s_mov_b32 s18, -1
    s_mov_b32 s14, 100671488
    s_cmp_ge_u32 s17, 32
    s_cselect_b32 s14, 101195776, s14
    s_cmp_ge_u32 s17, 64
    s_cselect_b32 s14, 101711872, s14
    s_cmp_ge_u32 s17, 128
    s_cselect_b32 s14, 102760448, s14
    s_cselect_b32 s18, 0, s18
    s_lshl_b32 s19, s17, 14
    s_add_u32 s14, s14, s19
    v_mov_b32 v8, s18
    v_mov_b32 v9, s18
    v_mov_b32 v10, s18
    v_mov_b32 v11, s18
    v_lshlrev_b32 v3, 4, v0
    buffer_store_dwordx4 v[8:11], v3, s[4:7], s14 offen offset:0
    s_add_u32 s14, s14, 4096
    buffer_store_dwordx4 v[8:11], v3, s[4:7], s14 offen
    s_add_u32 s14, s14, 4096
    buffer_store_dwordx4 v[8:11], v3, s[4:7], s14 offen
    s_add_u32 s14, s14, 4096
    buffer_store_dwordx4 v[8:11], v3, s[4:7], s14 offen
    s_branch prep_end
prep_ln:
    s_sub_u32 s17, s2, 2446
    s_mov_b32 s8, s20
    s_and_b32 s9, s21, 0xffff
    s_mov_b32 s10, 0x200000
    s_mov_b32 s11, 0x20000
    s_lshl_b32 s12, s17, 12
    v_lshlrev_b32 v1, 4, v0
    buffer_load_dwordx4 v[4:7], v1, s[8:11], s12 offen
    s_add_u32 s13, s12, 20971520
    s_waitcnt vmcnt(0)
    buffer_store_dwordx4 v[4:7], v1, s[4:7], s13 offen
    v_lshlrev_b32 v8, 16, v4
    v_and_b32 v9, 0xffff0000, v4
    v_lshlrev_b32 v10, 16, v5
    v_and_b32 v11, 0xffff0000, v5
    v_lshlrev_b32 v12, 16, v6
    v_and_b32 v13, 0xffff0000, v6
    v_lshlrev_b32 v14, 16, v7
    v_and_b32 v15, 0xffff0000, v7
    v_add_f32 v16, v8, v9
    v_add_f32 v16, v16, v10
    v_add_f32 v16, v16, v11
    v_add_f32 v16, v16, v12
    v_add_f32 v16, v16, v13
    v_add_f32 v16, v16, v14
    v_add_f32 v16, v16, v15
    s_nop 1
    v_add_f32_dpp v16, v16, v16 quad_perm:[1,0,3,2] row_mask:0xf bank_mask:0xf
    s_nop 1
    v_add_f32_dpp v16, v16, v16 quad_perm:[2,3,0,1] row_mask:0xf bank_mask:0xf
    s_nop 1
    v_add_f32_dpp v16, v16, v16 row_half_mirror row_mask:0xf bank_mask:0xf
    s_nop 1
    v_add_f32_dpp v16, v16, v16 row_mirror row_mask:0xf bank_mask:0xf
    v_mov_b32 v17, v16
    s_nop 1
    v_permlane16_swap_b32 v16, v17
    v_add_f32 v16, v16, v17
    v_mov_b32 v17, v16
    s_nop 1
    v_permlane32_swap_b32 v16, v17
    v_add_f32 v16, v16, v17
    v_mul_f32 v16, 0x3b000000, v16
    v_mov_b32 v18, 0
    v_sub_f32 v17, v8, v16
    v_fmac_f32 v18, v17, v17
    v_sub_f32 v17, v9, v16
    v_fmac_f32 v18, v17, v17
    v_sub_f32 v17, v10, v16
    v_fmac_f32 v18, v17, v17
    v_sub_f32 v17, v11, v16
    v_fmac_f32 v18, v17, v17
    v_sub_f32 v17, v12, v16
    v_fmac_f32 v18, v17, v17
    v_sub_f32 v17, v13, v16
    v_fmac_f32 v18, v17, v17
    v_sub_f32 v17, v14, v16
    v_fmac_f32 v18, v17, v17
    v_sub_f32 v17, v15, v16
    v_fmac_f32 v18, v17, v17
    s_nop 1
    v_add_f32_dpp v18, v18, v18 quad_perm:[1,0,3,2] row_mask:0xf bank_mask:0xf
    s_nop 1
    v_add_f32_dpp v18, v18, v18 quad_perm:[2,3,0,1] row_mask:0xf bank_mask:0xf
    s_nop 1
    v_add_f32_dpp v18, v18, v18 row_half_mirror row_mask:0xf bank_mask:0xf
    s_nop 1
    v_add_f32_dpp v18, v18, v18 row_mirror row_mask:0xf bank_mask:0xf
    v_mov_b32 v17, v18
    s_nop 1
    v_permlane16_swap_b32 v18, v17
    v_add_f32 v18, v18, v17
    v_mov_b32 v17, v18
    s_nop 1
    v_permlane32_swap_b32 v18, v17
    v_add_f32 v18, v18, v17
    v_mul_f32 v18, 0x3b000000, v18
    v_cvt_pk_bf16_f32 v17, v18, v18
    v_lshlrev_b32 v18, 16, v17
    v_add_f32 v18, 0x3727c5ac, v18
    v_cvt_pk_bf16_f32 v17, v18, v18
    v_lshlrev_b32 v18, 16, v17
    v_sqrt_f32 v18, v18
    s_nop 0
    v_cvt_pk_bf16_f32 v17, v18, v18
    v_lshlrev_b32 v18, 16, v17
    v_cvt_pk_bf16_f32 v17, v16, v16
    v_lshlrev_b32 v16, 16, v17
    v_rcp_f32 v19, v18
    v_sub_f32 v8, v8, v16
    v_sub_f32 v9, v9, v16
    v_cvt_pk_bf16_f32 v17, v8, v9
    v_lshlrev_b32 v8, 16, v17
    v_and_b32 v9, 0xffff0000, v17
    v_mul_f32 v20, v8, v19
    v_fma_f32 v21, -v20, v18, v8
    v_fma_f32 v8, v21, v19, v20
    v_mul_f32 v20, v9, v19
    v_fma_f32 v21, -v20, v18, v9
    v_fma_f32 v9, v21, v19, v20
    v_cvt_pk_bf16_f32 v24, v8, v9
    v_sub_f32 v10, v10, v16
    v_sub_f32 v11, v11, v16
    v_cvt_pk_bf16_f32 v17, v10, v11
    v_lshlrev_b32 v10, 16, v17
    v_and_b32 v11, 0xffff0000, v17
    v_mul_f32 v20, v10, v19
    v_fma_f32 v21, -v20, v18, v10
    v_fma_f32 v10, v21, v19, v20
    v_mul_f32 v20, v11, v19
    v_fma_f32 v21, -v20, v18, v11
    v_fma_f32 v11, v21, v19, v20
    v_cvt_pk_bf16_f32 v25, v10, v11
    v_sub_f32 v12, v12, v16
    v_sub_f32 v13, v13, v16
    v_cvt_pk_bf16_f32 v17, v12, v13
    v_lshlrev_b32 v12, 16, v17
    v_and_b32 v13, 0xffff0000, v17
    v_mul_f32 v20, v12, v19
    v_fma_f32 v21, -v20, v18, v12
    v_fma_f32 v12, v21, v19, v20
    v_mul_f32 v20, v13, v19
    v_fma_f32 v21, -v20, v18, v13
    v_fma_f32 v13, v21, v19, v20
    v_cvt_pk_bf16_f32 v26, v12, v13
    v_sub_f32 v14, v14, v16
    v_sub_f32 v15, v15, v16
    v_cvt_pk_bf16_f32 v17, v14, v15
    v_lshlrev_b32 v14, 16, v17
    v_and_b32 v15, 0xffff0000, v17
    v_mul_f32 v20, v14, v19
    v_fma_f32 v21, -v20, v18, v14
    v_fma_f32 v14, v21, v19, v20
    v_mul_f32 v20, v15, v19
    v_fma_f32 v21, -v20, v18, v15
    v_fma_f32 v15, v21, v19, v20
    v_cvt_pk_bf16_f32 v27, v14, v15
    v_lshrrev_b32 v22, 6, v0
    s_lshl_b32 s13, s17, 2
    v_add_u32 v22, s13, v22
    v_lshrrev_b32 v23, 4, v22
    v_lshlrev_b32 v23, 14, v23
    v_and_b32 v22, 15, v22
    v_lshl_add_u32 v23, v22, 4, v23
    v_bfe_u32 v22, v0, 2, 4
    v_lshl_add_u32 v23, v22, 10, v23
    v_and_b32 v22, 3, v0
    v_lshl_add_u32 v23, v22, 8, v23
    s_mov_b32 s13, 18874368
    buffer_store_dwordx4 v[24:27], v23, s[4:7], s13 offen
prep_end:
    s_endpgm
.globl mega_kernel
.p2align 8
.type mega_kernel,@function
mega_kernel:
    s_cmp_ge_u32 s2, 256
    s_cbranch_scc1 mega_kernel_end
    s_load_dwordx2 s[4:5], s[0:1], 96
    s_load_dwordx2 s[8:9], s[0:1], 88
    s_load_dwordx2 s[76:77], s[0:1], 80
    s_waitcnt lgkmcnt(0)
    s_and_b32 s5, s5, 0xffff
    s_mov_b32 s6, 268435456
    s_mov_b32 s7, 0x20000
    s_and_b32 s9, s9, 0xffff
    s_mov_b32 s10, 256
    s_mov_b32 s11, 0x20000
    s_and_b32 s77, s77, 0xffff
    s_mov_b32 s78, 2097152
    s_mov_b32 s79, 0x20000
    v_lshrrev_b32 v1, 6, v0
    s_nop 0
    v_readfirstlane_b32 s14, v1
    s_cmp_lg_u32 s14, 0
    s_cbranch_scc1 mega_kernel_role_wait
    s_getreg_b32 s26, hwreg(HW_REG_XCC_ID)
    s_and_b32 s26, s26, 7
    s_mov_b64 s[28:29], exec
    s_mov_b64 exec, 1
    s_lshl_b32 s27, s26, 2
    v_mov_b32 v2, s27
    v_mov_b32 v3, 1
    buffer_atomic_add v3, v2, s[8:11], 0 offen sc0
    s_waitcnt vmcnt(0)
    v_readfirstlane_b32 s27, v3
    s_mov_b32 s12, -1
    s_cmp_ge_u32 s27, 32
    s_cbranch_scc1 mega_kernel_role_done
    v_mov_b32 v2, 32
    s_add_u32 s26, s26, 1
    s_cmp_lg_u32 s27, 31
    s_cbranch_scc1 mega_kernel_role_poll0
    v_mov_b32 v4, s26
    v_mov_b32 v5, 0
    buffer_atomic_cmpswap v[4:5], v2, s[8:11], 0 offen sc0
    s_waitcnt vmcnt(0)
mega_kernel_role_poll0:
    s_mov_b32 s36, 0
mega_kernel_role_poll:
    buffer_load_dword v3, v2, s[8:11], 0 offen sc1
    s_waitcnt vmcnt(0)
    v_readfirstlane_b32 s37, v3
    s_cmp_lg_u32 s37, 0
    s_cbranch_scc1 mega_kernel_role_dec
    s_sleep 4
    s_add_u32 s36, s36, 1
    s_cmp_lt_u32 s36, 4000
    s_cbranch_scc1 mega_kernel_role_poll
    v_mov_b32 v4, 100
    v_mov_b32 v5, 0
    buffer_atomic_cmpswap v[4:5], v2, s[8:11], 0 offen sc0
    s_waitcnt vmcnt(0)
    s_branch mega_kernel_role_poll0
mega_kernel_role_dec:
    s_cmp_eq_u32 s37, s26
    s_cselect_b32 s12, s27, s12
    s_cmp_lg_u32 s37, 100
    s_cbranch_scc1 mega_kernel_role_done
    v_mov_b32 v2, 36
    v_mov_b32 v3, 1
    buffer_atomic_add v3, v2, s[8:11], 0 offen sc0
    s_waitcnt vmcnt(0)
    v_readfirstlane_b32 s27, v3
    s_or_b32 s26, s27, 256
    s_cmp_lt_u32 s27, 32
    s_cselect_b32 s12, s26, s12
mega_kernel_role_done:
    v_mov_b32 v2, 131072
    v_mov_b32 v3, s12
    ds_write_b32 v2, v3
    s_waitcnt lgkmcnt(0)
    s_mov_b64 exec, s[28:29]
mega_kernel_role_wait:
    s_barrier
    v_mov_b32 v2, 131072
    ds_read_b32 v3, v2
    s_waitcnt lgkmcnt(0)
    v_readfirstlane_b32 s12, v3
    s_cmp_eq_u32 s12, -1
    s_cbranch_scc1 mega_kernel_worker
    s_lshr_b32 s13, s12, 8
    s_and_b32 s12, s12, 31
    v_and_b32 v0, 63, v0
    v_and_b32 v12, 15, v0
    v_lshrrev_b32 v13, 4, v0
    v_and_b32 v14, 7, v0
    v_cmp_gt_u32 s[30:31], 8, v12
    v_cmp_gt_u32 s[32:33], 8, v0
    v_cmp_gt_u32 s[34:35], 32, v0
    v_mov_b32 v16, 0x7fffff00
    v_lshlrev_b32 v1, 7, v13
    v_lshl_add_u32 v1, v14, 4, v1
    s_lshl_b32 s26, s14, 10
    v_lshlrev_b32 v2, 4, v0
    v_add_u32 v2, s26, v2
    s_lshl_b32 s26, s14, 11
    v_lshlrev_b32 v3, 6, v12
    v_lshl_add_u32 v3, v13, 4, v3
    v_add_u32 v3, s26, v3
    v_lshlrev_b32 v4, 6, v12
    v_lshl_add_u32 v4, v13, 4, v4
    v_cndmask_b32 v4, v16, v4, s[30:31]
    s_lshl_b32 s26, s14, 7
    v_lshrrev_b32 v5, 3, v0
    v_lshlrev_b32 v5, 9, v5
    v_lshl_add_u32 v5, v14, 4, v5
    v_add_u32 v5, s26, v5
    v_bfe_u32 v15, v0, 1, 1
    v_lshlrev_b32 v6, 7, v15
    v_bfe_u32 v15, v0, 2, 1
    v_lshl_add_u32 v6, v15, 4, v6
    v_and_b32 v15, 1, v0
    v_lshl_add_u32 v6, v15, 3, v6
    v_lshl_add_u32 v6, v13, 2, v6
    s_lshl_b32 s26, s14, 5
    v_add_u32 v6, s26, v6
    s_and_b64 s[32:33], s[30:31], s[34:35]
    v_cndmask_b32 v6, v16, v6, s[32:33]
    s_lshl_b32 s26, s14, 9
    v_add_u32 v7, s26, v1
    v_cndmask_b32 v7, v16, v7, s[30:31]
    s_lshl_b32 s26, s14, 9
    v_lshlrev_b32 v8, 4, v12
    v_lshl_add_u32 v8, v13, 3, v8
    v_add_u32 v8, s26, v8
    v_cndmask_b32 v8, v16, v8, s[34:35]
    v_lshlrev_b32 v9, 4, v0
    s_lshl_b32 s26, s14, 15
    v_add_u32 v10, s26, v9
    s_lshl_b32 s26, s12, 17
    s_lshl_b32 s27, s14, 15
    s_add_u32 s26, s26, s27
    s_add_u32 s26, s26, 0
    s_add_u32 s27, s26, 0
    buffer_load_dwordx4 a[0:3], v9, s[4:7], s27 offen offset:0
    buffer_load_dwordx4 a[4:7], v9, s[4:7], s27 offen offset:1024
    buffer_load_dwordx4 a[8:11], v9, s[4:7], s27 offen offset:2048
    buffer_load_dwordx4 a[12:15], v9, s[4:7], s27 offen offset:3072
    s_add_u32 s27, s26, 4096
    buffer_load_dwordx4 a[16:19], v9, s[4:7], s27 offen offset:0
    buffer_load_dwordx4 a[20:23], v9, s[4:7], s27 offen offset:1024
    buffer_load_dwordx4 a[24:27], v9, s[4:7], s27 offen offset:2048
    buffer_load_dwordx4 a[28:31], v9, s[4:7], s27 offen offset:3072
    s_add_u32 s27, s26, 8192
    buffer_load_dwordx4 a[32:35], v9, s[4:7], s27 offen offset:0
    buffer_load_dwordx4 a[36:39], v9, s[4:7], s27 offen offset:1024
    buffer_load_dwordx4 a[40:43], v9, s[4:7], s27 offen offset:2048
    buffer_load_dwordx4 a[44:47], v9, s[4:7], s27 offen offset:3072
    s_add_u32 s27, s26, 12288
    buffer_load_dwordx4 a[48:51], v9, s[4:7], s27 offen offset:0
    buffer_load_dwordx4 a[52:55], v9, s[4:7], s27 offen offset:1024
    buffer_load_dwordx4 a[56:59], v9, s[4:7], s27 offen offset:2048
    buffer_load_dwordx4 a[60:63], v9, s[4:7], s27 offen offset:3072
    s_add_u32 s27, s26, 16384
    buffer_load_dwordx4 a[64:67], v9, s[4:7], s27 offen offset:0
    buffer_load_dwordx4 a[68:71], v9, s[4:7], s27 offen offset:1024
    buffer_load_dwordx4 a[72:75], v9, s[4:7], s27 offen offset:2048
    buffer_load_dwordx4 a[76:79], v9, s[4:7], s27 offen offset:3072
    s_add_u32 s27, s26, 20480
    buffer_load_dwordx4 a[80:83], v9, s[4:7], s27 offen offset:0
    buffer_load_dwordx4 a[84:87], v9, s[4:7], s27 offen offset:1024
    buffer_load_dwordx4 a[88:91], v9, s[4:7], s27 offen offset:2048
    buffer_load_dwordx4 a[92:95], v9, s[4:7], s27 offen offset:3072
    s_add_u32 s27, s26, 24576
    buffer_load_dwordx4 a[96:99], v9, s[4:7], s27 offen offset:0
    buffer_load_dwordx4 a[100:103], v9, s[4:7], s27 offen offset:1024
    buffer_load_dwordx4 a[104:107], v9, s[4:7], s27 offen offset:2048
    buffer_load_dwordx4 a[108:111], v9, s[4:7], s27 offen offset:3072
    s_add_u32 s27, s26, 28672
    buffer_load_dwordx4 a[112:115], v9, s[4:7], s27 offen offset:0
    buffer_load_dwordx4 a[116:119], v9, s[4:7], s27 offen offset:1024
    buffer_load_dwordx4 a[120:123], v9, s[4:7], s27 offen offset:2048
    buffer_load_dwordx4 a[124:127], v9, s[4:7], s27 offen offset:3072
    s_add_u32 s27, s26, 4194304
    buffer_load_dwordx4 a[128:131], v9, s[4:7], s27 offen offset:0
    buffer_load_dwordx4 a[132:135], v9, s[4:7], s27 offen offset:1024
    buffer_load_dwordx4 a[136:139], v9, s[4:7], s27 offen offset:2048
    buffer_load_dwordx4 a[140:143], v9, s[4:7], s27 offen offset:3072
    s_add_u32 s27, s26, 4198400
    buffer_load_dwordx4 a[144:147], v9, s[4:7], s27 offen offset:0
    buffer_load_dwordx4 a[148:151], v9, s[4:7], s27 offen offset:1024
    buffer_load_dwordx4 a[152:155], v9, s[4:7], s27 offen offset:2048
    buffer_load_dwordx4 a[156:159], v9, s[4:7], s27 offen offset:3072
    s_add_u32 s27, s26, 4202496
    buffer_load_dwordx4 a[160:163], v9, s[4:7], s27 offen offset:0
    buffer_load_dwordx4 a[164:167], v9, s[4:7], s27 offen offset:1024
    buffer_load_dwordx4 a[168:171], v9, s[4:7], s27 offen offset:2048
    buffer_load_dwordx4 a[172:175], v9, s[4:7], s27 offen offset:3072
    s_add_u32 s27, s26, 4206592
    buffer_load_dwordx4 a[176:179], v9, s[4:7], s27 offen offset:0
    buffer_load_dwordx4 a[180:183], v9, s[4:7], s27 offen offset:1024
    buffer_load_dwordx4 a[184:187], v9, s[4:7], s27 offen offset:2048
    buffer_load_dwordx4 a[188:191], v9, s[4:7], s27 offen offset:3072
    s_add_u32 s27, s26, 4210688
    buffer_load_dwordx4 a[192:195], v9, s[4:7], s27 offen offset:0
    buffer_load_dwordx4 a[196:199], v9, s[4:7], s27 offen offset:1024
    buffer_load_dwordx4 a[200:203], v9, s[4:7], s27 offen offset:2048
    buffer_load_dwordx4 a[204:207], v9, s[4:7], s27 offen offset:3072
    s_add_u32 s27, s26, 4214784
    buffer_load_dwordx4 a[208:211], v9, s[4:7], s27 offen offset:0
    buffer_load_dwordx4 a[212:215], v9, s[4:7], s27 offen offset:1024
    buffer_load_dwordx4 a[216:219], v9, s[4:7], s27 offen offset:2048
    buffer_load_dwordx4 a[220:223], v9, s[4:7], s27 offen offset:3072
    s_add_u32 s27, s26, 4218880
    buffer_load_dwordx4 a[224:227], v9, s[4:7], s27 offen offset:0
    buffer_load_dwordx4 a[228:231], v9, s[4:7], s27 offen offset:1024
    buffer_load_dwordx4 a[232:235], v9, s[4:7], s27 offen offset:2048
    buffer_load_dwordx4 a[236:239], v9, s[4:7], s27 offen offset:3072
    s_add_u32 s27, s26, 4222976
    buffer_load_dwordx4 a[240:243], v9, s[4:7], s27 offen offset:0
    buffer_load_dwordx4 a[244:247], v9, s[4:7], s27 offen offset:1024
    buffer_load_dwordx4 a[248:251], v9, s[4:7], s27 offen offset:2048
    buffer_load_dwordx4 a[252:255], v9, s[4:7], s27 offen offset:3072
    s_add_u32 s27, s26, 8388608
    buffer_load_dwordx4 v[128:131], v9, s[4:7], s27 offen offset:0
    buffer_load_dwordx4 v[132:135], v9, s[4:7], s27 offen offset:1024
    buffer_load_dwordx4 v[136:139], v9, s[4:7], s27 offen offset:2048
    buffer_load_dwordx4 v[140:143], v9, s[4:7], s27 offen offset:3072
    s_add_u32 s27, s26, 8392704
    buffer_load_dwordx4 v[144:147], v9, s[4:7], s27 offen offset:0
    buffer_load_dwordx4 v[148:151], v9, s[4:7], s27 offen offset:1024
    buffer_load_dwordx4 v[152:155], v9, s[4:7], s27 offen offset:2048
    buffer_load_dwordx4 v[156:159], v9, s[4:7], s27 offen offset:3072
    s_add_u32 s27, s26, 8396800
    buffer_load_dwordx4 v[160:163], v9, s[4:7], s27 offen offset:0
    buffer_load_dwordx4 v[164:167], v9, s[4:7], s27 offen offset:1024
    buffer_load_dwordx4 v[168:171], v9, s[4:7], s27 offen offset:2048
    buffer_load_dwordx4 v[172:175], v9, s[4:7], s27 offen offset:3072
    s_add_u32 s27, s26, 8400896
    buffer_load_dwordx4 v[176:179], v9, s[4:7], s27 offen offset:0
    buffer_load_dwordx4 v[180:183], v9, s[4:7], s27 offen offset:1024
    buffer_load_dwordx4 v[184:187], v9, s[4:7], s27 offen offset:2048
    buffer_load_dwordx4 v[188:191], v9, s[4:7], s27 offen offset:3072
    s_add_u32 s27, s26, 8404992
    buffer_load_dwordx4 v[192:195], v9, s[4:7], s27 offen offset:0
    buffer_load_dwordx4 v[196:199], v9, s[4:7], s27 offen offset:1024
    buffer_load_dwordx4 v[200:203], v9, s[4:7], s27 offen offset:2048
    buffer_load_dwordx4 v[204:207], v9, s[4:7], s27 offen offset:3072
    s_add_u32 s27, s26, 8409088
    buffer_load_dwordx4 v[208:211], v9, s[4:7], s27 offen offset:0
    buffer_load_dwordx4 v[212:215], v9, s[4:7], s27 offen offset:1024
    buffer_load_dwordx4 v[216:219], v9, s[4:7], s27 offen offset:2048
    buffer_load_dwordx4 v[220:223], v9, s[4:7], s27 offen offset:3072
    s_add_u32 s27, s26, 8413184
    buffer_load_dwordx4 v[224:227], v9, s[4:7], s27 offen offset:0
    buffer_load_dwordx4 v[228:231], v9, s[4:7], s27 offen offset:1024
    buffer_load_dwordx4 v[232:235], v9, s[4:7], s27 offen offset:2048
    buffer_load_dwordx4 v[236:239], v9, s[4:7], s27 offen offset:3072
    s_add_u32 s27, s26, 8417280
    buffer_load_dwordx4 v[240:243], v9, s[4:7], s27 offen offset:0
    buffer_load_dwordx4 v[244:247], v9, s[4:7], s27 offen offset:1024
    buffer_load_dwordx4 v[248:251], v9, s[4:7], s27 offen offset:2048
    buffer_load_dwordx4 v[252:255], v9, s[4:7], s27 offen offset:3072
    s_lshl_b32 s26, s14, 20
    s_lshl_b32 s27, s12, 12
    s_add_u32 s26, s26, s27
    s_add_u32 s26, s26, 12582912
    s_lshl_b32 s27, s14, 15
    s_mov_b32 m0, s27
    s_nop 0
    buffer_load_dwordx4 v9, s[4:7], s26 offen offset:0 lds
    buffer_load_dwordx4 v9, s[4:7], s26 offen offset:1024 lds
    buffer_load_dwordx4 v9, s[4:7], s26 offen offset:2048 lds
    buffer_load_dwordx4 v9, s[4:7], s26 offen offset:3072 lds
    s_add_u32 s26, s26, 131072
    s_add_u32 s27, s27, 4096
    s_mov_b32 m0, s27
    s_nop 0
    buffer_load_dwordx4 v9, s[4:7], s26 offen offset:0 lds
    buffer_load_dwordx4 v9, s[4:7], s26 offen offset:1024 lds
    buffer_load_dwordx4 v9, s[4:7], s26 offen offset:2048 lds
    buffer_load_dwordx4 v9, s[4:7], s26 offen offset:3072 lds
    s_add_u32 s26, s26, 131072
    s_add_u32 s27, s27, 4096
    s_mov_b32 m0, s27
    s_nop 0
    buffer_load_dwordx4 v9, s[4:7], s26 offen offset:0 lds
    buffer_load_dwordx4 v9, s[4:7], s26 offen offset:1024 lds
    buffer_load_dwordx4 v9, s[4:7], s26 offen offset:2048 lds
    buffer_load_dwordx4 v9, s[4:7], s26 offen offset:3072 lds
    s_add_u32 s26, s26, 131072
    s_add_u32 s27, s27, 4096
    s_mov_b32 m0, s27
    s_nop 0
    buffer_load_dwordx4 v9, s[4:7], s26 offen offset:0 lds
    buffer_load_dwordx4 v9, s[4:7], s26 offen offset:1024 lds
    buffer_load_dwordx4 v9, s[4:7], s26 offen offset:2048 lds
    buffer_load_dwordx4 v9, s[4:7], s26 offen offset:3072 lds
    s_add_u32 s26, s26, 131072
    s_add_u32 s27, s27, 4096
    s_mov_b32 m0, s27
    s_nop 0
    buffer_load_dwordx4 v9, s[4:7], s26 offen offset:0 lds
    buffer_load_dwordx4 v9, s[4:7], s26 offen offset:1024 lds
    buffer_load_dwordx4 v9, s[4:7], s26 offen offset:2048 lds
    buffer_load_dwordx4 v9, s[4:7], s26 offen offset:3072 lds
    s_add_u32 s26, s26, 131072
    s_add_u32 s27, s27, 4096
    s_mov_b32 m0, s27
    s_nop 0
    buffer_load_dwordx4 v9, s[4:7], s26 offen offset:0 lds
    buffer_load_dwordx4 v9, s[4:7], s26 offen offset:1024 lds
    buffer_load_dwordx4 v9, s[4:7], s26 offen offset:2048 lds
    buffer_load_dwordx4 v9, s[4:7], s26 offen offset:3072 lds
    s_add_u32 s26, s26, 131072
    s_add_u32 s27, s27, 4096
    s_mov_b32 m0, s27
    s_nop 0
    buffer_load_dwordx4 v9, s[4:7], s26 offen offset:0 lds
    buffer_load_dwordx4 v9, s[4:7], s26 offen offset:1024 lds
    buffer_load_dwordx4 v9, s[4:7], s26 offen offset:2048 lds
    buffer_load_dwordx4 v9, s[4:7], s26 offen offset:3072 lds
    s_add_u32 s26, s26, 131072
    s_add_u32 s27, s27, 4096
    s_mov_b32 m0, s27
    s_nop 0
    buffer_load_dwordx4 v9, s[4:7], s26 offen offset:0 lds
    buffer_load_dwordx4 v9, s[4:7], s26 offen offset:1024 lds
    buffer_load_dwordx4 v9, s[4:7], s26 offen offset:2048 lds
    buffer_load_dwordx4 v9, s[4:7], s26 offen offset:3072 lds
    s_add_u32 s26, s26, 131072
    s_add_u32 s27, s27, 4096
    v_add_u32 v11, 147456, v9
    s_lshl_b32 s26, s14, 9
    v_add_u32 v12, 131072, v1
    v_add_u32 v13, s26, v12
    v_add_u32 v14, 137216, v1
    v_add_u32 v15, s26, v14
    v_add_u32 v17, 139264, v9
    v_cndmask_b32 v15, v17, v15, s[30:31]
    s_lshl_b32 s26, s14, 11
    v_add_u32 v17, s26, v9
    v_add_u32 v18, 139264, v17
    v_add_u32 v1, 139264, v1
    v_mov_b32 v9, v17
    v_mov_b32 v0, v18
    s_mov_b32 s89, 0
    s_mov_b32 s88, 0
mega_kernel_layer:
    s_lshl_b32 s16, s89, 20
    s_add_u32 s16, s16, 100663296
    s_add_u32 s17, s16, 4096
    s_lshr_b32 s26, s12, 1
    s_lshl_b32 s26, s26, 9
    s_and_b32 s27, s12, 1
    s_lshl_b32 s27, s27, 8
    s_add_u32 s18, s26, s27
    s_add_u32 s18, s18, s16
    s_add_u32 s18, s18, 8192
    s_lshl_b32 s26, s12, 19
    s_add_u32 s26, s26, s88
    s_add_u32 s19, s26, 33554432
    s_add_u32 s20, s19, 4096
    s_add_u32 s21, s26, 50331648
    s_lshl_b32 s26, s12, 9
    s_lshl_b32 s27, s14, 17
    s_add_u32 s22, s26, s27
    s_add_u32 s22, s22, 102760448
    s_lshl_b32 s26, s12, 14
    s_add_u32 s23, s26, 102760448
    s_lshl_b32 s26, s12, 17
    s_add_u32 s26, s26, s88
    s_add_u32 s24, s26, 67108864
    s_add_u32 s25, s26, 71303168
    s_mov_b32 s15, 0
    s_lshl_b32 s38, s14, 11
    s_add_u32 s38, s38, 147456
    s_add_u32 s39, s38, 1024
    s_mov_b32 s41, 0
    s_lshl_b32 s42, s89, 12
    s_add_u32 s42, s42, 104988672
    s_lshl_b32 s43, s12, 2
    s_add_u32 s43, s43, s42
    s_add_u32 s43, s43, 512
    s_mov_b32 s47, 0
    s_cmp_lg_u32 s41, 0
    s_cbranch_scc1 kvw_1_ok
    s_mov_b32 s46, 0
kvw_1_p:
    s_lshl_b32 s44, s47, 2
    v_mov_b32 v50, s44
    v_mov_b32 v51, 128
    buffer_load_dword v50, v50, s[4:7], s42 offen sc1
    buffer_load_dword v51, v51, s[4:7], s42 offen sc1
    s_waitcnt vmcnt(0)
    v_readfirstlane_b32 s44, v50
    v_readfirstlane_b32 s45, v51
    s_cmp_ge_u32 s45, 512
    s_cselect_b32 s41, 1, 0
    s_cmp_ge_u32 s44, 32
    s_cbranch_scc1 kvw_1_ok
    s_sleep 2
    s_add_u32 s46, s46, 1
    s_cmp_le_u32 s46, 262144
    s_cbranch_scc1 kvw_1_p
kvw_1_ok:
    s_mov_b32 m0, s38
    s_nop 0
    buffer_load_dwordx4 v2, s[4:7], s19 offen sc1 lds
    s_mov_b32 m0, s39
    s_nop 0
    buffer_load_dwordx4 v2, s[4:7], s20 offen sc1 lds
    s_add_u32 s19, s19, 8192
    s_add_u32 s20, s20, 8192
    s_xor_b32 s38, s38, 0x2000
    s_xor_b32 s39, s39, 0x2000
    s_waitcnt vmcnt(0)
    s_barrier
    s_xor_b32 s29, s23, 0x80000
    s_add_u32 s26, s29, 4096
    s_add_u32 s27, s29, 8192
    s_add_u32 s28, s29, 12288
    s_cmp_lg_u32 s13, 0
    s_cbranch_scc1 mega_kernel_s_step
mega_kernel_f_step:
    s_mov_b32 s36, 0
mega_kernel_f_gpoll:
    buffer_load_dwordx4 v[64:67], v9, s[4:7], s16 offen sc1
    buffer_load_dwordx4 v[68:71], v9, s[4:7], s16 offen offset:1024 sc1
    s_waitcnt vmcnt(0)
    v_max3_u32 v56, v64, v65, v66
    v_max3_u32 v56, v56, v67, v68
    v_max3_u32 v56, v56, v69, v70
    v_max_u32 v56, v56, v71
    v_cmp_eq_u32 vcc, -1, v56
    s_nop 0
    s_cbranch_vccz mega_kernel_f_gok
    s_add_u32 s36, s36, 1
    s_cmp_le_u32 s36, 65536
    s_cbranch_scc1 mega_kernel_f_gpoll
mega_kernel_f_gok:
    ds_write_b128 v0, v[64:67]
    ds_write_b128 v0, v[68:71] offset:1024
    v_mov_b32 v92, -1
    v_mov_b32 v93, -1
    v_mov_b32 v94, -1
    v_mov_b32 v95, -1
    buffer_store_dwordx4 v[92:95], v5, s[4:7], s29 offen
    buffer_store_dwordx4 v[92:95], v5, s[4:7], s26 offen
    buffer_store_dwordx4 v[92:95], v5, s[4:7], s27 offen
    buffer_store_dwordx4 v[92:95], v5, s[4:7], s28 offen
    s_waitcnt lgkmcnt(0)
    s_barrier
    ds_read_b128 v[64:67], v1 offset:0
    ds_read_b128 v[68:71], v1 offset:512
    ds_read_b128 v[72:75], v1 offset:1024
    ds_read_b128 v[76:79], v1 offset:1536
    ds_read_b128 v[80:83], v1 offset:2048
    ds_read_b128 v[84:87], v1 offset:2560
    ds_read_b128 v[88:91], v1 offset:3072
    ds_read_b128 v[92:95], v1 offset:3584
    ds_read_b128 v[96:99], v1 offset:4096
    ds_read_b128 v[100:103], v1 offset:4608
    ds_read_b128 v[104:107], v1 offset:5120
    ds_read_b128 v[108:111], v1 offset:5632
    ds_read_b128 v[112:115], v1 offset:6144
    ds_read_b128 v[116:119], v1 offset:6656
    ds_read_b128 v[120:123], v1 offset:7168
    ds_read_b128 v[124:127], v1 offset:7680
    s_waitcnt lgkmcnt(15)
    v_mfma_f32_16x16x32_bf16 v[32:35], a[0:3], v[64:67], 0
    v_mfma_f32_16x16x32_bf16 v[36:39], a[64:67], v[64:67], 0
    s_waitcnt lgkmcnt(14)
    v_mfma_f32_16x16x32_bf16 v[32:35], a[4:7], v[68:71], v[32:35]
    v_mfma_f32_16x16x32_bf16 v[36:39], a[68:71], v[68:71], v[36:39]
    s_waitcnt lgkmcnt(13)
    v_mfma_f32_16x16x32_bf16 v[32:35], a[8:11], v[72:75], v[32:35]
    v_mfma_f32_16x16x32_bf16 v[36:39], a[72:75], v[72:75], v[36:39]
    buffer_load_dwordx4 v[24:27], v3, s[4:7], s21 offen sc1
    s_waitcnt lgkmcnt(12)
    v_mfma_f32_16x16x32_bf16 v[32:35], a[12:15], v[76:79], v[32:35]
    v_mfma_f32_16x16x32_bf16 v[36:39], a[76:79], v[76:79], v[36:39]
    buffer_load_dwordx4 v[28:31], v3, s[4:7], s21 offen offset:1024 sc1
    s_waitcnt lgkmcnt(11)
    v_mfma_f32_16x16x32_bf16 v[32:35], a[16:19], v[80:83], v[32:35]
    v_mfma_f32_16x16x32_bf16 v[36:39], a[80:83], v[80:83], v[36:39]
    s_add_u32 s21, s21, 8192
    s_waitcnt lgkmcnt(10)
    v_mfma_f32_16x16x32_bf16 v[32:35], a[20:23], v[84:87], v[32:35]
    v_mfma_f32_16x16x32_bf16 v[36:39], a[84:87], v[84:87], v[36:39]
    s_waitcnt lgkmcnt(9)
    v_mfma_f32_16x16x32_bf16 v[32:35], a[24:27], v[88:91], v[32:35]
    v_mfma_f32_16x16x32_bf16 v[36:39], a[88:91], v[88:91], v[36:39]
    s_waitcnt lgkmcnt(8)
    v_mfma_f32_16x16x32_bf16 v[32:35], a[28:31], v[92:95], v[32:35]
    v_mfma_f32_16x16x32_bf16 v[36:39], a[92:95], v[92:95], v[36:39]
    s_waitcnt lgkmcnt(7)
    v_mfma_f32_16x16x32_bf16 v[32:35], a[32:35], v[96:99], v[32:35]
    v_mfma_f32_16x16x32_bf16 v[36:39], a[96:99], v[96:99], v[36:39]
    s_waitcnt lgkmcnt(6)
    v_mfma_f32_16x16x32_bf16 v[32:35], a[36:39], v[100:103], v[32:35]
    v_mfma_f32_16x16x32_bf16 v[36:39], a[100:103], v[100:103], v[36:39]
    s_waitcnt lgkmcnt(5)
    v_mfma_f32_16x16x32_bf16 v[32:35], a[40:43], v[104:107], v[32:35]
    v_mfma_f32_16x16x32_bf16 v[36:39], a[104:107], v[104:107], v[36:39]
    s_waitcnt lgkmcnt(4)
    v_mfma_f32_16x16x32_bf16 v[32:35], a[44:47], v[108:111], v[32:35]
    v_mfma_f32_16x16x32_bf16 v[36:39], a[108:111], v[108:111], v[36:39]
    s_waitcnt lgkmcnt(3)
    v_mfma_f32_16x16x32_bf16 v[32:35], a[48:51], v[112:115], v[32:35]
    v_mfma_f32_16x16x32_bf16 v[36:39], a[112:115], v[112:115], v[36:39]
    s_waitcnt lgkmcnt(2)
    v_mfma_f32_16x16x32_bf16 v[32:35], a[52:55], v[116:119], v[32:35]
    v_mfma_f32_16x16x32_bf16 v[36:39], a[116:119], v[116:119], v[36:39]
    s_waitcnt lgkmcnt(1)
    v_mfma_f32_16x16x32_bf16 v[32:35], a[56:59], v[120:123], v[32:35]
    v_mfma_f32_16x16x32_bf16 v[36:39], a[120:123], v[120:123], v[36:39]
    s_waitcnt lgkmcnt(0)
    v_mfma_f32_16x16x32_bf16 v[32:35], a[60:63], v[124:127], v[32:35]
    v_mfma_f32_16x16x32_bf16 v[36:39], a[124:127], v[124:127], v[36:39]
    v_mfma_f32_16x16x32_bf16 v[40:43], a[128:131], v[64:67], 0
    v_mfma_f32_16x16x32_bf16 v[44:47], a[192:195], v[64:67], 0
    v_mfma_f32_16x16x32_bf16 v[40:43], a[132:135], v[68:71], v[40:43]
    v_mfma_f32_16x16x32_bf16 v[44:47], a[196:199], v[68:71], v[44:47]
    s_nop 2
    v_cvt_pk_bf16_f32 v56, v32, v33
    v_cvt_pk_bf16_f32 v57, v34, v35
    v_cvt_pk_bf16_f32 v58, v36, v37
    v_cvt_pk_bf16_f32 v59, v38, v39
    ds_write_b128 v13, v[56:59]
    v_mfma_f32_16x16x32_bf16 v[40:43], a[136:139], v[72:75], v[40:43]
    v_mfma_f32_16x16x32_bf16 v[44:47], a[200:203], v[72:75], v[44:47]
    s_and_b32 s44, s15, 3
    s_cmp_lg_u32 s44, 0
    s_cbranch_scc1 mega_kernel_f_np
    s_cmp_lg_u32 s14, 0
    s_cbranch_scc1 mega_kernel_f_np
    v_mov_b32 v48, s15
    v_mov_b32 v49, 0
    buffer_store_dword v48, v49, s[4:7], s43 offen sc1
mega_kernel_f_np:
    s_cmp_lg_u32 s44, 3
    s_cbranch_scc1 mega_kernel_f_nk
    s_add_u32 s47, s15, 1
    s_lshr_b32 s47, s47, 2
    s_min_u32 s47, s47, 15
    s_cmp_lg_u32 s41, 0
    s_cbranch_scc1 kvw_2_ok
    s_mov_b32 s46, 0
kvw_2_p:
    s_lshl_b32 s44, s47, 2
    v_mov_b32 v50, s44
    v_mov_b32 v51, 128
    buffer_load_dword v50, v50, s[4:7], s42 offen sc1
    buffer_load_dword v51, v51, s[4:7], s42 offen sc1
    s_waitcnt vmcnt(0)
    v_readfirstlane_b32 s44, v50
    v_readfirstlane_b32 s45, v51
    s_cmp_ge_u32 s45, 512
    s_cselect_b32 s41, 1, 0
    s_cmp_ge_u32 s44, 32
    s_cbranch_scc1 kvw_2_ok
    s_sleep 2
    s_add_u32 s46, s46, 1
    s_cmp_le_u32 s46, 262144
    s_cbranch_scc1 kvw_2_p
kvw_2_ok:
mega_kernel_f_nk:
    s_mov_b32 m0, s38
    s_nop 0
    buffer_load_dwordx4 v2, s[4:7], s19 offen sc1 lds
    v_mfma_f32_16x16x32_bf16 v[40:43], a[140:143], v[76:79], v[40:43]
    s_mov_b32 m0, s39
    s_nop 0
    buffer_load_dwordx4 v2, s[4:7], s20 offen sc1 lds
    v_mfma_f32_16x16x32_bf16 v[44:47], a[204:207], v[76:79], v[44:47]
    s_add_u32 s19, s19, 8192
    s_add_u32 s20, s20, 8192
    v_mfma_f32_16x16x32_bf16 v[40:43], a[144:147], v[80:83], v[40:43]
    s_xor_b32 s38, s38, 0x2000
    s_xor_b32 s39, s39, 0x2000
    v_mfma_f32_16x16x32_bf16 v[44:47], a[208:211], v[80:83], v[44:47]
    s_waitcnt lgkmcnt(0)
    s_barrier
    ds_read_b128 v[16:19], v12 offset:0
    ds_read_b128 v[20:23], v12 offset:512
    ds_read_b128 v[56:59], v12 offset:1024
    ds_read_b128 v[60:63], v12 offset:1536
    ds_read_b128 v[48:51], v11 offset:0
    ds_read_b128 v[52:55], v11 offset:1024
    v_mfma_f32_16x16x32_bf16 v[40:43], a[148:151], v[84:87], v[40:43]
    v_mfma_f32_16x16x32_bf16 v[44:47], a[212:215], v[84:87], v[44:47]
    v_mfma_f32_16x16x32_bf16 v[40:43], a[152:155], v[88:91], v[40:43]
    v_mfma_f32_16x16x32_bf16 v[44:47], a[216:219], v[88:91], v[44:47]
    v_mfma_f32_16x16x32_bf16 v[40:43], a[156:159], v[92:95], v[40:43]
    s_waitcnt lgkmcnt(0)
    v_mfma_f32_16x16x32_bf16 v[32:35], v[48:51], v[16:19], 0
    v_mfma_f32_16x16x32_bf16 v[36:39], v[52:55], v[16:19], 0
    ds_read_b128 v[48:51], v11 offset:2048
    ds_read_b128 v[52:55], v11 offset:3072
    v_mfma_f32_16x16x32_bf16 v[44:47], a[220:223], v[92:95], v[44:47]
    v_mfma_f32_16x16x32_bf16 v[40:43], a[160:163], v[96:99], v[40:43]
    v_mfma_f32_16x16x32_bf16 v[44:47], a[224:227], v[96:99], v[44:47]
    v_mfma_f32_16x16x32_bf16 v[40:43], a[164:167], v[100:103], v[40:43]
    v_mfma_f32_16x16x32_bf16 v[44:47], a[228:231], v[100:103], v[44:47]
    s_waitcnt lgkmcnt(0)
    v_mfma_f32_16x16x32_bf16 v[32:35], v[48:51], v[20:23], v[32:35]
    v_mfma_f32_16x16x32_bf16 v[36:39], v[52:55], v[20:23], v[36:39]
    ds_read_b128 v[48:51], v11 offset:4096
    ds_read_b128 v[52:55], v11 offset:5120
    v_mfma_f32_16x16x32_bf16 v[40:43], a[168:171], v[104:107], v[40:43]
    v_mfma_f32_16x16x32_bf16 v[44:47], a[232:235], v[104:107], v[44:47]
    v_mfma_f32_16x16x32_bf16 v[40:43], a[172:175], v[108:111], v[40:43]
    v_mfma_f32_16x16x32_bf16 v[44:47], a[236:239], v[108:111], v[44:47]
    v_mfma_f32_16x16x32_bf16 v[40:43], a[176:179], v[112:115], v[40:43]
    s_waitcnt lgkmcnt(0)
    v_mfma_f32_16x16x32_bf16 v[32:35], v[48:51], v[56:59], v[32:35]
    v_mfma_f32_16x16x32_bf16 v[36:39], v[52:55], v[56:59], v[36:39]
    ds_read_b128 v[48:51], v11 offset:6144
    ds_read_b128 v[52:55], v11 offset:7168
    v_mfma_f32_16x16x32_bf16 v[44:47], a[240:243], v[112:115], v[44:47]
    v_mfma_f32_16x16x32_bf16 v[40:43], a[180:183], v[116:119], v[40:43]
    v_mfma_f32_16x16x32_bf16 v[44:47], a[244:247], v[116:119], v[44:47]
    v_mfma_f32_16x16x32_bf16 v[40:43], a[184:187], v[120:123], v[40:43]
    s_waitcnt lgkmcnt(0)
    v_mfma_f32_16x16x32_bf16 v[32:35], v[48:51], v[60:63], v[32:35]
    v_mfma_f32_16x16x32_bf16 v[36:39], v[52:55], v[60:63], v[36:39]
    v_mfma_f32_16x16x32_bf16 v[44:47], a[248:251], v[120:123], v[44:47]
    v_mfma_f32_16x16x32_bf16 v[40:43], a[188:191], v[124:127], v[40:43]
    v_mfma_f32_16x16x32_bf16 v[44:47], a[252:255], v[124:127], v[44:47]
    v_xor_b32 v11, 0x2000, v11
    s_nop 4
    s_nop 0
    v_cvt_pk_bf16_f32 v48, v40, v41
    v_cvt_pk_bf16_f32 v49, v42, v43
    v_cvt_pk_bf16_f32 v50, v44, v45
    v_cvt_pk_bf16_f32 v51, v46, v47
    ds_write_b128 v13, v[48:51] offset:2048
    buffer_store_dwordx4 v[48:51], v7, s[4:7], s24 offen sc1
    v_mfma_f32_16x16x32_bf16 v[40:43], v[64:67], v[128:131], 0
    v_mfma_f32_16x16x32_bf16 v[44:47], v[64:67], v[192:195], 0
    v_mfma_f32_16x16x32_bf16 v[40:43], v[68:71], v[132:135], v[40:43]
    v_mfma_f32_16x16x32_bf16 v[44:47], v[68:71], v[196:199], v[44:47]
    v_mfma_f32_16x16x32_bf16 v[40:43], v[72:75], v[136:139], v[40:43]
    v_mfma_f32_16x16x32_bf16 v[44:47], v[72:75], v[200:203], v[44:47]
    v_mfma_f32_16x16x32_bf16 v[40:43], v[76:79], v[140:143], v[40:43]
    v_mfma_f32_16x16x32_bf16 v[44:47], v[76:79], v[204:207], v[44:47]
    s_waitcnt lgkmcnt(0)
    s_barrier
    ds_read_b128 v[64:67], v12 offset:2048
    ds_read_b128 v[68:71], v12 offset:2560
    ds_read_b128 v[72:75], v12 offset:3072
    ds_read_b128 v[76:79], v12 offset:3584
    v_cndmask_b32 v32, v36, v32, s[30:31]
    v_cndmask_b32 v33, v37, v33, s[30:31]
    v_cndmask_b32 v34, v38, v34, s[30:31]
    v_cndmask_b32 v35, v39, v35, s[30:31]
    v_max3_f32 v52, v32, v33, v34
    v_max_f32 v52, v52, v35
    v_mfma_f32_16x16x32_bf16 v[40:43], v[80:83], v[144:147], v[40:43]
    v_mfma_f32_16x16x32_bf16 v[44:47], v[80:83], v[208:211], v[44:47]
    v_mfma_f32_16x16x32_bf16 v[40:43], v[84:87], v[148:151], v[40:43]
    v_mfma_f32_16x16x32_bf16 v[44:47], v[84:87], v[212:215], v[44:47]
    s_waitcnt lgkmcnt(0)
    v_mfma_f32_16x16x32_bf16 v[48:51], v[64:67], v[16:19], 0
    v_mfma_f32_16x16x32_bf16 v[48:51], v[68:71], v[20:23], v[48:51]
    v_mfma_f32_16x16x32_bf16 v[48:51], v[72:75], v[56:59], v[48:51]
    v_mfma_f32_16x16x32_bf16 v[48:51], v[76:79], v[60:63], v[48:51]
    v_mfma_f32_16x16x32_bf16 v[40:43], v[88:91], v[152:155], v[40:43]
    v_mfma_f32_16x16x32_bf16 v[44:47], v[88:91], v[216:219], v[44:47]
    v_mfma_f32_16x16x32_bf16 v[40:43], v[92:95], v[156:159], v[40:43]
    v_mfma_f32_16x16x32_bf16 v[44:47], v[92:95], v[220:223], v[44:47]
    v_mfma_f32_16x16x32_bf16 v[40:43], v[96:99], v[160:163], v[40:43]
    v_mov_b32 v17, 0xf149f2ca
    s_nop 1
    v_cndmask_b32 v36, v50, v48, s[30:31]
    v_cndmask_b32 v37, v51, v49, s[30:31]
    v_mfma_f32_16x16x32_bf16 v[44:47], v[96:99], v[224:227], v[44:47]
    v_cndmask_b32 v36, v17, v36, s[34:35]
    v_cndmask_b32 v37, v17, v37, s[34:35]
    v_max3_f32 v52, v52, v36, v37
    v_mfma_f32_16x16x32_bf16 v[40:43], v[100:103], v[164:167], v[40:43]
    s_nop 0
    v_max_f32_dpp v52, v52, v52 row_ror:8 row_mask:0xf bank_mask:0xf
    v_mov_b32 v53, v52
    s_nop 1
    v_permlane16_swap_b32 v52, v53
    v_mfma_f32_16x16x32_bf16 v[44:47], v[100:103], v[228:231], v[44:47]
    v_max_f32 v52, v52, v53
    v_mov_b32 v53, v52
    s_nop 1
    v_permlane32_swap_b32 v52, v53
    v_mfma_f32_16x16x32_bf16 v[40:43], v[104:107], v[168:171], v[40:43]
    v_max_f32 v52, v52, v53
    v_mul_f32 v52, 0x3e0293ee, v52
    v_mov_b32 v17, 0x3e0293ee
    v_mfma_f32_16x16x32_bf16 v[44:47], v[104:107], v[232:235], v[44:47]
    v_fma_f32 v32, v32, v17, -v52
    v_fma_f32 v33, v33, v17, -v52
    v_fma_f32 v34, v34, v17, -v52
    v_mfma_f32_16x16x32_bf16 v[40:43], v[108:111], v[172:175], v[40:43]
    v_fma_f32 v35, v35, v17, -v52
    v_fma_f32 v36, v36, v17, -v52
    v_fma_f32 v37, v37, v17, -v52
    v_mfma_f32_16x16x32_bf16 v[44:47], v[108:111], v[236:239], v[44:47]
    v_exp_f32 v32, v32
    v_exp_f32 v33, v33
    v_exp_f32 v34, v34
    v_mfma_f32_16x16x32_bf16 v[40:43], v[112:115], v[176:179], v[40:43]
    v_exp_f32 v35, v35
    v_exp_f32 v36, v36
    v_exp_f32 v37, v37
    v_mfma_f32_16x16x32_bf16 v[44:47], v[112:115], v[240:243], v[44:47]
    v_add_f32 v52, v32, v33
    v_add_f32 v53, v34, v35
    v_add_f32 v52, v52, v36
    v_mfma_f32_16x16x32_bf16 v[40:43], v[116:119], v[180:183], v[40:43]
    v_add_f32 v53, v53, v37
    v_add_f32 v52, v52, v53
    s_nop 1
    v_add_f32_dpp v52, v52, v52 row_ror:8 row_mask:0xf bank_mask:0xf
    v_mfma_f32_16x16x32_bf16 v[44:47], v[116:119], v[244:247], v[44:47]
    v_mov_b32 v53, v52
    s_nop 1
    v_permlane16_swap_b32 v52, v53
    v_add_f32 v52, v52, v53
    v_mfma_f32_16x16x32_bf16 v[40:43], v[120:123], v[184:187], v[40:43]
    v_mov_b32 v53, v52
    s_nop 1
    v_permlane32_swap_b32 v52, v53
    v_add_f32 v52, v52, v53
    v_mfma_f32_16x16x32_bf16 v[44:47], v[120:123], v[248:251], v[44:47]
    v_rcp_f32 v52, v52
    s_nop 0
    v_mul_f32 v32, v32, v52
    v_mul_f32 v33, v33, v52
    v_mfma_f32_16x16x32_bf16 v[40:43], v[124:127], v[188:191], v[40:43]
    v_mul_f32 v34, v34, v52
    v_mul_f32 v35, v35, v52
    v_mul_f32 v36, v36, v52
    v_mfma_f32_16x16x32_bf16 v[44:47], v[124:127], v[252:255], v[44:47]
    v_mul_f32 v37, v37, v52
    v_cvt_pk_bf16_f32 v16, v32, v33
    v_cvt_pk_bf16_f32 v17, v34, v35
    v_cvt_pk_bf16_f32 v20, v36, v37
    v_mov_b32_dpp v18, v16 row_ror:8 row_mask:0xf bank_mask:0xf
    v_mov_b32_dpp v19, v17 row_ror:8 row_mask:0xf bank_mask:0xf
    v_mov_b32_dpp v21, v20 row_ror:8 row_mask:0xf bank_mask:0xf
    ds_read_b128 v[64:67], v10 offset:0
    ds_read_b128 v[68:71], v10 offset:1024
    ds_read_b128 v[72:75], v10 offset:2048
    ds_read_b128 v[76:79], v10 offset:3072
    ds_read_b128 v[80:83], v10 offset:4096
    ds_read_b128 v[84:87], v10 offset:5120
    ds_read_b128 v[88:91], v10 offset:6144
    ds_read_b128 v[92:95], v10 offset:7168
    ds_read_b128 v[96:99], v10 offset:8192
    ds_read_b128 v[100:103], v10 offset:9216
    ds_read_b128 v[104:107], v10 offset:10240
    ds_read_b128 v[108:111], v10 offset:11264
    ds_read_b128 v[112:115], v10 offset:12288
    ds_read_b128 v[116:119], v10 offset:13312
    ds_read_b128 v[120:123], v10 offset:14336
    ds_read_b128 v[124:127], v10 offset:15360
    v_cvt_pk_bf16_f32 v56, v40, v41
    v_cvt_pk_bf16_f32 v57, v42, v43
    v_cvt_pk_bf16_f32 v60, v44, v45
    v_cvt_pk_bf16_f32 v61, v46, v47
    s_waitcnt vmcnt(3)
    v_mfma_f32_16x16x32_bf16 v[32:35], v[24:27], v[16:19], 0
    v_mfma_f32_16x16x32_bf16 v[36:39], v[28:31], v[16:19], 0
    v_mfma_f32_16x16x16_bf16 v[32:35], v[56:57], v[20:21], v[32:35]
    v_mfma_f32_16x16x16_bf16 v[36:39], v[60:61], v[20:21], v[36:39]
    buffer_store_dwordx2 v[56:57], v8, s[4:7], s25 offen sc1
    buffer_store_dwordx2 v[60:61], v8, s[4:7], s25 offen offset:256 sc1
    s_nop 4
    v_cvt_pk_bf16_f32 v40, v32, v33
    v_cvt_pk_bf16_f32 v41, v34, v35
    v_cvt_pk_bf16_f32 v42, v36, v37
    v_cvt_pk_bf16_f32 v43, v38, v39
    ds_write_b128 v15, v[40:43]
    s_waitcnt lgkmcnt(0)
    s_barrier
    ds_read_b128 v[44:47], v14 offset:0
    ds_read_b128 v[48:51], v14 offset:512
    ds_read_b128 v[52:55], v14 offset:1024
    ds_read_b128 v[56:59], v14 offset:1536
    s_waitcnt lgkmcnt(0)
    s_mov_b32 s26, s22
    v_mfma_f32_16x16x32_bf16 v[16:19], v[64:67], v[44:47], 0
    v_mfma_f32_16x16x32_bf16 v[16:19], v[68:71], v[48:51], v[16:19]
    v_mfma_f32_16x16x32_bf16 v[16:19], v[72:75], v[52:55], v[16:19]
    v_mfma_f32_16x16x32_bf16 v[16:19], v[76:79], v[56:59], v[16:19]
    ds_read_b128 v[64:67], v10 offset:16384
    ds_read_b128 v[68:71], v10 offset:17408
    ds_read_b128 v[72:75], v10 offset:18432
    ds_read_b128 v[76:79], v10 offset:19456
    v_mfma_f32_16x16x32_bf16 v[20:23], v[80:83], v[44:47], 0
    v_mfma_f32_16x16x32_bf16 v[20:23], v[84:87], v[48:51], v[20:23]
    v_mfma_f32_16x16x32_bf16 v[20:23], v[88:91], v[52:55], v[20:23]
    v_mfma_f32_16x16x32_bf16 v[20:23], v[92:95], v[56:59], v[20:23]
    ds_read_b128 v[80:83], v10 offset:20480
    ds_read_b128 v[84:87], v10 offset:21504
    ds_read_b128 v[88:91], v10 offset:22528
    ds_read_b128 v[92:95], v10 offset:23552
    buffer_store_dwordx4 v[16:19], v4, s[4:7], s26 offen
    s_add_u32 s26, s26, 16384
    v_mfma_f32_16x16x32_bf16 v[24:27], v[96:99], v[44:47], 0
    v_mfma_f32_16x16x32_bf16 v[24:27], v[100:103], v[48:51], v[24:27]
    v_mfma_f32_16x16x32_bf16 v[24:27], v[104:107], v[52:55], v[24:27]
    v_mfma_f32_16x16x32_bf16 v[24:27], v[108:111], v[56:59], v[24:27]
    ds_read_b128 v[96:99], v10 offset:24576
    ds_read_b128 v[100:103], v10 offset:25600
    ds_read_b128 v[104:107], v10 offset:26624
    ds_read_b128 v[108:111], v10 offset:27648
    buffer_store_dwordx4 v[20:23], v4, s[4:7], s26 offen
    s_add_u32 s26, s26, 16384
    v_mfma_f32_16x16x32_bf16 v[28:31], v[112:115], v[44:47], 0
    v_mfma_f32_16x16x32_bf16 v[28:31], v[116:119], v[48:51], v[28:31]
    v_mfma_f32_16x16x32_bf16 v[28:31], v[120:123], v[52:55], v[28:31]
    v_mfma_f32_16x16x32_bf16 v[28:31], v[124:127], v[56:59], v[28:31]
    ds_read_b128 v[112:115], v10 offset:28672
    ds_read_b128 v[116:119], v10 offset:29696
    ds_read_b128 v[120:123], v10 offset:30720
    ds_read_b128 v[124:127], v10 offset:31744
    buffer_store_dwordx4 v[24:27], v4, s[4:7], s26 offen
    s_add_u32 s26, s26, 16384
    s_waitcnt lgkmcnt(12)
    v_mfma_f32_16x16x32_bf16 v[32:35], v[64:67], v[44:47], 0
    v_mfma_f32_16x16x32_bf16 v[32:35], v[68:71], v[48:51], v[32:35]
    v_mfma_f32_16x16x32_bf16 v[32:35], v[72:75], v[52:55], v[32:35]
    v_mfma_f32_16x16x32_bf16 v[32:35], v[76:79], v[56:59], v[32:35]
    buffer_store_dwordx4 v[28:31], v4, s[4:7], s26 offen
    s_add_u32 s26, s26, 16384
    s_waitcnt lgkmcnt(8)
    v_mfma_f32_16x16x32_bf16 v[36:39], v[80:83], v[44:47], 0
    v_mfma_f32_16x16x32_bf16 v[36:39], v[84:87], v[48:51], v[36:39]
    v_mfma_f32_16x16x32_bf16 v[36:39], v[88:91], v[52:55], v[36:39]
    v_mfma_f32_16x16x32_bf16 v[36:39], v[92:95], v[56:59], v[36:39]
    s_nop 0
    buffer_store_dwordx4 v[32:35], v4, s[4:7], s26 offen
    s_add_u32 s26, s26, 16384
    s_waitcnt lgkmcnt(4)
    v_mfma_f32_16x16x32_bf16 v[40:43], v[96:99], v[44:47], 0
    v_mfma_f32_16x16x32_bf16 v[40:43], v[100:103], v[48:51], v[40:43]
    v_mfma_f32_16x16x32_bf16 v[40:43], v[104:107], v[52:55], v[40:43]
    v_mfma_f32_16x16x32_bf16 v[40:43], v[108:111], v[56:59], v[40:43]
    buffer_store_dwordx4 v[36:39], v4, s[4:7], s26 offen
    s_add_u32 s26, s26, 16384
    s_waitcnt lgkmcnt(0)
    v_mfma_f32_16x16x32_bf16 v[60:63], v[112:115], v[44:47], 0
    v_mfma_f32_16x16x32_bf16 v[60:63], v[116:119], v[48:51], v[60:63]
    v_mfma_f32_16x16x32_bf16 v[60:63], v[120:123], v[52:55], v[60:63]
    v_mfma_f32_16x16x32_bf16 v[60:63], v[124:127], v[56:59], v[60:63]
    s_nop 0
    buffer_store_dwordx4 v[40:43], v4, s[4:7], s26 offen
    s_add_u32 s26, s26, 16384
    s_nop 4
    buffer_store_dwordx4 v[60:63], v4, s[4:7], s26 offen
    s_add_u32 s26, s26, 16384
    s_add_u32 s24, s24, 2048
    s_add_u32 s25, s25, 2048
    s_add_u32 s26, s23, 4096
    s_add_u32 s27, s23, 8192
    s_add_u32 s28, s23, 12288
    s_mov_b32 s36, 0
mega_kernel_f_rpoll:
    buffer_load_dwordx4 v[64:67], v5, s[4:7], s23 offen sc1
    buffer_load_dwordx4 v[68:71], v5, s[4:7], s26 offen sc1
    buffer_load_dwordx4 v[72:75], v5, s[4:7], s27 offen sc1
    buffer_load_dwordx4 v[76:79], v5, s[4:7], s28 offen sc1
    s_waitcnt vmcnt(0)
    v_max3_u32 v80, v64, v65, v66
    v_max3_u32 v80, v80, v67, v68
    v_max3_u32 v80, v80, v69, v70
    v_max3_u32 v80, v80, v71, v72
    v_max3_u32 v80, v80, v73, v74
    v_max3_u32 v80, v80, v75, v76
    v_max3_u32 v80, v80, v77, v78
    v_max_u32 v80, v80, v79
    v_cmp_eq_u32 vcc, -1, v80
    s_nop 0
    s_cbranch_vccz mega_kernel_f_rok
    s_add_u32 s36, s36, 1
    s_cmp_le_u32 s36, 65536
    s_cbranch_scc1 mega_kernel_f_rpoll
mega_kernel_f_rok:
    v_add_f32 v80, v64, v68
    v_add_f32 v84, v72, v76
    v_add_f32 v81, v65, v69
    v_add_f32 v85, v73, v77
    v_add_f32 v82, v66, v70
    v_add_f32 v86, v74, v78
    v_add_f32 v83, v67, v71
    v_add_f32 v87, v75, v79
    v_add_f32 v80, v80, v84
    v_add_f32 v81, v81, v85
    v_add_f32 v82, v82, v86
    v_add_f32 v83, v83, v87
    v_add_f32_dpp v80, v80, v80 row_ror:8 row_mask:0xf bank_mask:0xf
    v_add_f32_dpp v81, v81, v81 row_ror:8 row_mask:0xf bank_mask:0xf
    v_add_f32_dpp v82, v82, v82 row_ror:8 row_mask:0xf bank_mask:0xf
    v_add_f32_dpp v83, v83, v83 row_ror:8 row_mask:0xf bank_mask:0xf
    v_permlane32_swap_b32 v80, v81
    s_nop 0
    v_permlane32_swap_b32 v82, v83
    v_add_f32 v80, v80, v81
    v_add_f32 v82, v82, v83
    s_nop 1
    v_permlane16_swap_b32 v80, v82
    v_add_f32 v80, v80, v82
    v_mov_b32 v81, v80
    s_nop 1
    v_permlane32_swap_b32 v80, v81
    v_cvt_pk_bf16_f32 v88, v80, v81
    buffer_store_dword v88, v6, s[4:7], s18 offen
    s_mov_b32 s29, s23
    s_add_u32 s16, s16, 8192
    s_add_u32 s17, s17, 8192
    s_add_u32 s18, s18, 8192
    s_xor_b32 s22, s22, 0x80000
    s_xor_b32 s23, s23, 0x80000
    s_add_u32 s15, s15, 1
    s_cmp_lt_u32 s15, 64
    s_cbranch_scc1 mega_kernel_f_step
    s_branch mega_kernel_recdone
mega_kernel_s_step:
    s_mov_b32 s36, 0
mega_kernel_s_gpoll:
    buffer_load_dwordx4 v[64:67], v9, s[4:7], s16 offen sc1
    buffer_load_dwordx4 v[68:71], v9, s[4:7], s16 offen offset:1024 sc1
    s_waitcnt vmcnt(0)
    v_max3_u32 v56, v64, v65, v66
    v_max3_u32 v56, v56, v67, v68
    v_max3_u32 v56, v56, v69, v70
    v_max_u32 v56, v56, v71
    v_cmp_eq_u32 vcc, -1, v56
    s_nop 0
    s_cbranch_vccz mega_kernel_s_gok
    s_add_u32 s36, s36, 1
    s_cmp_le_u32 s36, 65536
    s_cbranch_scc1 mega_kernel_s_gpoll
mega_kernel_s_gok:
    ds_write_b128 v0, v[64:67]
    ds_write_b128 v0, v[68:71] offset:1024
    v_mov_b32 v92, -1
    v_mov_b32 v93, -1
    v_mov_b32 v94, -1
    v_mov_b32 v95, -1
    buffer_store_dwordx4 v[92:95], v5, s[4:7], s29 offen sc1
    buffer_store_dwordx4 v[92:95], v5, s[4:7], s26 offen sc1
    buffer_store_dwordx4 v[92:95], v5, s[4:7], s27 offen sc1
    buffer_store_dwordx4 v[92:95], v5, s[4:7], s28 offen sc1
    s_waitcnt lgkmcnt(0)
    s_barrier
    ds_read_b128 v[64:67], v1 offset:0
    ds_read_b128 v[68:71], v1 offset:512
    ds_read_b128 v[72:75], v1 offset:1024
    ds_read_b128 v[76:79], v1 offset:1536
    ds_read_b128 v[80:83], v1 offset:2048
    ds_read_b128 v[84:87], v1 offset:2560
    ds_read_b128 v[88:91], v1 offset:3072
    ds_read_b128 v[92:95], v1 offset:3584
    ds_read_b128 v[96:99], v1 offset:4096
    ds_read_b128 v[100:103], v1 offset:4608
    ds_read_b128 v[104:107], v1 offset:5120
    ds_read_b128 v[108:111], v1 offset:5632
    ds_read_b128 v[112:115], v1 offset:6144
    ds_read_b128 v[116:119], v1 offset:6656
    ds_read_b128 v[120:123], v1 offset:7168
    ds_read_b128 v[124:127], v1 offset:7680
    s_waitcnt lgkmcnt(15)
    v_mfma_f32_16x16x32_bf16 v[32:35], a[0:3], v[64:67], 0
    v_mfma_f32_16x16x32_bf16 v[36:39], a[64:67], v[64:67], 0
    s_waitcnt lgkmcnt(14)
    v_mfma_f32_16x16x32_bf16 v[32:35], a[4:7], v[68:71], v[32:35]
    v_mfma_f32_16x16x32_bf16 v[36:39], a[68:71], v[68:71], v[36:39]
    s_waitcnt lgkmcnt(13)
    v_mfma_f32_16x16x32_bf16 v[32:35], a[8:11], v[72:75], v[32:35]
    v_mfma_f32_16x16x32_bf16 v[36:39], a[72:75], v[72:75], v[36:39]
    buffer_load_dwordx4 v[24:27], v3, s[4:7], s21 offen sc1
    s_waitcnt lgkmcnt(12)
    v_mfma_f32_16x16x32_bf16 v[32:35], a[12:15], v[76:79], v[32:35]
    v_mfma_f32_16x16x32_bf16 v[36:39], a[76:79], v[76:79], v[36:39]
    buffer_load_dwordx4 v[28:31], v3, s[4:7], s21 offen offset:1024 sc1
    s_waitcnt lgkmcnt(11)
    v_mfma_f32_16x16x32_bf16 v[32:35], a[16:19], v[80:83], v[32:35]
    v_mfma_f32_16x16x32_bf16 v[36:39], a[80:83], v[80:83], v[36:39]
    s_add_u32 s21, s21, 8192
    s_waitcnt lgkmcnt(10)
    v_mfma_f32_16x16x32_bf16 v[32:35], a[20:23], v[84:87], v[32:35]
    v_mfma_f32_16x16x32_bf16 v[36:39], a[84:87], v[84:87], v[36:39]
    s_waitcnt lgkmcnt(9)
    v_mfma_f32_16x16x32_bf16 v[32:35], a[24:27], v[88:91], v[32:35]
    v_mfma_f32_16x16x32_bf16 v[36:39], a[88:91], v[88:91], v[36:39]
    s_waitcnt lgkmcnt(8)
    v_mfma_f32_16x16x32_bf16 v[32:35], a[28:31], v[92:95], v[32:35]
    v_mfma_f32_16x16x32_bf16 v[36:39], a[92:95], v[92:95], v[36:39]
    s_waitcnt lgkmcnt(7)
    v_mfma_f32_16x16x32_bf16 v[32:35], a[32:35], v[96:99], v[32:35]
    v_mfma_f32_16x16x32_bf16 v[36:39], a[96:99], v[96:99], v[36:39]
    s_waitcnt lgkmcnt(6)
    v_mfma_f32_16x16x32_bf16 v[32:35], a[36:39], v[100:103], v[32:35]
    v_mfma_f32_16x16x32_bf16 v[36:39], a[100:103], v[100:103], v[36:39]
    s_waitcnt lgkmcnt(5)
    v_mfma_f32_16x16x32_bf16 v[32:35], a[40:43], v[104:107], v[32:35]
    v_mfma_f32_16x16x32_bf16 v[36:39], a[104:107], v[104:107], v[36:39]
    s_waitcnt lgkmcnt(4)
    v_mfma_f32_16x16x32_bf16 v[32:35], a[44:47], v[108:111], v[32:35]
    v_mfma_f32_16x16x32_bf16 v[36:39], a[108:111], v[108:111], v[36:39]
    s_waitcnt lgkmcnt(3)
    v_mfma_f32_16x16x32_bf16 v[32:35], a[48:51], v[112:115], v[32:35]
    v_mfma_f32_16x16x32_bf16 v[36:39], a[112:115], v[112:115], v[36:39]
    s_waitcnt lgkmcnt(2)
    v_mfma_f32_16x16x32_bf16 v[32:35], a[52:55], v[116:119], v[32:35]
    v_mfma_f32_16x16x32_bf16 v[36:39], a[116:119], v[116:119], v[36:39]
    s_waitcnt lgkmcnt(1)
    v_mfma_f32_16x16x32_bf16 v[32:35], a[56:59], v[120:123], v[32:35]
    v_mfma_f32_16x16x32_bf16 v[36:39], a[120:123], v[120:123], v[36:39]
    s_waitcnt lgkmcnt(0)
    v_mfma_f32_16x16x32_bf16 v[32:35], a[60:63], v[124:127], v[32:35]
    v_mfma_f32_16x16x32_bf16 v[36:39], a[124:127], v[124:127], v[36:39]
    v_mfma_f32_16x16x32_bf16 v[40:43], a[128:131], v[64:67], 0
    v_mfma_f32_16x16x32_bf16 v[44:47], a[192:195], v[64:67], 0
    v_mfma_f32_16x16x32_bf16 v[40:43], a[132:135], v[68:71], v[40:43]
    v_mfma_f32_16x16x32_bf16 v[44:47], a[196:199], v[68:71], v[44:47]
    s_nop 2
    v_cvt_pk_bf16_f32 v56, v32, v33
    v_cvt_pk_bf16_f32 v57, v34, v35
    v_cvt_pk_bf16_f32 v58, v36, v37
    v_cvt_pk_bf16_f32 v59, v38, v39
    ds_write_b128 v13, v[56:59]
    v_mfma_f32_16x16x32_bf16 v[40:43], a[136:139], v[72:75], v[40:43]
    v_mfma_f32_16x16x32_bf16 v[44:47], a[200:203], v[72:75], v[44:47]
    s_and_b32 s44, s15, 3
    s_cmp_lg_u32 s44, 0
    s_cbranch_scc1 mega_kernel_s_np
    s_cmp_lg_u32 s14, 0
    s_cbranch_scc1 mega_kernel_s_np
    v_mov_b32 v48, s15
    v_mov_b32 v49, 0
    buffer_store_dword v48, v49, s[4:7], s43 offen sc1
mega_kernel_s_np:
    s_cmp_lg_u32 s44, 3
    s_cbranch_scc1 mega_kernel_s_nk
    s_add_u32 s47, s15, 1
    s_lshr_b32 s47, s47, 2
    s_min_u32 s47, s47, 15
    s_cmp_lg_u32 s41, 0
    s_cbranch_scc1 kvw_3_ok
    s_mov_b32 s46, 0
kvw_3_p:
    s_lshl_b32 s44, s47, 2
    v_mov_b32 v50, s44
    v_mov_b32 v51, 128
    buffer_load_dword v50, v50, s[4:7], s42 offen sc1
    buffer_load_dword v51, v51, s[4:7], s42 offen sc1
    s_waitcnt vmcnt(0)
    v_readfirstlane_b32 s44, v50
    v_readfirstlane_b32 s45, v51
    s_cmp_ge_u32 s45, 512
    s_cselect_b32 s41, 1, 0
    s_cmp_ge_u32 s44, 32
    s_cbranch_scc1 kvw_3_ok
    s_sleep 2
    s_add_u32 s46, s46, 1
    s_cmp_le_u32 s46, 262144
    s_cbranch_scc1 kvw_3_p
kvw_3_ok:
mega_kernel_s_nk:
    s_mov_b32 m0, s38
    s_nop 0
    buffer_load_dwordx4 v2, s[4:7], s19 offen sc1 lds
    v_mfma_f32_16x16x32_bf16 v[40:43], a[140:143], v[76:79], v[40:43]
    s_mov_b32 m0, s39
    s_nop 0
    buffer_load_dwordx4 v2, s[4:7], s20 offen sc1 lds
    v_mfma_f32_16x16x32_bf16 v[44:47], a[204:207], v[76:79], v[44:47]
    s_add_u32 s19, s19, 8192
    s_add_u32 s20, s20, 8192
    v_mfma_f32_16x16x32_bf16 v[40:43], a[144:147], v[80:83], v[40:43]
    s_xor_b32 s38, s38, 0x2000
    s_xor_b32 s39, s39, 0x2000
    v_mfma_f32_16x16x32_bf16 v[44:47], a[208:211], v[80:83], v[44:47]
    s_waitcnt lgkmcnt(0)
    s_barrier
    ds_read_b128 v[16:19], v12 offset:0
    ds_read_b128 v[20:23], v12 offset:512
    ds_read_b128 v[56:59], v12 offset:1024
    ds_read_b128 v[60:63], v12 offset:1536
    ds_read_b128 v[48:51], v11 offset:0
    ds_read_b128 v[52:55], v11 offset:1024
    v_mfma_f32_16x16x32_bf16 v[40:43], a[148:151], v[84:87], v[40:43]
    v_mfma_f32_16x16x32_bf16 v[44:47], a[212:215], v[84:87], v[44:47]
    v_mfma_f32_16x16x32_bf16 v[40:43], a[152:155], v[88:91], v[40:43]
    v_mfma_f32_16x16x32_bf16 v[44:47], a[216:219], v[88:91], v[44:47]
    v_mfma_f32_16x16x32_bf16 v[40:43], a[156:159], v[92:95], v[40:43]
    s_waitcnt lgkmcnt(0)
    v_mfma_f32_16x16x32_bf16 v[32:35], v[48:51], v[16:19], 0
    v_mfma_f32_16x16x32_bf16 v[36:39], v[52:55], v[16:19], 0
    ds_read_b128 v[48:51], v11 offset:2048
    ds_read_b128 v[52:55], v11 offset:3072
    v_mfma_f32_16x16x32_bf16 v[44:47], a[220:223], v[92:95], v[44:47]
    v_mfma_f32_16x16x32_bf16 v[40:43], a[160:163], v[96:99], v[40:43]
    v_mfma_f32_16x16x32_bf16 v[44:47], a[224:227], v[96:99], v[44:47]
    v_mfma_f32_16x16x32_bf16 v[40:43], a[164:167], v[100:103], v[40:43]
    v_mfma_f32_16x16x32_bf16 v[44:47], a[228:231], v[100:103], v[44:47]
    s_waitcnt lgkmcnt(0)
    v_mfma_f32_16x16x32_bf16 v[32:35], v[48:51], v[20:23], v[32:35]
    v_mfma_f32_16x16x32_bf16 v[36:39], v[52:55], v[20:23], v[36:39]
    ds_read_b128 v[48:51], v11 offset:4096
    ds_read_b128 v[52:55], v11 offset:5120
    v_mfma_f32_16x16x32_bf16 v[40:43], a[168:171], v[104:107], v[40:43]
    v_mfma_f32_16x16x32_bf16 v[44:47], a[232:235], v[104:107], v[44:47]
    v_mfma_f32_16x16x32_bf16 v[40:43], a[172:175], v[108:111], v[40:43]
    v_mfma_f32_16x16x32_bf16 v[44:47], a[236:239], v[108:111], v[44:47]
    v_mfma_f32_16x16x32_bf16 v[40:43], a[176:179], v[112:115], v[40:43]
    s_waitcnt lgkmcnt(0)
    v_mfma_f32_16x16x32_bf16 v[32:35], v[48:51], v[56:59], v[32:35]
    v_mfma_f32_16x16x32_bf16 v[36:39], v[52:55], v[56:59], v[36:39]
    ds_read_b128 v[48:51], v11 offset:6144
    ds_read_b128 v[52:55], v11 offset:7168
    v_mfma_f32_16x16x32_bf16 v[44:47], a[240:243], v[112:115], v[44:47]
    v_mfma_f32_16x16x32_bf16 v[40:43], a[180:183], v[116:119], v[40:43]
    v_mfma_f32_16x16x32_bf16 v[44:47], a[244:247], v[116:119], v[44:47]
    v_mfma_f32_16x16x32_bf16 v[40:43], a[184:187], v[120:123], v[40:43]
    s_waitcnt lgkmcnt(0)
    v_mfma_f32_16x16x32_bf16 v[32:35], v[48:51], v[60:63], v[32:35]
    v_mfma_f32_16x16x32_bf16 v[36:39], v[52:55], v[60:63], v[36:39]
    v_mfma_f32_16x16x32_bf16 v[44:47], a[248:251], v[120:123], v[44:47]
    v_mfma_f32_16x16x32_bf16 v[40:43], a[188:191], v[124:127], v[40:43]
    v_mfma_f32_16x16x32_bf16 v[44:47], a[252:255], v[124:127], v[44:47]
    v_xor_b32 v11, 0x2000, v11
    s_nop 4
    s_nop 0
    v_cvt_pk_bf16_f32 v48, v40, v41
    v_cvt_pk_bf16_f32 v49, v42, v43
    v_cvt_pk_bf16_f32 v50, v44, v45
    v_cvt_pk_bf16_f32 v51, v46, v47
    ds_write_b128 v13, v[48:51] offset:2048
    buffer_store_dwordx4 v[48:51], v7, s[4:7], s24 offen sc1
    v_mfma_f32_16x16x32_bf16 v[40:43], v[64:67], v[128:131], 0
    v_mfma_f32_16x16x32_bf16 v[44:47], v[64:67], v[192:195], 0
    v_mfma_f32_16x16x32_bf16 v[40:43], v[68:71], v[132:135], v[40:43]
    v_mfma_f32_16x16x32_bf16 v[44:47], v[68:71], v[196:199], v[44:47]
    v_mfma_f32_16x16x32_bf16 v[40:43], v[72:75], v[136:139], v[40:43]
    v_mfma_f32_16x16x32_bf16 v[44:47], v[72:75], v[200:203], v[44:47]
    v_mfma_f32_16x16x32_bf16 v[40:43], v[76:79], v[140:143], v[40:43]
    v_mfma_f32_16x16x32_bf16 v[44:47], v[76:79], v[204:207], v[44:47]
    s_waitcnt lgkmcnt(0)
    s_barrier
    ds_read_b128 v[64:67], v12 offset:2048
    ds_read_b128 v[68:71], v12 offset:2560
    ds_read_b128 v[72:75], v12 offset:3072
    ds_read_b128 v[76:79], v12 offset:3584
    v_cndmask_b32 v32, v36, v32, s[30:31]
    v_cndmask_b32 v33, v37, v33, s[30:31]
    v_cndmask_b32 v34, v38, v34, s[30:31]
    v_cndmask_b32 v35, v39, v35, s[30:31]
    v_max3_f32 v52, v32, v33, v34
    v_max_f32 v52, v52, v35
    v_mfma_f32_16x16x32_bf16 v[40:43], v[80:83], v[144:147], v[40:43]
    v_mfma_f32_16x16x32_bf16 v[44:47], v[80:83], v[208:211], v[44:47]
    v_mfma_f32_16x16x32_bf16 v[40:43], v[84:87], v[148:151], v[40:43]
    v_mfma_f32_16x16x32_bf16 v[44:47], v[84:87], v[212:215], v[44:47]
    s_waitcnt lgkmcnt(0)
    v_mfma_f32_16x16x32_bf16 v[48:51], v[64:67], v[16:19], 0
    v_mfma_f32_16x16x32_bf16 v[48:51], v[68:71], v[20:23], v[48:51]
    v_mfma_f32_16x16x32_bf16 v[48:51], v[72:75], v[56:59], v[48:51]
    v_mfma_f32_16x16x32_bf16 v[48:51], v[76:79], v[60:63], v[48:51]
    v_mfma_f32_16x16x32_bf16 v[40:43], v[88:91], v[152:155], v[40:43]
    v_mfma_f32_16x16x32_bf16 v[44:47], v[88:91], v[216:219], v[44:47]
    v_mfma_f32_16x16x32_bf16 v[40:43], v[92:95], v[156:159], v[40:43]
    v_mfma_f32_16x16x32_bf16 v[44:47], v[92:95], v[220:223], v[44:47]
    v_mfma_f32_16x16x32_bf16 v[40:43], v[96:99], v[160:163], v[40:43]
    v_mov_b32 v17, 0xf149f2ca
    s_nop 1
    v_cndmask_b32 v36, v50, v48, s[30:31]
    v_cndmask_b32 v37, v51, v49, s[30:31]
    v_mfma_f32_16x16x32_bf16 v[44:47], v[96:99], v[224:227], v[44:47]
    v_cndmask_b32 v36, v17, v36, s[34:35]
    v_cndmask_b32 v37, v17, v37, s[34:35]
    v_max3_f32 v52, v52, v36, v37
    v_mfma_f32_16x16x32_bf16 v[40:43], v[100:103], v[164:167], v[40:43]
    s_nop 0
    v_max_f32_dpp v52, v52, v52 row_ror:8 row_mask:0xf bank_mask:0xf
    v_mov_b32 v53, v52
    s_nop 1
    v_permlane16_swap_b32 v52, v53
    v_mfma_f32_16x16x32_bf16 v[44:47], v[100:103], v[228:231], v[44:47]
    v_max_f32 v52, v52, v53
    v_mov_b32 v53, v52
    s_nop 1
    v_permlane32_swap_b32 v52, v53
    v_mfma_f32_16x16x32_bf16 v[40:43], v[104:107], v[168:171], v[40:43]
    v_max_f32 v52, v52, v53
    v_mul_f32 v52, 0x3e0293ee, v52
    v_mov_b32 v17, 0x3e0293ee
    v_mfma_f32_16x16x32_bf16 v[44:47], v[104:107], v[232:235], v[44:47]
    v_fma_f32 v32, v32, v17, -v52
    v_fma_f32 v33, v33, v17, -v52
    v_fma_f32 v34, v34, v17, -v52
    v_mfma_f32_16x16x32_bf16 v[40:43], v[108:111], v[172:175], v[40:43]
    v_fma_f32 v35, v35, v17, -v52
    v_fma_f32 v36, v36, v17, -v52
    v_fma_f32 v37, v37, v17, -v52
    v_mfma_f32_16x16x32_bf16 v[44:47], v[108:111], v[236:239], v[44:47]
    v_exp_f32 v32, v32
    v_exp_f32 v33, v33
    v_exp_f32 v34, v34
    v_mfma_f32_16x16x32_bf16 v[40:43], v[112:115], v[176:179], v[40:43]
    v_exp_f32 v35, v35
    v_exp_f32 v36, v36
    v_exp_f32 v37, v37
    v_mfma_f32_16x16x32_bf16 v[44:47], v[112:115], v[240:243], v[44:47]
    v_add_f32 v52, v32, v33
    v_add_f32 v53, v34, v35
    v_add_f32 v52, v52, v36
    v_mfma_f32_16x16x32_bf16 v[40:43], v[116:119], v[180:183], v[40:43]
    v_add_f32 v53, v53, v37
    v_add_f32 v52, v52, v53
    s_nop 1
    v_add_f32_dpp v52, v52, v52 row_ror:8 row_mask:0xf bank_mask:0xf
    v_mfma_f32_16x16x32_bf16 v[44:47], v[116:119], v[244:247], v[44:47]
    v_mov_b32 v53, v52
    s_nop 1
    v_permlane16_swap_b32 v52, v53
    v_add_f32 v52, v52, v53
    v_mfma_f32_16x16x32_bf16 v[40:43], v[120:123], v[184:187], v[40:43]
    v_mov_b32 v53, v52
    s_nop 1
    v_permlane32_swap_b32 v52, v53
    v_add_f32 v52, v52, v53
    v_mfma_f32_16x16x32_bf16 v[44:47], v[120:123], v[248:251], v[44:47]
    v_rcp_f32 v52, v52
    s_nop 0
    v_mul_f32 v32, v32, v52
    v_mul_f32 v33, v33, v52
    v_mfma_f32_16x16x32_bf16 v[40:43], v[124:127], v[188:191], v[40:43]
    v_mul_f32 v34, v34, v52
    v_mul_f32 v35, v35, v52
    v_mul_f32 v36, v36, v52
    v_mfma_f32_16x16x32_bf16 v[44:47], v[124:127], v[252:255], v[44:47]
    v_mul_f32 v37, v37, v52
    v_cvt_pk_bf16_f32 v16, v32, v33
    v_cvt_pk_bf16_f32 v17, v34, v35
    v_cvt_pk_bf16_f32 v20, v36, v37
    v_mov_b32_dpp v18, v16 row_ror:8 row_mask:0xf bank_mask:0xf
    v_mov_b32_dpp v19, v17 row_ror:8 row_mask:0xf bank_mask:0xf
    v_mov_b32_dpp v21, v20 row_ror:8 row_mask:0xf bank_mask:0xf
    ds_read_b128 v[64:67], v10 offset:0
    ds_read_b128 v[68:71], v10 offset:1024
    ds_read_b128 v[72:75], v10 offset:2048
    ds_read_b128 v[76:79], v10 offset:3072
    ds_read_b128 v[80:83], v10 offset:4096
    ds_read_b128 v[84:87], v10 offset:5120
    ds_read_b128 v[88:91], v10 offset:6144
    ds_read_b128 v[92:95], v10 offset:7168
    ds_read_b128 v[96:99], v10 offset:8192
    ds_read_b128 v[100:103], v10 offset:9216
    ds_read_b128 v[104:107], v10 offset:10240
    ds_read_b128 v[108:111], v10 offset:11264
    ds_read_b128 v[112:115], v10 offset:12288
    ds_read_b128 v[116:119], v10 offset:13312
    ds_read_b128 v[120:123], v10 offset:14336
    ds_read_b128 v[124:127], v10 offset:15360
    v_cvt_pk_bf16_f32 v56, v40, v41
    v_cvt_pk_bf16_f32 v57, v42, v43
    v_cvt_pk_bf16_f32 v60, v44, v45
    v_cvt_pk_bf16_f32 v61, v46, v47
    s_waitcnt vmcnt(3)
    v_mfma_f32_16x16x32_bf16 v[32:35], v[24:27], v[16:19], 0
    v_mfma_f32_16x16x32_bf16 v[36:39], v[28:31], v[16:19], 0
    v_mfma_f32_16x16x16_bf16 v[32:35], v[56:57], v[20:21], v[32:35]
    v_mfma_f32_16x16x16_bf16 v[36:39], v[60:61], v[20:21], v[36:39]
    buffer_store_dwordx2 v[56:57], v8, s[4:7], s25 offen sc1
    buffer_store_dwordx2 v[60:61], v8, s[4:7], s25 offen offset:256 sc1
    s_nop 4
    v_cvt_pk_bf16_f32 v40, v32, v33
    v_cvt_pk_bf16_f32 v41, v34, v35
    v_cvt_pk_bf16_f32 v42, v36, v37
    v_cvt_pk_bf16_f32 v43, v38, v39
    ds_write_b128 v15, v[40:43]
    s_waitcnt lgkmcnt(0)
    s_barrier
    ds_read_b128 v[44:47], v14 offset:0
    ds_read_b128 v[48:51], v14 offset:512
    ds_read_b128 v[52:55], v14 offset:1024
    ds_read_b128 v[56:59], v14 offset:1536
    s_waitcnt lgkmcnt(0)
    s_mov_b32 s26, s22
    v_mfma_f32_16x16x32_bf16 v[16:19], v[64:67], v[44:47], 0
    v_mfma_f32_16x16x32_bf16 v[16:19], v[68:71], v[48:51], v[16:19]
    v_mfma_f32_16x16x32_bf16 v[16:19], v[72:75], v[52:55], v[16:19]
    v_mfma_f32_16x16x32_bf16 v[16:19], v[76:79], v[56:59], v[16:19]
    ds_read_b128 v[64:67], v10 offset:16384
    ds_read_b128 v[68:71], v10 offset:17408
    ds_read_b128 v[72:75], v10 offset:18432
    ds_read_b128 v[76:79], v10 offset:19456
    v_mfma_f32_16x16x32_bf16 v[20:23], v[80:83], v[44:47], 0
    v_mfma_f32_16x16x32_bf16 v[20:23], v[84:87], v[48:51], v[20:23]
    v_mfma_f32_16x16x32_bf16 v[20:23], v[88:91], v[52:55], v[20:23]
    v_mfma_f32_16x16x32_bf16 v[20:23], v[92:95], v[56:59], v[20:23]
    ds_read_b128 v[80:83], v10 offset:20480
    ds_read_b128 v[84:87], v10 offset:21504
    ds_read_b128 v[88:91], v10 offset:22528
    ds_read_b128 v[92:95], v10 offset:23552
    buffer_store_dwordx4 v[16:19], v4, s[4:7], s26 offen sc1
    s_add_u32 s26, s26, 16384
    v_mfma_f32_16x16x32_bf16 v[24:27], v[96:99], v[44:47], 0
    v_mfma_f32_16x16x32_bf16 v[24:27], v[100:103], v[48:51], v[24:27]
    v_mfma_f32_16x16x32_bf16 v[24:27], v[104:107], v[52:55], v[24:27]
    v_mfma_f32_16x16x32_bf16 v[24:27], v[108:111], v[56:59], v[24:27]
    ds_read_b128 v[96:99], v10 offset:24576
    ds_read_b128 v[100:103], v10 offset:25600
    ds_read_b128 v[104:107], v10 offset:26624
    ds_read_b128 v[108:111], v10 offset:27648
    buffer_store_dwordx4 v[20:23], v4, s[4:7], s26 offen sc1
    s_add_u32 s26, s26, 16384
    v_mfma_f32_16x16x32_bf16 v[28:31], v[112:115], v[44:47], 0
    v_mfma_f32_16x16x32_bf16 v[28:31], v[116:119], v[48:51], v[28:31]
    v_mfma_f32_16x16x32_bf16 v[28:31], v[120:123], v[52:55], v[28:31]
    v_mfma_f32_16x16x32_bf16 v[28:31], v[124:127], v[56:59], v[28:31]
    ds_read_b128 v[112:115], v10 offset:28672
    ds_read_b128 v[116:119], v10 offset:29696
    ds_read_b128 v[120:123], v10 offset:30720
    ds_read_b128 v[124:127], v10 offset:31744
    buffer_store_dwordx4 v[24:27], v4, s[4:7], s26 offen sc1
    s_add_u32 s26, s26, 16384
    s_waitcnt lgkmcnt(12)
    v_mfma_f32_16x16x32_bf16 v[32:35], v[64:67], v[44:47], 0
    v_mfma_f32_16x16x32_bf16 v[32:35], v[68:71], v[48:51], v[32:35]
    v_mfma_f32_16x16x32_bf16 v[32:35], v[72:75], v[52:55], v[32:35]
    v_mfma_f32_16x16x32_bf16 v[32:35], v[76:79], v[56:59], v[32:35]
    buffer_store_dwordx4 v[28:31], v4, s[4:7], s26 offen sc1
    s_add_u32 s26, s26, 16384
    s_waitcnt lgkmcnt(8)
    v_mfma_f32_16x16x32_bf16 v[36:39], v[80:83], v[44:47], 0
    v_mfma_f32_16x16x32_bf16 v[36:39], v[84:87], v[48:51], v[36:39]
    v_mfma_f32_16x16x32_bf16 v[36:39], v[88:91], v[52:55], v[36:39]
    v_mfma_f32_16x16x32_bf16 v[36:39], v[92:95], v[56:59], v[36:39]
    s_nop 0
    buffer_store_dwordx4 v[32:35], v4, s[4:7], s26 offen sc1
    s_add_u32 s26, s26, 16384
    s_waitcnt lgkmcnt(4)
    v_mfma_f32_16x16x32_bf16 v[40:43], v[96:99], v[44:47], 0
    v_mfma_f32_16x16x32_bf16 v[40:43], v[100:103], v[48:51], v[40:43]
    v_mfma_f32_16x16x32_bf16 v[40:43], v[104:107], v[52:55], v[40:43]
    v_mfma_f32_16x16x32_bf16 v[40:43], v[108:111], v[56:59], v[40:43]
    buffer_store_dwordx4 v[36:39], v4, s[4:7], s26 offen sc1
    s_add_u32 s26, s26, 16384
    s_waitcnt lgkmcnt(0)
    v_mfma_f32_16x16x32_bf16 v[60:63], v[112:115], v[44:47], 0
    v_mfma_f32_16x16x32_bf16 v[60:63], v[116:119], v[48:51], v[60:63]
    v_mfma_f32_16x16x32_bf16 v[60:63], v[120:123], v[52:55], v[60:63]
    v_mfma_f32_16x16x32_bf16 v[60:63], v[124:127], v[56:59], v[60:63]
    s_nop 0
    buffer_store_dwordx4 v[40:43], v4, s[4:7], s26 offen sc1
    s_add_u32 s26, s26, 16384
    s_nop 4
    buffer_store_dwordx4 v[60:63], v4, s[4:7], s26 offen sc1
    s_add_u32 s26, s26, 16384
    s_add_u32 s24, s24, 2048
    s_add_u32 s25, s25, 2048
    s_add_u32 s26, s23, 4096
    s_add_u32 s27, s23, 8192
    s_add_u32 s28, s23, 12288
    s_mov_b32 s36, 0
mega_kernel_s_rpoll:
    buffer_load_dwordx4 v[64:67], v5, s[4:7], s23 offen sc1
    buffer_load_dwordx4 v[68:71], v5, s[4:7], s26 offen sc1
    buffer_load_dwordx4 v[72:75], v5, s[4:7], s27 offen sc1
    buffer_load_dwordx4 v[76:79], v5, s[4:7], s28 offen sc1
    s_waitcnt vmcnt(0)
    v_max3_u32 v80, v64, v65, v66
    v_max3_u32 v80, v80, v67, v68
    v_max3_u32 v80, v80, v69, v70
    v_max3_u32 v80, v80, v71, v72
    v_max3_u32 v80, v80, v73, v74
    v_max3_u32 v80, v80, v75, v76
    v_max3_u32 v80, v80, v77, v78
    v_max_u32 v80, v80, v79
    v_cmp_eq_u32 vcc, -1, v80
    s_nop 0
    s_cbranch_vccz mega_kernel_s_rok
    s_add_u32 s36, s36, 1
    s_cmp_le_u32 s36, 65536
    s_cbranch_scc1 mega_kernel_s_rpoll
mega_kernel_s_rok:
    v_add_f32 v80, v64, v68
    v_add_f32 v84, v72, v76
    v_add_f32 v81, v65, v69
    v_add_f32 v85, v73, v77
    v_add_f32 v82, v66, v70
    v_add_f32 v86, v74, v78
    v_add_f32 v83, v67, v71
    v_add_f32 v87, v75, v79
    v_add_f32 v80, v80, v84
    v_add_f32 v81, v81, v85
    v_add_f32 v82, v82, v86
    v_add_f32 v83, v83, v87
    v_add_f32_dpp v80, v80, v80 row_ror:8 row_mask:0xf bank_mask:0xf
    v_add_f32_dpp v81, v81, v81 row_ror:8 row_mask:0xf bank_mask:0xf
    v_add_f32_dpp v82, v82, v82 row_ror:8 row_mask:0xf bank_mask:0xf
    v_add_f32_dpp v83, v83, v83 row_ror:8 row_mask:0xf bank_mask:0xf
    v_permlane32_swap_b32 v80, v81
    s_nop 0
    v_permlane32_swap_b32 v82, v83
    v_add_f32 v80, v80, v81
    v_add_f32 v82, v82, v83
    s_nop 1
    v_permlane16_swap_b32 v80, v82
    v_add_f32 v80, v80, v82
    v_mov_b32 v81, v80
    s_nop 1
    v_permlane32_swap_b32 v80, v81
    v_cvt_pk_bf16_f32 v88, v80, v81
    buffer_store_dword v88, v6, s[4:7], s18 offen sc1
    s_mov_b32 s29, s23
    s_add_u32 s16, s16, 8192
    s_add_u32 s17, s17, 8192
    s_add_u32 s18, s18, 8192
    s_xor_b32 s22, s22, 0x80000
    s_xor_b32 s23, s23, 0x80000
    s_add_u32 s15, s15, 1
    s_cmp_lt_u32 s15, 64
    s_cbranch_scc1 mega_kernel_s_step
mega_kernel_recdone:
    v_mov_b32 v92, -1
    v_mov_b32 v93, -1
    v_mov_b32 v94, -1
    v_mov_b32 v95, -1
    buffer_store_dwordx4 v[92:95], v5, s[4:7], s29 offen sc1
    buffer_store_dwordx4 v[92:95], v5, s[4:7], s26 offen sc1
    buffer_store_dwordx4 v[92:95], v5, s[4:7], s27 offen sc1
    buffer_store_dwordx4 v[92:95], v5, s[4:7], s28 offen sc1
    s_waitcnt vmcnt(0)
    s_barrier
    s_cmp_lg_u32 s14, 0
    s_cbranch_scc1 mega_kernel_nopub
    v_mov_b32 v56, 64
    v_mov_b32 v57, 0
    buffer_store_dword v56, v57, s[4:7], s43 offen sc1
mega_kernel_nopub:
    s_add_u32 s89, s89, 1
    s_add_u32 s88, s88, 100663296
    s_cmp_lt_u32 s89, 2
    s_cbranch_scc1 mega_kernel_layer
    s_branch mega_kernel_end
mega_kernel_worker:
mega_kernel_next:
    v_mbcnt_lo_u32_b32 v0, -1, 0
    v_mbcnt_hi_u32_b32 v0, -1, v0
    s_lshl_b32 s81, s14, 6
    v_add_u32 v0, s81, v0
    s_barrier
    s_cmp_lg_u32 s14, 0
    s_cbranch_scc1 mega_kernel_tw
    s_mov_b64 exec, 1
    v_mov_b32 v2, 40
    v_mov_b32 v3, 1
    buffer_atomic_add v3, v2, s[8:11], 0 offen sc0
    s_waitcnt vmcnt(0)
    v_mov_b32 v2, 163584
    ds_write_b32 v2, v3
    s_waitcnt lgkmcnt(0)
    s_mov_b64 exec, -1
mega_kernel_tw:
    s_barrier
    v_mov_b32 v2, 163584
    ds_read_b32 v3, v2
    s_waitcnt lgkmcnt(0)
    v_readfirstlane_b32 s81, v3
    s_cmp_ge_u32 s81, 5376
    s_cbranch_scc1 mega_kernel_end
    s_cmp_ge_u32 s81, 2688
    s_cselect_b32 s89, 1, 0
    s_cselect_b32 s88, 100663296, 0
    s_cselect_b32 s82, 2688, 0
    s_sub_u32 s81, s81, s82
    s_lshl_b32 s80, s89, 12
    s_add_u32 s80, s80, 104988672
    s_cmp_ge_u32 s81, 512
    s_cbranch_scc1 mega_kernel_t23
    s_mov_b32 s40, s81
    s_lshr_b32 s41, s40, 5
    s_and_b32 s42, s40, 31
    v_and_b32 v1, 63, v0
    v_lshrrev_b32 v2, 6, v0
    s_nop 0
    v_readfirstlane_b32 s43, v2
    s_lshr_b32 s44, s43, 1
    s_and_b32 s45, s43, 1
    v_lshlrev_b32 v3, 4, v1
    s_lshl_b32 s46, s41, 17
    s_add_u32 s46, s46, 18874368
    s_add_u32 s46, s46, s88
    s_lshl_b32 s47, s42, 17
    s_add_u32 s47, s47, 4063232
    s_add_u32 s48, s47, 4063232
    s_mul_i32 s49, s43, 6
    s_add_u32 s50, s49, 0
    s_cmp_ge_u32 s50, 8
    s_cselect_b32 s51, s47, s46
    s_cmp_ge_u32 s50, 16
    s_cselect_b32 s51, s48, s51
    s_lshl_b32 s50, s50, 14
    s_add_u32 s51, s51, s50
    v_add_u32 v4, s51, v3
    s_add_u32 s50, s49, 1
    s_cmp_ge_u32 s50, 8
    s_cselect_b32 s51, s47, s46
    s_cmp_ge_u32 s50, 16
    s_cselect_b32 s51, s48, s51
    s_lshl_b32 s50, s50, 14
    s_add_u32 s51, s51, s50
    v_add_u32 v5, s51, v3
    s_add_u32 s50, s49, 2
    s_cmp_ge_u32 s50, 8
    s_cselect_b32 s51, s47, s46
    s_cmp_ge_u32 s50, 16
    s_cselect_b32 s51, s48, s51
    s_lshl_b32 s50, s50, 14
    s_add_u32 s51, s51, s50
    v_add_u32 v6, s51, v3
    s_add_u32 s50, s49, 3
    s_cmp_ge_u32 s50, 8
    s_cselect_b32 s51, s47, s46
    s_cmp_ge_u32 s50, 16
    s_cselect_b32 s51, s48, s51
    s_lshl_b32 s50, s50, 14
    s_add_u32 s51, s51, s50
    v_add_u32 v7, s51, v3
    s_add_u32 s50, s49, 4
    s_cmp_ge_u32 s50, 8
    s_cselect_b32 s51, s47, s46
    s_cmp_ge_u32 s50, 16
    s_cselect_b32 s51, s48, s51
    s_lshl_b32 s50, s50, 14
    s_add_u32 s51, s51, s50
    v_add_u32 v8, s51, v3
    s_add_u32 s50, s49, 5
    s_cmp_ge_u32 s50, 8
    s_cselect_b32 s51, s47, s46
    s_cmp_ge_u32 s50, 16
    s_cselect_b32 s51, s48, s51
    s_lshl_b32 s50, s50, 14
    s_add_u32 s51, s51, s50
    v_add_u32 v9, s51, v3
    s_mul_i32 s49, s43, 6144
    s_lshl_b32 s50, s44, 12
    v_add_u32 v10, s50, v3
    s_lshl_b32 s50, s45, 12
    s_add_u32 s50, s50, 8192
    v_add_u32 v11, s50, v3
    v_add_u32 v12, 49152, v10
    v_add_u32 v13, 49152, v11
    v_mov_b32 v128, 0
    v_mov_b32 v129, 0
    v_mov_b32 v130, 0
    v_mov_b32 v131, 0
    v_mov_b32 v132, 0
    v_mov_b32 v133, 0
    v_mov_b32 v134, 0
    v_mov_b32 v135, 0
    v_mov_b32 v136, 0
    v_mov_b32 v137, 0
    v_mov_b32 v138, 0
    v_mov_b32 v139, 0
    v_mov_b32 v140, 0
    v_mov_b32 v141, 0
    v_mov_b32 v142, 0
    v_mov_b32 v143, 0
    v_mov_b32 v144, 0
    v_mov_b32 v145, 0
    v_mov_b32 v146, 0
    v_mov_b32 v147, 0
    v_mov_b32 v148, 0
    v_mov_b32 v149, 0
    v_mov_b32 v150, 0
    v_mov_b32 v151, 0
    v_mov_b32 v152, 0
    v_mov_b32 v153, 0
    v_mov_b32 v154, 0
    v_mov_b32 v155, 0
    v_mov_b32 v156, 0
    v_mov_b32 v157, 0
    v_mov_b32 v158, 0
    v_mov_b32 v159, 0
    v_mov_b32 v160, 0
    v_mov_b32 v161, 0
    v_mov_b32 v162, 0
    v_mov_b32 v163, 0
    v_mov_b32 v164, 0
    v_mov_b32 v165, 0
    v_mov_b32 v166, 0
    v_mov_b32 v167, 0
    v_mov_b32 v168, 0
    v_mov_b32 v169, 0
    v_mov_b32 v170, 0
    v_mov_b32 v171, 0
    v_mov_b32 v172, 0
    v_mov_b32 v173, 0
    v_mov_b32 v174, 0
    v_mov_b32 v175, 0
    v_mov_b32 v176, 0
    v_mov_b32 v177, 0
    v_mov_b32 v178, 0
    v_mov_b32 v179, 0
    v_mov_b32 v180, 0
    v_mov_b32 v181, 0
    v_mov_b32 v182, 0
    v_mov_b32 v183, 0
    v_mov_b32 v184, 0
    v_mov_b32 v185, 0
    v_mov_b32 v186, 0
    v_mov_b32 v187, 0
    v_mov_b32 v188, 0
    v_mov_b32 v189, 0
    v_mov_b32 v190, 0
    v_mov_b32 v191, 0
    v_mov_b32 v192, 0
    v_mov_b32 v193, 0
    v_mov_b32 v194, 0
    v_mov_b32 v195, 0
    v_mov_b32 v196, 0
    v_mov_b32 v197, 0
    v_mov_b32 v198, 0
    v_mov_b32 v199, 0
    v_mov_b32 v200, 0
    v_mov_b32 v201, 0
    v_mov_b32 v202, 0
    v_mov_b32 v203, 0
    v_mov_b32 v204, 0
    v_mov_b32 v205, 0
    v_mov_b32 v206, 0
    v_mov_b32 v207, 0
    v_mov_b32 v208, 0
    v_mov_b32 v209, 0
    v_mov_b32 v210, 0
    v_mov_b32 v211, 0
    v_mov_b32 v212, 0
    v_mov_b32 v213, 0
    v_mov_b32 v214, 0
    v_mov_b32 v215, 0
    v_mov_b32 v216, 0
    v_mov_b32 v217, 0
    v_mov_b32 v218, 0
    v_mov_b32 v219, 0
    v_mov_b32 v220, 0
    v_mov_b32 v221, 0
    v_mov_b32 v222, 0
    v_mov_b32 v223, 0
    v_mov_b32 v224, 0
    v_mov_b32 v225, 0
    v_mov_b32 v226, 0
    v_mov_b32 v227, 0
    v_mov_b32 v228, 0
    v_mov_b32 v229, 0
    v_mov_b32 v230, 0
    v_mov_b32 v231, 0
    v_mov_b32 v232, 0
    v_mov_b32 v233, 0
    v_mov_b32 v234, 0
    v_mov_b32 v235, 0
    v_mov_b32 v236, 0
    v_mov_b32 v237, 0
    v_mov_b32 v238, 0
    v_mov_b32 v239, 0
    v_mov_b32 v240, 0
    v_mov_b32 v241, 0
    v_mov_b32 v242, 0
    v_mov_b32 v243, 0
    v_mov_b32 v244, 0
    v_mov_b32 v245, 0
    v_mov_b32 v246, 0
    v_mov_b32 v247, 0
    v_mov_b32 v248, 0
    v_mov_b32 v249, 0
    v_mov_b32 v250, 0
    v_mov_b32 v251, 0
    v_mov_b32 v252, 0
    v_mov_b32 v253, 0
    v_mov_b32 v254, 0
    v_mov_b32 v255, 0
    s_cmp_eq_u32 s89, 0
    s_cbranch_scc1 w1_4
    s_lshl_b32 s86, s41, 2
    s_add_u32 s86, s86, 1280
    s_mov_b32 s87, 104988672
    s_mov_b32 s85, 0
poll_5:
    v_mov_b32 v254, s86
    buffer_load_dword v254, v254, s[4:7], s87 offen sc1
    s_waitcnt vmcnt(0)
    v_readfirstlane_b32 s84, v254
    s_cmp_ge_u32 s84, 8
    s_cbranch_scc1 poll_5_ok
    s_sleep 8
    s_add_u32 s85, s85, 1
    s_cmp_le_u32 s85, 262144
    s_cbranch_scc1 poll_5
poll_5_ok:
w1_4:
    s_cmp_lt_u32 s41, 16
    s_cbranch_scc1 w1_4_b
    s_mov_b32 s85, 0
poll_6:
    v_mov_b32 v254, 0
    buffer_load_dword v254, v254, s[4:7], s80 offen sc1
    s_waitcnt vmcnt(0)
    v_readfirstlane_b32 s84, v254
    s_cmp_ge_u32 s84, 32
    s_cbranch_scc1 poll_6_ok
    s_sleep 8
    s_add_u32 s85, s85, 1
    s_cmp_le_u32 s85, 262144
    s_cbranch_scc1 poll_6
poll_6_ok:
w1_4_b:
    s_mov_b32 s98, 0
    s_add_u32 m0, s49, 0
    s_nop 0
    buffer_load_dwordx4 v4, s[4:7], s98 offen sc1 lds
    s_add_u32 m0, s49, 1024
    s_nop 0
    buffer_load_dwordx4 v5, s[4:7], s98 offen sc1 lds
    s_add_u32 m0, s49, 2048
    s_nop 0
    buffer_load_dwordx4 v6, s[4:7], s98 offen sc1 lds
    s_add_u32 m0, s49, 3072
    s_nop 0
    buffer_load_dwordx4 v7, s[4:7], s98 offen sc1 lds
    s_add_u32 m0, s49, 4096
    s_nop 0
    buffer_load_dwordx4 v8, s[4:7], s98 offen sc1 lds
    s_add_u32 m0, s49, 5120
    s_nop 0
    buffer_load_dwordx4 v9, s[4:7], s98 offen sc1 lds
    s_mov_b32 s98, 1024
    s_add_u32 m0, s49, 24576
    s_nop 0
    buffer_load_dwordx4 v4, s[4:7], s98 offen sc1 lds
    s_add_u32 m0, s49, 25600
    s_nop 0
    buffer_load_dwordx4 v5, s[4:7], s98 offen sc1 lds
    s_add_u32 m0, s49, 26624
    s_nop 0
    buffer_load_dwordx4 v6, s[4:7], s98 offen sc1 lds
    s_add_u32 m0, s49, 27648
    s_nop 0
    buffer_load_dwordx4 v7, s[4:7], s98 offen sc1 lds
    s_add_u32 m0, s49, 28672
    s_nop 0
    buffer_load_dwordx4 v8, s[4:7], s98 offen sc1 lds
    s_add_u32 m0, s49, 29696
    s_nop 0
    buffer_load_dwordx4 v9, s[4:7], s98 offen sc1 lds
    s_mov_b32 s98, 2048
    s_add_u32 m0, s49, 49152
    s_nop 0
    buffer_load_dwordx4 v4, s[4:7], s98 offen sc1 lds
    s_add_u32 m0, s49, 50176
    s_nop 0
    buffer_load_dwordx4 v5, s[4:7], s98 offen sc1 lds
    s_add_u32 m0, s49, 51200
    s_nop 0
    buffer_load_dwordx4 v6, s[4:7], s98 offen sc1 lds
    s_add_u32 m0, s49, 52224
    s_nop 0
    buffer_load_dwordx4 v7, s[4:7], s98 offen sc1 lds
    s_add_u32 m0, s49, 53248
    s_nop 0
    buffer_load_dwordx4 v8, s[4:7], s98 offen sc1 lds
    s_add_u32 m0, s49, 54272
    s_nop 0
    buffer_load_dwordx4 v9, s[4:7], s98 offen sc1 lds
    s_waitcnt vmcnt(12) lgkmcnt(0)
    s_barrier
    s_mov_b32 s98, 3072
    s_add_u32 m0, s49, 73728
    s_nop 0
    buffer_load_dwordx4 v4, s[4:7], s98 offen sc1 lds
    s_add_u32 m0, s49, 74752
    s_nop 0
    buffer_load_dwordx4 v5, s[4:7], s98 offen sc1 lds
    s_add_u32 m0, s49, 75776
    s_nop 0
    buffer_load_dwordx4 v6, s[4:7], s98 offen sc1 lds
    s_add_u32 m0, s49, 76800
    s_nop 0
    buffer_load_dwordx4 v7, s[4:7], s98 offen sc1 lds
    s_add_u32 m0, s49, 77824
    s_nop 0
    buffer_load_dwordx4 v8, s[4:7], s98 offen sc1 lds
    s_add_u32 m0, s49, 78848
    s_nop 0
    buffer_load_dwordx4 v9, s[4:7], s98 offen sc1 lds
    ds_read_b128 v[16:19], v10 offset:0
    ds_read_b128 v[20:23], v10 offset:1024
    ds_read_b128 v[24:27], v10 offset:2048
    ds_read_b128 v[28:31], v10 offset:3072
    ds_read_b128 v[32:35], v11 offset:0
    ds_read_b128 v[36:39], v11 offset:1024
    ds_read_b128 v[40:43], v11 offset:2048
    ds_read_b128 v[44:47], v11 offset:3072
    ds_read_b128 v[48:51], v11 offset:8192
    ds_read_b128 v[52:55], v11 offset:9216
    ds_read_b128 v[56:59], v11 offset:10240
    ds_read_b128 v[60:63], v11 offset:11264
    s_waitcnt vmcnt(12) lgkmcnt(0)
    s_barrier
    s_mov_b32 s98, 4096
    s_add_u32 m0, s49, 0
    s_nop 0
    buffer_load_dwordx4 v4, s[4:7], s98 offen sc1 lds
    s_add_u32 m0, s49, 1024
    s_nop 0
    buffer_load_dwordx4 v5, s[4:7], s98 offen sc1 lds
    s_add_u32 m0, s49, 2048
    s_nop 0
    buffer_load_dwordx4 v6, s[4:7], s98 offen sc1 lds
    s_add_u32 m0, s49, 3072
    s_nop 0
    buffer_load_dwordx4 v7, s[4:7], s98 offen sc1 lds
    s_add_u32 m0, s49, 4096
    s_nop 0
    buffer_load_dwordx4 v8, s[4:7], s98 offen sc1 lds
    s_add_u32 m0, s49, 5120
    s_nop 0
    buffer_load_dwordx4 v9, s[4:7], s98 offen sc1 lds
    ds_read_b128 v[64:67], v10 offset:24576
    ds_read_b128 v[68:71], v10 offset:25600
    ds_read_b128 v[72:75], v10 offset:26624
    ds_read_b128 v[76:79], v10 offset:27648
    ds_read_b128 v[80:83], v11 offset:24576
    ds_read_b128 v[84:87], v11 offset:25600
    ds_read_b128 v[88:91], v11 offset:26624
    ds_read_b128 v[92:95], v11 offset:27648
    ds_read_b128 v[96:99], v11 offset:32768
    ds_read_b128 v[100:103], v11 offset:33792
    ds_read_b128 v[104:107], v11 offset:34816
    ds_read_b128 v[108:111], v11 offset:35840
    v_mfma_f32_16x16x32_bf16 v[128:131], v[32:35], v[16:19], v[128:131]
    v_mfma_f32_16x16x32_bf16 v[132:135], v[32:35], v[20:23], v[132:135]
    v_mfma_f32_16x16x32_bf16 v[136:139], v[32:35], v[24:27], v[136:139]
    v_mfma_f32_16x16x32_bf16 v[140:143], v[32:35], v[28:31], v[140:143]
    v_mfma_f32_16x16x32_bf16 v[144:147], v[36:39], v[16:19], v[144:147]
    v_mfma_f32_16x16x32_bf16 v[148:151], v[36:39], v[20:23], v[148:151]
    v_mfma_f32_16x16x32_bf16 v[152:155], v[36:39], v[24:27], v[152:155]
    v_mfma_f32_16x16x32_bf16 v[156:159], v[36:39], v[28:31], v[156:159]
    v_mfma_f32_16x16x32_bf16 v[160:163], v[40:43], v[16:19], v[160:163]
    v_mfma_f32_16x16x32_bf16 v[164:167], v[40:43], v[20:23], v[164:167]
    v_mfma_f32_16x16x32_bf16 v[168:171], v[40:43], v[24:27], v[168:171]
    v_mfma_f32_16x16x32_bf16 v[172:175], v[40:43], v[28:31], v[172:175]
    v_mfma_f32_16x16x32_bf16 v[176:179], v[44:47], v[16:19], v[176:179]
    v_mfma_f32_16x16x32_bf16 v[180:183], v[44:47], v[20:23], v[180:183]
    v_mfma_f32_16x16x32_bf16 v[184:187], v[44:47], v[24:27], v[184:187]
    v_mfma_f32_16x16x32_bf16 v[188:191], v[44:47], v[28:31], v[188:191]
    v_mfma_f32_16x16x32_bf16 v[192:195], v[16:19], v[48:51], v[192:195]
    v_mfma_f32_16x16x32_bf16 v[196:199], v[16:19], v[52:55], v[196:199]
    v_mfma_f32_16x16x32_bf16 v[200:203], v[16:19], v[56:59], v[200:203]
    v_mfma_f32_16x16x32_bf16 v[204:207], v[16:19], v[60:63], v[204:207]
    v_mfma_f32_16x16x32_bf16 v[208:211], v[20:23], v[48:51], v[208:211]
    v_mfma_f32_16x16x32_bf16 v[212:215], v[20:23], v[52:55], v[212:215]
    v_mfma_f32_16x16x32_bf16 v[216:219], v[20:23], v[56:59], v[216:219]
    v_mfma_f32_16x16x32_bf16 v[220:223], v[20:23], v[60:63], v[220:223]
    v_mfma_f32_16x16x32_bf16 v[224:227], v[24:27], v[48:51], v[224:227]
    v_mfma_f32_16x16x32_bf16 v[228:231], v[24:27], v[52:55], v[228:231]
    v_mfma_f32_16x16x32_bf16 v[232:235], v[24:27], v[56:59], v[232:235]
    v_mfma_f32_16x16x32_bf16 v[236:239], v[24:27], v[60:63], v[236:239]
    v_mfma_f32_16x16x32_bf16 v[240:243], v[28:31], v[48:51], v[240:243]
    v_mfma_f32_16x16x32_bf16 v[244:247], v[28:31], v[52:55], v[244:247]
    v_mfma_f32_16x16x32_bf16 v[248:251], v[28:31], v[56:59], v[248:251]
    v_mfma_f32_16x16x32_bf16 v[252:255], v[28:31], v[60:63], v[252:255]
    s_waitcnt vmcnt(12) lgkmcnt(0)
    s_barrier
    s_mov_b32 s98, 5120
    s_add_u32 m0, s49, 24576
    s_nop 0
    buffer_load_dwordx4 v4, s[4:7], s98 offen sc1 lds
    s_add_u32 m0, s49, 25600
    s_nop 0
    buffer_load_dwordx4 v5, s[4:7], s98 offen sc1 lds
    s_add_u32 m0, s49, 26624
    s_nop 0
    buffer_load_dwordx4 v6, s[4:7], s98 offen sc1 lds
    s_add_u32 m0, s49, 27648
    s_nop 0
    buffer_load_dwordx4 v7, s[4:7], s98 offen sc1 lds
    s_add_u32 m0, s49, 28672
    s_nop 0
    buffer_load_dwordx4 v8, s[4:7], s98 offen sc1 lds
    s_add_u32 m0, s49, 29696
    s_nop 0
    buffer_load_dwordx4 v9, s[4:7], s98 offen sc1 lds
    ds_read_b128 v[16:19], v12 offset:0
    ds_read_b128 v[20:23], v12 offset:1024
    ds_read_b128 v[24:27], v12 offset:2048
    ds_read_b128 v[28:31], v12 offset:3072
    ds_read_b128 v[32:35], v13 offset:0
    ds_read_b128 v[36:39], v13 offset:1024
    ds_read_b128 v[40:43], v13 offset:2048
    ds_read_b128 v[44:47], v13 offset:3072
    ds_read_b128 v[48:51], v13 offset:8192
    ds_read_b128 v[52:55], v13 offset:9216
    ds_read_b128 v[56:59], v13 offset:10240
    ds_read_b128 v[60:63], v13 offset:11264
    v_mfma_f32_16x16x32_bf16 v[128:131], v[80:83], v[64:67], v[128:131]
    v_mfma_f32_16x16x32_bf16 v[132:135], v[80:83], v[68:71], v[132:135]
    v_mfma_f32_16x16x32_bf16 v[136:139], v[80:83], v[72:75], v[136:139]
    v_mfma_f32_16x16x32_bf16 v[140:143], v[80:83], v[76:79], v[140:143]
    v_mfma_f32_16x16x32_bf16 v[144:147], v[84:87], v[64:67], v[144:147]
    v_mfma_f32_16x16x32_bf16 v[148:151], v[84:87], v[68:71], v[148:151]
    v_mfma_f32_16x16x32_bf16 v[152:155], v[84:87], v[72:75], v[152:155]
    v_mfma_f32_16x16x32_bf16 v[156:159], v[84:87], v[76:79], v[156:159]
    v_mfma_f32_16x16x32_bf16 v[160:163], v[88:91], v[64:67], v[160:163]
    v_mfma_f32_16x16x32_bf16 v[164:167], v[88:91], v[68:71], v[164:167]
    v_mfma_f32_16x16x32_bf16 v[168:171], v[88:91], v[72:75], v[168:171]
    v_mfma_f32_16x16x32_bf16 v[172:175], v[88:91], v[76:79], v[172:175]
    v_mfma_f32_16x16x32_bf16 v[176:179], v[92:95], v[64:67], v[176:179]
    v_mfma_f32_16x16x32_bf16 v[180:183], v[92:95], v[68:71], v[180:183]
    v_mfma_f32_16x16x32_bf16 v[184:187], v[92:95], v[72:75], v[184:187]
    v_mfma_f32_16x16x32_bf16 v[188:191], v[92:95], v[76:79], v[188:191]
    v_mfma_f32_16x16x32_bf16 v[192:195], v[64:67], v[96:99], v[192:195]
    v_mfma_f32_16x16x32_bf16 v[196:199], v[64:67], v[100:103], v[196:199]
    v_mfma_f32_16x16x32_bf16 v[200:203], v[64:67], v[104:107], v[200:203]
    v_mfma_f32_16x16x32_bf16 v[204:207], v[64:67], v[108:111], v[204:207]
    v_mfma_f32_16x16x32_bf16 v[208:211], v[68:71], v[96:99], v[208:211]
    v_mfma_f32_16x16x32_bf16 v[212:215], v[68:71], v[100:103], v[212:215]
    v_mfma_f32_16x16x32_bf16 v[216:219], v[68:71], v[104:107], v[216:219]
    v_mfma_f32_16x16x32_bf16 v[220:223], v[68:71], v[108:111], v[220:223]
    v_mfma_f32_16x16x32_bf16 v[224:227], v[72:75], v[96:99], v[224:227]
    v_mfma_f32_16x16x32_bf16 v[228:231], v[72:75], v[100:103], v[228:231]
    v_mfma_f32_16x16x32_bf16 v[232:235], v[72:75], v[104:107], v[232:235]
    v_mfma_f32_16x16x32_bf16 v[236:239], v[72:75], v[108:111], v[236:239]
    v_mfma_f32_16x16x32_bf16 v[240:243], v[76:79], v[96:99], v[240:243]
    v_mfma_f32_16x16x32_bf16 v[244:247], v[76:79], v[100:103], v[244:247]
    v_mfma_f32_16x16x32_bf16 v[248:251], v[76:79], v[104:107], v[248:251]
    v_mfma_f32_16x16x32_bf16 v[252:255], v[76:79], v[108:111], v[252:255]
    s_waitcnt vmcnt(12) lgkmcnt(0)
    s_barrier
    s_mov_b32 s98, 6144
    s_add_u32 m0, s49, 49152
    s_nop 0
    buffer_load_dwordx4 v4, s[4:7], s98 offen sc1 lds
    s_add_u32 m0, s49, 50176
    s_nop 0
    buffer_load_dwordx4 v5, s[4:7], s98 offen sc1 lds
    s_add_u32 m0, s49, 51200
    s_nop 0
    buffer_load_dwordx4 v6, s[4:7], s98 offen sc1 lds
    s_add_u32 m0, s49, 52224
    s_nop 0
    buffer_load_dwordx4 v7, s[4:7], s98 offen sc1 lds
    s_add_u32 m0, s49, 53248
    s_nop 0
    buffer_load_dwordx4 v8, s[4:7], s98 offen sc1 lds
    s_add_u32 m0, s49, 54272
    s_nop 0
    buffer_load_dwordx4 v9, s[4:7], s98 offen sc1 lds
    ds_read_b128 v[64:67], v12 offset:24576
    ds_read_b128 v[68:71], v12 offset:25600
    ds_read_b128 v[72:75], v12 offset:26624
    ds_read_b128 v[76:79], v12 offset:27648
    ds_read_b128 v[80:83], v13 offset:24576
    ds_read_b128 v[84:87], v13 offset:25600
    ds_read_b128 v[88:91], v13 offset:26624
    ds_read_b128 v[92:95], v13 offset:27648
    ds_read_b128 v[96:99], v13 offset:32768
    ds_read_b128 v[100:103], v13 offset:33792
    ds_read_b128 v[104:107], v13 offset:34816
    ds_read_b128 v[108:111], v13 offset:35840
    v_mfma_f32_16x16x32_bf16 v[128:131], v[32:35], v[16:19], v[128:131]
    v_mfma_f32_16x16x32_bf16 v[132:135], v[32:35], v[20:23], v[132:135]
    v_mfma_f32_16x16x32_bf16 v[136:139], v[32:35], v[24:27], v[136:139]
    v_mfma_f32_16x16x32_bf16 v[140:143], v[32:35], v[28:31], v[140:143]
    v_mfma_f32_16x16x32_bf16 v[144:147], v[36:39], v[16:19], v[144:147]
    v_mfma_f32_16x16x32_bf16 v[148:151], v[36:39], v[20:23], v[148:151]
    v_mfma_f32_16x16x32_bf16 v[152:155], v[36:39], v[24:27], v[152:155]
    v_mfma_f32_16x16x32_bf16 v[156:159], v[36:39], v[28:31], v[156:159]
    v_mfma_f32_16x16x32_bf16 v[160:163], v[40:43], v[16:19], v[160:163]
    v_mfma_f32_16x16x32_bf16 v[164:167], v[40:43], v[20:23], v[164:167]
    v_mfma_f32_16x16x32_bf16 v[168:171], v[40:43], v[24:27], v[168:171]
    v_mfma_f32_16x16x32_bf16 v[172:175], v[40:43], v[28:31], v[172:175]
    v_mfma_f32_16x16x32_bf16 v[176:179], v[44:47], v[16:19], v[176:179]
    v_mfma_f32_16x16x32_bf16 v[180:183], v[44:47], v[20:23], v[180:183]
    v_mfma_f32_16x16x32_bf16 v[184:187], v[44:47], v[24:27], v[184:187]
    v_mfma_f32_16x16x32_bf16 v[188:191], v[44:47], v[28:31], v[188:191]
    v_mfma_f32_16x16x32_bf16 v[192:195], v[16:19], v[48:51], v[192:195]
    v_mfma_f32_16x16x32_bf16 v[196:199], v[16:19], v[52:55], v[196:199]
    v_mfma_f32_16x16x32_bf16 v[200:203], v[16:19], v[56:59], v[200:203]
    v_mfma_f32_16x16x32_bf16 v[204:207], v[16:19], v[60:63], v[204:207]
    v_mfma_f32_16x16x32_bf16 v[208:211], v[20:23], v[48:51], v[208:211]
    v_mfma_f32_16x16x32_bf16 v[212:215], v[20:23], v[52:55], v[212:215]
    v_mfma_f32_16x16x32_bf16 v[216:219], v[20:23], v[56:59], v[216:219]
    v_mfma_f32_16x16x32_bf16 v[220:223], v[20:23], v[60:63], v[220:223]
    v_mfma_f32_16x16x32_bf16 v[224:227], v[24:27], v[48:51], v[224:227]
    v_mfma_f32_16x16x32_bf16 v[228:231], v[24:27], v[52:55], v[228:231]
    v_mfma_f32_16x16x32_bf16 v[232:235], v[24:27], v[56:59], v[232:235]
    v_mfma_f32_16x16x32_bf16 v[236:239], v[24:27], v[60:63], v[236:239]
    v_mfma_f32_16x16x32_bf16 v[240:243], v[28:31], v[48:51], v[240:243]
    v_mfma_f32_16x16x32_bf16 v[244:247], v[28:31], v[52:55], v[244:247]
    v_mfma_f32_16x16x32_bf16 v[248:251], v[28:31], v[56:59], v[248:251]
    v_mfma_f32_16x16x32_bf16 v[252:255], v[28:31], v[60:63], v[252:255]
    s_waitcnt vmcnt(12) lgkmcnt(0)
    s_barrier
    s_mov_b32 s98, 7168
    s_add_u32 m0, s49, 73728
    s_nop 0
    buffer_load_dwordx4 v4, s[4:7], s98 offen sc1 lds
    s_add_u32 m0, s49, 74752
    s_nop 0
    buffer_load_dwordx4 v5, s[4:7], s98 offen sc1 lds
    s_add_u32 m0, s49, 75776
    s_nop 0
    buffer_load_dwordx4 v6, s[4:7], s98 offen sc1 lds
    s_add_u32 m0, s49, 76800
    s_nop 0
    buffer_load_dwordx4 v7, s[4:7], s98 offen sc1 lds
    s_add_u32 m0, s49, 77824
    s_nop 0
    buffer_load_dwordx4 v8, s[4:7], s98 offen sc1 lds
    s_add_u32 m0, s49, 78848
    s_nop 0
    buffer_load_dwordx4 v9, s[4:7], s98 offen sc1 lds
    ds_read_b128 v[16:19], v10 offset:0
    ds_read_b128 v[20:23], v10 offset:1024
    ds_read_b128 v[24:27], v10 offset:2048
    ds_read_b128 v[28:31], v10 offset:3072
    ds_read_b128 v[32:35], v11 offset:0
    ds_read_b128 v[36:39], v11 offset:1024
    ds_read_b128 v[40:43], v11 offset:2048
    ds_read_b128 v[44:47], v11 offset:3072
    ds_read_b128 v[48:51], v11 offset:8192
    ds_read_b128 v[52:55], v11 offset:9216
    ds_read_b128 v[56:59], v11 offset:10240
    ds_read_b128 v[60:63], v11 offset:11264
    v_mfma_f32_16x16x32_bf16 v[128:131], v[80:83], v[64:67], v[128:131]
    v_mfma_f32_16x16x32_bf16 v[132:135], v[80:83], v[68:71], v[132:135]
    v_mfma_f32_16x16x32_bf16 v[136:139], v[80:83], v[72:75], v[136:139]
    v_mfma_f32_16x16x32_bf16 v[140:143], v[80:83], v[76:79], v[140:143]
    v_mfma_f32_16x16x32_bf16 v[144:147], v[84:87], v[64:67], v[144:147]
    v_mfma_f32_16x16x32_bf16 v[148:151], v[84:87], v[68:71], v[148:151]
    v_mfma_f32_16x16x32_bf16 v[152:155], v[84:87], v[72:75], v[152:155]
    v_mfma_f32_16x16x32_bf16 v[156:159], v[84:87], v[76:79], v[156:159]
    v_mfma_f32_16x16x32_bf16 v[160:163], v[88:91], v[64:67], v[160:163]
    v_mfma_f32_16x16x32_bf16 v[164:167], v[88:91], v[68:71], v[164:167]
    v_mfma_f32_16x16x32_bf16 v[168:171], v[88:91], v[72:75], v[168:171]
    v_mfma_f32_16x16x32_bf16 v[172:175], v[88:91], v[76:79], v[172:175]
    v_mfma_f32_16x16x32_bf16 v[176:179], v[92:95], v[64:67], v[176:179]
    v_mfma_f32_16x16x32_bf16 v[180:183], v[92:95], v[68:71], v[180:183]
    v_mfma_f32_16x16x32_bf16 v[184:187], v[92:95], v[72:75], v[184:187]
    v_mfma_f32_16x16x32_bf16 v[188:191], v[92:95], v[76:79], v[188:191]
    v_mfma_f32_16x16x32_bf16 v[192:195], v[64:67], v[96:99], v[192:195]
    v_mfma_f32_16x16x32_bf16 v[196:199], v[64:67], v[100:103], v[196:199]
    v_mfma_f32_16x16x32_bf16 v[200:203], v[64:67], v[104:107], v[200:203]
    v_mfma_f32_16x16x32_bf16 v[204:207], v[64:67], v[108:111], v[204:207]
    v_mfma_f32_16x16x32_bf16 v[208:211], v[68:71], v[96:99], v[208:211]
    v_mfma_f32_16x16x32_bf16 v[212:215], v[68:71], v[100:103], v[212:215]
    v_mfma_f32_16x16x32_bf16 v[216:219], v[68:71], v[104:107], v[216:219]
    v_mfma_f32_16x16x32_bf16 v[220:223], v[68:71], v[108:111], v[220:223]
    v_mfma_f32_16x16x32_bf16 v[224:227], v[72:75], v[96:99], v[224:227]
    v_mfma_f32_16x16x32_bf16 v[228:231], v[72:75], v[100:103], v[228:231]
    v_mfma_f32_16x16x32_bf16 v[232:235], v[72:75], v[104:107], v[232:235]
    v_mfma_f32_16x16x32_bf16 v[236:239], v[72:75], v[108:111], v[236:239]
    v_mfma_f32_16x16x32_bf16 v[240:243], v[76:79], v[96:99], v[240:243]
    v_mfma_f32_16x16x32_bf16 v[244:247], v[76:79], v[100:103], v[244:247]
    v_mfma_f32_16x16x32_bf16 v[248:251], v[76:79], v[104:107], v[248:251]
    v_mfma_f32_16x16x32_bf16 v[252:255], v[76:79], v[108:111], v[252:255]
    s_waitcnt vmcnt(12) lgkmcnt(0)
    s_barrier
    s_mov_b32 s98, 8192
    s_add_u32 m0, s49, 0
    s_nop 0
    buffer_load_dwordx4 v4, s[4:7], s98 offen sc1 lds
    s_add_u32 m0, s49, 1024
    s_nop 0
    buffer_load_dwordx4 v5, s[4:7], s98 offen sc1 lds
    s_add_u32 m0, s49, 2048
    s_nop 0
    buffer_load_dwordx4 v6, s[4:7], s98 offen sc1 lds
    s_add_u32 m0, s49, 3072
    s_nop 0
    buffer_load_dwordx4 v7, s[4:7], s98 offen sc1 lds
    s_add_u32 m0, s49, 4096
    s_nop 0
    buffer_load_dwordx4 v8, s[4:7], s98 offen sc1 lds
    s_add_u32 m0, s49, 5120
    s_nop 0
    buffer_load_dwordx4 v9, s[4:7], s98 offen sc1 lds
    ds_read_b128 v[64:67], v10 offset:24576
    ds_read_b128 v[68:71], v10 offset:25600
    ds_read_b128 v[72:75], v10 offset:26624
    ds_read_b128 v[76:79], v10 offset:27648
    ds_read_b128 v[80:83], v11 offset:24576
    ds_read_b128 v[84:87], v11 offset:25600
    ds_read_b128 v[88:91], v11 offset:26624
    ds_read_b128 v[92:95], v11 offset:27648
    ds_read_b128 v[96:99], v11 offset:32768
    ds_read_b128 v[100:103], v11 offset:33792
    ds_read_b128 v[104:107], v11 offset:34816
    ds_read_b128 v[108:111], v11 offset:35840
    v_mfma_f32_16x16x32_bf16 v[128:131], v[32:35], v[16:19], v[128:131]
    v_mfma_f32_16x16x32_bf16 v[132:135], v[32:35], v[20:23], v[132:135]
    v_mfma_f32_16x16x32_bf16 v[136:139], v[32:35], v[24:27], v[136:139]
    v_mfma_f32_16x16x32_bf16 v[140:143], v[32:35], v[28:31], v[140:143]
    v_mfma_f32_16x16x32_bf16 v[144:147], v[36:39], v[16:19], v[144:147]
    v_mfma_f32_16x16x32_bf16 v[148:151], v[36:39], v[20:23], v[148:151]
    v_mfma_f32_16x16x32_bf16 v[152:155], v[36:39], v[24:27], v[152:155]
    v_mfma_f32_16x16x32_bf16 v[156:159], v[36:39], v[28:31], v[156:159]
    v_mfma_f32_16x16x32_bf16 v[160:163], v[40:43], v[16:19], v[160:163]
    v_mfma_f32_16x16x32_bf16 v[164:167], v[40:43], v[20:23], v[164:167]
    v_mfma_f32_16x16x32_bf16 v[168:171], v[40:43], v[24:27], v[168:171]
    v_mfma_f32_16x16x32_bf16 v[172:175], v[40:43], v[28:31], v[172:175]
    v_mfma_f32_16x16x32_bf16 v[176:179], v[44:47], v[16:19], v[176:179]
    v_mfma_f32_16x16x32_bf16 v[180:183], v[44:47], v[20:23], v[180:183]
    v_mfma_f32_16x16x32_bf16 v[184:187], v[44:47], v[24:27], v[184:187]
    v_mfma_f32_16x16x32_bf16 v[188:191], v[44:47], v[28:31], v[188:191]
    v_mfma_f32_16x16x32_bf16 v[192:195], v[16:19], v[48:51], v[192:195]
    v_mfma_f32_16x16x32_bf16 v[196:199], v[16:19], v[52:55], v[196:199]
    v_mfma_f32_16x16x32_bf16 v[200:203], v[16:19], v[56:59], v[200:203]
    v_mfma_f32_16x16x32_bf16 v[204:207], v[16:19], v[60:63], v[204:207]
    v_mfma_f32_16x16x32_bf16 v[208:211], v[20:23], v[48:51], v[208:211]
    v_mfma_f32_16x16x32_bf16 v[212:215], v[20:23], v[52:55], v[212:215]
    v_mfma_f32_16x16x32_bf16 v[216:219], v[20:23], v[56:59], v[216:219]
    v_mfma_f32_16x16x32_bf16 v[220:223], v[20:23], v[60:63], v[220:223]
    v_mfma_f32_16x16x32_bf16 v[224:227], v[24:27], v[48:51], v[224:227]
    v_mfma_f32_16x16x32_bf16 v[228:231], v[24:27], v[52:55], v[228:231]
    v_mfma_f32_16x16x32_bf16 v[232:235], v[24:27], v[56:59], v[232:235]
    v_mfma_f32_16x16x32_bf16 v[236:239], v[24:27], v[60:63], v[236:239]
    v_mfma_f32_16x16x32_bf16 v[240:243], v[28:31], v[48:51], v[240:243]
    v_mfma_f32_16x16x32_bf16 v[244:247], v[28:31], v[52:55], v[244:247]
    v_mfma_f32_16x16x32_bf16 v[248:251], v[28:31], v[56:59], v[248:251]
    v_mfma_f32_16x16x32_bf16 v[252:255], v[28:31], v[60:63], v[252:255]
    s_waitcnt vmcnt(12) lgkmcnt(0)
    s_barrier
    s_mov_b32 s98, 9216
    s_add_u32 m0, s49, 24576
    s_nop 0
    buffer_load_dwordx4 v4, s[4:7], s98 offen sc1 lds
    s_add_u32 m0, s49, 25600
    s_nop 0
    buffer_load_dwordx4 v5, s[4:7], s98 offen sc1 lds
    s_add_u32 m0, s49, 26624
    s_nop 0
    buffer_load_dwordx4 v6, s[4:7], s98 offen sc1 lds
    s_add_u32 m0, s49, 27648
    s_nop 0
    buffer_load_dwordx4 v7, s[4:7], s98 offen sc1 lds
    s_add_u32 m0, s49, 28672
    s_nop 0
    buffer_load_dwordx4 v8, s[4:7], s98 offen sc1 lds
    s_add_u32 m0, s49, 29696
    s_nop 0
    buffer_load_dwordx4 v9, s[4:7], s98 offen sc1 lds
    ds_read_b128 v[16:19], v12 offset:0
    ds_read_b128 v[20:23], v12 offset:1024
    ds_read_b128 v[24:27], v12 offset:2048
    ds_read_b128 v[28:31], v12 offset:3072
    ds_read_b128 v[32:35], v13 offset:0
    ds_read_b128 v[36:39], v13 offset:1024
    ds_read_b128 v[40:43], v13 offset:2048
    ds_read_b128 v[44:47], v13 offset:3072
    ds_read_b128 v[48:51], v13 offset:8192
    ds_read_b128 v[52:55], v13 offset:9216
    ds_read_b128 v[56:59], v13 offset:10240
    ds_read_b128 v[60:63], v13 offset:11264
    v_mfma_f32_16x16x32_bf16 v[128:131], v[80:83], v[64:67], v[128:131]
    v_mfma_f32_16x16x32_bf16 v[132:135], v[80:83], v[68:71], v[132:135]
    v_mfma_f32_16x16x32_bf16 v[136:139], v[80:83], v[72:75], v[136:139]
    v_mfma_f32_16x16x32_bf16 v[140:143], v[80:83], v[76:79], v[140:143]
    v_mfma_f32_16x16x32_bf16 v[144:147], v[84:87], v[64:67], v[144:147]
    v_mfma_f32_16x16x32_bf16 v[148:151], v[84:87], v[68:71], v[148:151]
    v_mfma_f32_16x16x32_bf16 v[152:155], v[84:87], v[72:75], v[152:155]
    v_mfma_f32_16x16x32_bf16 v[156:159], v[84:87], v[76:79], v[156:159]
    v_mfma_f32_16x16x32_bf16 v[160:163], v[88:91], v[64:67], v[160:163]
    v_mfma_f32_16x16x32_bf16 v[164:167], v[88:91], v[68:71], v[164:167]
    v_mfma_f32_16x16x32_bf16 v[168:171], v[88:91], v[72:75], v[168:171]
    v_mfma_f32_16x16x32_bf16 v[172:175], v[88:91], v[76:79], v[172:175]
    v_mfma_f32_16x16x32_bf16 v[176:179], v[92:95], v[64:67], v[176:179]
    v_mfma_f32_16x16x32_bf16 v[180:183], v[92:95], v[68:71], v[180:183]
    v_mfma_f32_16x16x32_bf16 v[184:187], v[92:95], v[72:75], v[184:187]
    v_mfma_f32_16x16x32_bf16 v[188:191], v[92:95], v[76:79], v[188:191]
    v_mfma_f32_16x16x32_bf16 v[192:195], v[64:67], v[96:99], v[192:195]
    v_mfma_f32_16x16x32_bf16 v[196:199], v[64:67], v[100:103], v[196:199]
    v_mfma_f32_16x16x32_bf16 v[200:203], v[64:67], v[104:107], v[200:203]
    v_mfma_f32_16x16x32_bf16 v[204:207], v[64:67], v[108:111], v[204:207]
    v_mfma_f32_16x16x32_bf16 v[208:211], v[68:71], v[96:99], v[208:211]
    v_mfma_f32_16x16x32_bf16 v[212:215], v[68:71], v[100:103], v[212:215]
    v_mfma_f32_16x16x32_bf16 v[216:219], v[68:71], v[104:107], v[216:219]
    v_mfma_f32_16x16x32_bf16 v[220:223], v[68:71], v[108:111], v[220:223]
    v_mfma_f32_16x16x32_bf16 v[224:227], v[72:75], v[96:99], v[224:227]
    v_mfma_f32_16x16x32_bf16 v[228:231], v[72:75], v[100:103], v[228:231]
    v_mfma_f32_16x16x32_bf16 v[232:235], v[72:75], v[104:107], v[232:235]
    v_mfma_f32_16x16x32_bf16 v[236:239], v[72:75], v[108:111], v[236:239]
    v_mfma_f32_16x16x32_bf16 v[240:243], v[76:79], v[96:99], v[240:243]
    v_mfma_f32_16x16x32_bf16 v[244:247], v[76:79], v[100:103], v[244:247]
    v_mfma_f32_16x16x32_bf16 v[248:251], v[76:79], v[104:107], v[248:251]
    v_mfma_f32_16x16x32_bf16 v[252:255], v[76:79], v[108:111], v[252:255]
    s_waitcnt vmcnt(12) lgkmcnt(0)
    s_barrier
    s_mov_b32 s98, 10240
    s_add_u32 m0, s49, 49152
    s_nop 0
    buffer_load_dwordx4 v4, s[4:7], s98 offen sc1 lds
    s_add_u32 m0, s49, 50176
    s_nop 0
    buffer_load_dwordx4 v5, s[4:7], s98 offen sc1 lds
    s_add_u32 m0, s49, 51200
    s_nop 0
    buffer_load_dwordx4 v6, s[4:7], s98 offen sc1 lds
    s_add_u32 m0, s49, 52224
    s_nop 0
    buffer_load_dwordx4 v7, s[4:7], s98 offen sc1 lds
    s_add_u32 m0, s49, 53248
    s_nop 0
    buffer_load_dwordx4 v8, s[4:7], s98 offen sc1 lds
    s_add_u32 m0, s49, 54272
    s_nop 0
    buffer_load_dwordx4 v9, s[4:7], s98 offen sc1 lds
    ds_read_b128 v[64:67], v12 offset:24576
    ds_read_b128 v[68:71], v12 offset:25600
    ds_read_b128 v[72:75], v12 offset:26624
    ds_read_b128 v[76:79], v12 offset:27648
    ds_read_b128 v[80:83], v13 offset:24576
    ds_read_b128 v[84:87], v13 offset:25600
    ds_read_b128 v[88:91], v13 offset:26624
    ds_read_b128 v[92:95], v13 offset:27648
    ds_read_b128 v[96:99], v13 offset:32768
    ds_read_b128 v[100:103], v13 offset:33792
    ds_read_b128 v[104:107], v13 offset:34816
    ds_read_b128 v[108:111], v13 offset:35840
    v_mfma_f32_16x16x32_bf16 v[128:131], v[32:35], v[16:19], v[128:131]
    v_mfma_f32_16x16x32_bf16 v[132:135], v[32:35], v[20:23], v[132:135]
    v_mfma_f32_16x16x32_bf16 v[136:139], v[32:35], v[24:27], v[136:139]
    v_mfma_f32_16x16x32_bf16 v[140:143], v[32:35], v[28:31], v[140:143]
    v_mfma_f32_16x16x32_bf16 v[144:147], v[36:39], v[16:19], v[144:147]
    v_mfma_f32_16x16x32_bf16 v[148:151], v[36:39], v[20:23], v[148:151]
    v_mfma_f32_16x16x32_bf16 v[152:155], v[36:39], v[24:27], v[152:155]
    v_mfma_f32_16x16x32_bf16 v[156:159], v[36:39], v[28:31], v[156:159]
    v_mfma_f32_16x16x32_bf16 v[160:163], v[40:43], v[16:19], v[160:163]
    v_mfma_f32_16x16x32_bf16 v[164:167], v[40:43], v[20:23], v[164:167]
    v_mfma_f32_16x16x32_bf16 v[168:171], v[40:43], v[24:27], v[168:171]
    v_mfma_f32_16x16x32_bf16 v[172:175], v[40:43], v[28:31], v[172:175]
    v_mfma_f32_16x16x32_bf16 v[176:179], v[44:47], v[16:19], v[176:179]
    v_mfma_f32_16x16x32_bf16 v[180:183], v[44:47], v[20:23], v[180:183]
    v_mfma_f32_16x16x32_bf16 v[184:187], v[44:47], v[24:27], v[184:187]
    v_mfma_f32_16x16x32_bf16 v[188:191], v[44:47], v[28:31], v[188:191]
    v_mfma_f32_16x16x32_bf16 v[192:195], v[16:19], v[48:51], v[192:195]
    v_mfma_f32_16x16x32_bf16 v[196:199], v[16:19], v[52:55], v[196:199]
    v_mfma_f32_16x16x32_bf16 v[200:203], v[16:19], v[56:59], v[200:203]
    v_mfma_f32_16x16x32_bf16 v[204:207], v[16:19], v[60:63], v[204:207]
    v_mfma_f32_16x16x32_bf16 v[208:211], v[20:23], v[48:51], v[208:211]
    v_mfma_f32_16x16x32_bf16 v[212:215], v[20:23], v[52:55], v[212:215]
    v_mfma_f32_16x16x32_bf16 v[216:219], v[20:23], v[56:59], v[216:219]
    v_mfma_f32_16x16x32_bf16 v[220:223], v[20:23], v[60:63], v[220:223]
    v_mfma_f32_16x16x32_bf16 v[224:227], v[24:27], v[48:51], v[224:227]
    v_mfma_f32_16x16x32_bf16 v[228:231], v[24:27], v[52:55], v[228:231]
    v_mfma_f32_16x16x32_bf16 v[232:235], v[24:27], v[56:59], v[232:235]
    v_mfma_f32_16x16x32_bf16 v[236:239], v[24:27], v[60:63], v[236:239]
    v_mfma_f32_16x16x32_bf16 v[240:243], v[28:31], v[48:51], v[240:243]
    v_mfma_f32_16x16x32_bf16 v[244:247], v[28:31], v[52:55], v[244:247]
    v_mfma_f32_16x16x32_bf16 v[248:251], v[28:31], v[56:59], v[248:251]
    v_mfma_f32_16x16x32_bf16 v[252:255], v[28:31], v[60:63], v[252:255]
    s_waitcnt vmcnt(12) lgkmcnt(0)
    s_barrier
    s_mov_b32 s98, 11264
    s_add_u32 m0, s49, 73728
    s_nop 0
    buffer_load_dwordx4 v4, s[4:7], s98 offen sc1 lds
    s_add_u32 m0, s49, 74752
    s_nop 0
    buffer_load_dwordx4 v5, s[4:7], s98 offen sc1 lds
    s_add_u32 m0, s49, 75776
    s_nop 0
    buffer_load_dwordx4 v6, s[4:7], s98 offen sc1 lds
    s_add_u32 m0, s49, 76800
    s_nop 0
    buffer_load_dwordx4 v7, s[4:7], s98 offen sc1 lds
    s_add_u32 m0, s49, 77824
    s_nop 0
    buffer_load_dwordx4 v8, s[4:7], s98 offen sc1 lds
    s_add_u32 m0, s49, 78848
    s_nop 0
    buffer_load_dwordx4 v9, s[4:7], s98 offen sc1 lds
    ds_read_b128 v[16:19], v10 offset:0
    ds_read_b128 v[20:23], v10 offset:1024
    ds_read_b128 v[24:27], v10 offset:2048
    ds_read_b128 v[28:31], v10 offset:3072
    ds_read_b128 v[32:35], v11 offset:0
    ds_read_b128 v[36:39], v11 offset:1024
    ds_read_b128 v[40:43], v11 offset:2048
    ds_read_b128 v[44:47], v11 offset:3072
    ds_read_b128 v[48:51], v11 offset:8192
    ds_read_b128 v[52:55], v11 offset:9216
    ds_read_b128 v[56:59], v11 offset:10240
    ds_read_b128 v[60:63], v11 offset:11264
    v_mfma_f32_16x16x32_bf16 v[128:131], v[80:83], v[64:67], v[128:131]
    v_mfma_f32_16x16x32_bf16 v[132:135], v[80:83], v[68:71], v[132:135]
    v_mfma_f32_16x16x32_bf16 v[136:139], v[80:83], v[72:75], v[136:139]
    v_mfma_f32_16x16x32_bf16 v[140:143], v[80:83], v[76:79], v[140:143]
    v_mfma_f32_16x16x32_bf16 v[144:147], v[84:87], v[64:67], v[144:147]
    v_mfma_f32_16x16x32_bf16 v[148:151], v[84:87], v[68:71], v[148:151]
    v_mfma_f32_16x16x32_bf16 v[152:155], v[84:87], v[72:75], v[152:155]
    v_mfma_f32_16x16x32_bf16 v[156:159], v[84:87], v[76:79], v[156:159]
    v_mfma_f32_16x16x32_bf16 v[160:163], v[88:91], v[64:67], v[160:163]
    v_mfma_f32_16x16x32_bf16 v[164:167], v[88:91], v[68:71], v[164:167]
    v_mfma_f32_16x16x32_bf16 v[168:171], v[88:91], v[72:75], v[168:171]
    v_mfma_f32_16x16x32_bf16 v[172:175], v[88:91], v[76:79], v[172:175]
    v_mfma_f32_16x16x32_bf16 v[176:179], v[92:95], v[64:67], v[176:179]
    v_mfma_f32_16x16x32_bf16 v[180:183], v[92:95], v[68:71], v[180:183]
    v_mfma_f32_16x16x32_bf16 v[184:187], v[92:95], v[72:75], v[184:187]
    v_mfma_f32_16x16x32_bf16 v[188:191], v[92:95], v[76:79], v[188:191]
    v_mfma_f32_16x16x32_bf16 v[192:195], v[64:67], v[96:99], v[192:195]
    v_mfma_f32_16x16x32_bf16 v[196:199], v[64:67], v[100:103], v[196:199]
    v_mfma_f32_16x16x32_bf16 v[200:203], v[64:67], v[104:107], v[200:203]
    v_mfma_f32_16x16x32_bf16 v[204:207], v[64:67], v[108:111], v[204:207]
    v_mfma_f32_16x16x32_bf16 v[208:211], v[68:71], v[96:99], v[208:211]
    v_mfma_f32_16x16x32_bf16 v[212:215], v[68:71], v[100:103], v[212:215]
    v_mfma_f32_16x16x32_bf16 v[216:219], v[68:71], v[104:107], v[216:219]
    v_mfma_f32_16x16x32_bf16 v[220:223], v[68:71], v[108:111], v[220:223]
    v_mfma_f32_16x16x32_bf16 v[224:227], v[72:75], v[96:99], v[224:227]
    v_mfma_f32_16x16x32_bf16 v[228:231], v[72:75], v[100:103], v[228:231]
    v_mfma_f32_16x16x32_bf16 v[232:235], v[72:75], v[104:107], v[232:235]
    v_mfma_f32_16x16x32_bf16 v[236:239], v[72:75], v[108:111], v[236:239]
    v_mfma_f32_16x16x32_bf16 v[240:243], v[76:79], v[96:99], v[240:243]
    v_mfma_f32_16x16x32_bf16 v[244:247], v[76:79], v[100:103], v[244:247]
    v_mfma_f32_16x16x32_bf16 v[248:251], v[76:79], v[104:107], v[248:251]
    v_mfma_f32_16x16x32_bf16 v[252:255], v[76:79], v[108:111], v[252:255]
    s_waitcnt vmcnt(12) lgkmcnt(0)
    s_barrier
    s_mov_b32 s98, 12288
    s_add_u32 m0, s49, 0
    s_nop 0
    buffer_load_dwordx4 v4, s[4:7], s98 offen sc1 lds
    s_add_u32 m0, s49, 1024
    s_nop 0
    buffer_load_dwordx4 v5, s[4:7], s98 offen sc1 lds
    s_add_u32 m0, s49, 2048
    s_nop 0
    buffer_load_dwordx4 v6, s[4:7], s98 offen sc1 lds
    s_add_u32 m0, s49, 3072
    s_nop 0
    buffer_load_dwordx4 v7, s[4:7], s98 offen sc1 lds
    s_add_u32 m0, s49, 4096
    s_nop 0
    buffer_load_dwordx4 v8, s[4:7], s98 offen sc1 lds
    s_add_u32 m0, s49, 5120
    s_nop 0
    buffer_load_dwordx4 v9, s[4:7], s98 offen sc1 lds
    ds_read_b128 v[64:67], v10 offset:24576
    ds_read_b128 v[68:71], v10 offset:25600
    ds_read_b128 v[72:75], v10 offset:26624
    ds_read_b128 v[76:79], v10 offset:27648
    ds_read_b128 v[80:83], v11 offset:24576
    ds_read_b128 v[84:87], v11 offset:25600
    ds_read_b128 v[88:91], v11 offset:26624
    ds_read_b128 v[92:95], v11 offset:27648
    ds_read_b128 v[96:99], v11 offset:32768
    ds_read_b128 v[100:103], v11 offset:33792
    ds_read_b128 v[104:107], v11 offset:34816
    ds_read_b128 v[108:111], v11 offset:35840
    v_mfma_f32_16x16x32_bf16 v[128:131], v[32:35], v[16:19], v[128:131]
    v_mfma_f32_16x16x32_bf16 v[132:135], v[32:35], v[20:23], v[132:135]
    v_mfma_f32_16x16x32_bf16 v[136:139], v[32:35], v[24:27], v[136:139]
    v_mfma_f32_16x16x32_bf16 v[140:143], v[32:35], v[28:31], v[140:143]
    v_mfma_f32_16x16x32_bf16 v[144:147], v[36:39], v[16:19], v[144:147]
    v_mfma_f32_16x16x32_bf16 v[148:151], v[36:39], v[20:23], v[148:151]
    v_mfma_f32_16x16x32_bf16 v[152:155], v[36:39], v[24:27], v[152:155]
    v_mfma_f32_16x16x32_bf16 v[156:159], v[36:39], v[28:31], v[156:159]
    v_mfma_f32_16x16x32_bf16 v[160:163], v[40:43], v[16:19], v[160:163]
    v_mfma_f32_16x16x32_bf16 v[164:167], v[40:43], v[20:23], v[164:167]
    v_mfma_f32_16x16x32_bf16 v[168:171], v[40:43], v[24:27], v[168:171]
    v_mfma_f32_16x16x32_bf16 v[172:175], v[40:43], v[28:31], v[172:175]
    v_mfma_f32_16x16x32_bf16 v[176:179], v[44:47], v[16:19], v[176:179]
    v_mfma_f32_16x16x32_bf16 v[180:183], v[44:47], v[20:23], v[180:183]
    v_mfma_f32_16x16x32_bf16 v[184:187], v[44:47], v[24:27], v[184:187]
    v_mfma_f32_16x16x32_bf16 v[188:191], v[44:47], v[28:31], v[188:191]
    v_mfma_f32_16x16x32_bf16 v[192:195], v[16:19], v[48:51], v[192:195]
    v_mfma_f32_16x16x32_bf16 v[196:199], v[16:19], v[52:55], v[196:199]
    v_mfma_f32_16x16x32_bf16 v[200:203], v[16:19], v[56:59], v[200:203]
    v_mfma_f32_16x16x32_bf16 v[204:207], v[16:19], v[60:63], v[204:207]
    v_mfma_f32_16x16x32_bf16 v[208:211], v[20:23], v[48:51], v[208:211]
    v_mfma_f32_16x16x32_bf16 v[212:215], v[20:23], v[52:55], v[212:215]
    v_mfma_f32_16x16x32_bf16 v[216:219], v[20:23], v[56:59], v[216:219]
    v_mfma_f32_16x16x32_bf16 v[220:223], v[20:23], v[60:63], v[220:223]
    v_mfma_f32_16x16x32_bf16 v[224:227], v[24:27], v[48:51], v[224:227]
    v_mfma_f32_16x16x32_bf16 v[228:231], v[24:27], v[52:55], v[228:231]
    v_mfma_f32_16x16x32_bf16 v[232:235], v[24:27], v[56:59], v[232:235]
    v_mfma_f32_16x16x32_bf16 v[236:239], v[24:27], v[60:63], v[236:239]
    v_mfma_f32_16x16x32_bf16 v[240:243], v[28:31], v[48:51], v[240:243]
    v_mfma_f32_16x16x32_bf16 v[244:247], v[28:31], v[52:55], v[244:247]
    v_mfma_f32_16x16x32_bf16 v[248:251], v[28:31], v[56:59], v[248:251]
    v_mfma_f32_16x16x32_bf16 v[252:255], v[28:31], v[60:63], v[252:255]
    s_waitcnt vmcnt(12) lgkmcnt(0)
    s_barrier
    s_mov_b32 s98, 13312
    s_add_u32 m0, s49, 24576
    s_nop 0
    buffer_load_dwordx4 v4, s[4:7], s98 offen sc1 lds
    s_add_u32 m0, s49, 25600
    s_nop 0
    buffer_load_dwordx4 v5, s[4:7], s98 offen sc1 lds
    s_add_u32 m0, s49, 26624
    s_nop 0
    buffer_load_dwordx4 v6, s[4:7], s98 offen sc1 lds
    s_add_u32 m0, s49, 27648
    s_nop 0
    buffer_load_dwordx4 v7, s[4:7], s98 offen sc1 lds
    s_add_u32 m0, s49, 28672
    s_nop 0
    buffer_load_dwordx4 v8, s[4:7], s98 offen sc1 lds
    s_add_u32 m0, s49, 29696
    s_nop 0
    buffer_load_dwordx4 v9, s[4:7], s98 offen sc1 lds
    ds_read_b128 v[16:19], v12 offset:0
    ds_read_b128 v[20:23], v12 offset:1024
    ds_read_b128 v[24:27], v12 offset:2048
    ds_read_b128 v[28:31], v12 offset:3072
    ds_read_b128 v[32:35], v13 offset:0
    ds_read_b128 v[36:39], v13 offset:1024
    ds_read_b128 v[40:43], v13 offset:2048
    ds_read_b128 v[44:47], v13 offset:3072
    ds_read_b128 v[48:51], v13 offset:8192
    ds_read_b128 v[52:55], v13 offset:9216
    ds_read_b128 v[56:59], v13 offset:10240
    ds_read_b128 v[60:63], v13 offset:11264
    v_mfma_f32_16x16x32_bf16 v[128:131], v[80:83], v[64:67], v[128:131]
    v_mfma_f32_16x16x32_bf16 v[132:135], v[80:83], v[68:71], v[132:135]
    v_mfma_f32_16x16x32_bf16 v[136:139], v[80:83], v[72:75], v[136:139]
    v_mfma_f32_16x16x32_bf16 v[140:143], v[80:83], v[76:79], v[140:143]
    v_mfma_f32_16x16x32_bf16 v[144:147], v[84:87], v[64:67], v[144:147]
    v_mfma_f32_16x16x32_bf16 v[148:151], v[84:87], v[68:71], v[148:151]
    v_mfma_f32_16x16x32_bf16 v[152:155], v[84:87], v[72:75], v[152:155]
    v_mfma_f32_16x16x32_bf16 v[156:159], v[84:87], v[76:79], v[156:159]
    v_mfma_f32_16x16x32_bf16 v[160:163], v[88:91], v[64:67], v[160:163]
    v_mfma_f32_16x16x32_bf16 v[164:167], v[88:91], v[68:71], v[164:167]
    v_mfma_f32_16x16x32_bf16 v[168:171], v[88:91], v[72:75], v[168:171]
    v_mfma_f32_16x16x32_bf16 v[172:175], v[88:91], v[76:79], v[172:175]
    v_mfma_f32_16x16x32_bf16 v[176:179], v[92:95], v[64:67], v[176:179]
    v_mfma_f32_16x16x32_bf16 v[180:183], v[92:95], v[68:71], v[180:183]
    v_mfma_f32_16x16x32_bf16 v[184:187], v[92:95], v[72:75], v[184:187]
    v_mfma_f32_16x16x32_bf16 v[188:191], v[92:95], v[76:79], v[188:191]
    v_mfma_f32_16x16x32_bf16 v[192:195], v[64:67], v[96:99], v[192:195]
    v_mfma_f32_16x16x32_bf16 v[196:199], v[64:67], v[100:103], v[196:199]
    v_mfma_f32_16x16x32_bf16 v[200:203], v[64:67], v[104:107], v[200:203]
    v_mfma_f32_16x16x32_bf16 v[204:207], v[64:67], v[108:111], v[204:207]
    v_mfma_f32_16x16x32_bf16 v[208:211], v[68:71], v[96:99], v[208:211]
    v_mfma_f32_16x16x32_bf16 v[212:215], v[68:71], v[100:103], v[212:215]
    v_mfma_f32_16x16x32_bf16 v[216:219], v[68:71], v[104:107], v[216:219]
    v_mfma_f32_16x16x32_bf16 v[220:223], v[68:71], v[108:111], v[220:223]
    v_mfma_f32_16x16x32_bf16 v[224:227], v[72:75], v[96:99], v[224:227]
    v_mfma_f32_16x16x32_bf16 v[228:231], v[72:75], v[100:103], v[228:231]
    v_mfma_f32_16x16x32_bf16 v[232:235], v[72:75], v[104:107], v[232:235]
    v_mfma_f32_16x16x32_bf16 v[236:239], v[72:75], v[108:111], v[236:239]
    v_mfma_f32_16x16x32_bf16 v[240:243], v[76:79], v[96:99], v[240:243]
    v_mfma_f32_16x16x32_bf16 v[244:247], v[76:79], v[100:103], v[244:247]
    v_mfma_f32_16x16x32_bf16 v[248:251], v[76:79], v[104:107], v[248:251]
    v_mfma_f32_16x16x32_bf16 v[252:255], v[76:79], v[108:111], v[252:255]
    s_waitcnt vmcnt(12) lgkmcnt(0)
    s_barrier
    s_mov_b32 s98, 14336
    s_add_u32 m0, s49, 49152
    s_nop 0
    buffer_load_dwordx4 v4, s[4:7], s98 offen sc1 lds
    s_add_u32 m0, s49, 50176
    s_nop 0
    buffer_load_dwordx4 v5, s[4:7], s98 offen sc1 lds
    s_add_u32 m0, s49, 51200
    s_nop 0
    buffer_load_dwordx4 v6, s[4:7], s98 offen sc1 lds
    s_add_u32 m0, s49, 52224
    s_nop 0
    buffer_load_dwordx4 v7, s[4:7], s98 offen sc1 lds
    s_add_u32 m0, s49, 53248
    s_nop 0
    buffer_load_dwordx4 v8, s[4:7], s98 offen sc1 lds
    s_add_u32 m0, s49, 54272
    s_nop 0
    buffer_load_dwordx4 v9, s[4:7], s98 offen sc1 lds
    ds_read_b128 v[64:67], v12 offset:24576
    ds_read_b128 v[68:71], v12 offset:25600
    ds_read_b128 v[72:75], v12 offset:26624
    ds_read_b128 v[76:79], v12 offset:27648
    ds_read_b128 v[80:83], v13 offset:24576
    ds_read_b128 v[84:87], v13 offset:25600
    ds_read_b128 v[88:91], v13 offset:26624
    ds_read_b128 v[92:95], v13 offset:27648
    ds_read_b128 v[96:99], v13 offset:32768
    ds_read_b128 v[100:103], v13 offset:33792
    ds_read_b128 v[104:107], v13 offset:34816
    ds_read_b128 v[108:111], v13 offset:35840
    v_mfma_f32_16x16x32_bf16 v[128:131], v[32:35], v[16:19], v[128:131]
    v_mfma_f32_16x16x32_bf16 v[132:135], v[32:35], v[20:23], v[132:135]
    v_mfma_f32_16x16x32_bf16 v[136:139], v[32:35], v[24:27], v[136:139]
    v_mfma_f32_16x16x32_bf16 v[140:143], v[32:35], v[28:31], v[140:143]
    v_mfma_f32_16x16x32_bf16 v[144:147], v[36:39], v[16:19], v[144:147]
    v_mfma_f32_16x16x32_bf16 v[148:151], v[36:39], v[20:23], v[148:151]
    v_mfma_f32_16x16x32_bf16 v[152:155], v[36:39], v[24:27], v[152:155]
    v_mfma_f32_16x16x32_bf16 v[156:159], v[36:39], v[28:31], v[156:159]
    v_mfma_f32_16x16x32_bf16 v[160:163], v[40:43], v[16:19], v[160:163]
    v_mfma_f32_16x16x32_bf16 v[164:167], v[40:43], v[20:23], v[164:167]
    v_mfma_f32_16x16x32_bf16 v[168:171], v[40:43], v[24:27], v[168:171]
    v_mfma_f32_16x16x32_bf16 v[172:175], v[40:43], v[28:31], v[172:175]
    v_mfma_f32_16x16x32_bf16 v[176:179], v[44:47], v[16:19], v[176:179]
    v_mfma_f32_16x16x32_bf16 v[180:183], v[44:47], v[20:23], v[180:183]
    v_mfma_f32_16x16x32_bf16 v[184:187], v[44:47], v[24:27], v[184:187]
    v_mfma_f32_16x16x32_bf16 v[188:191], v[44:47], v[28:31], v[188:191]
    v_mfma_f32_16x16x32_bf16 v[192:195], v[16:19], v[48:51], v[192:195]
    v_mfma_f32_16x16x32_bf16 v[196:199], v[16:19], v[52:55], v[196:199]
    v_mfma_f32_16x16x32_bf16 v[200:203], v[16:19], v[56:59], v[200:203]
    v_mfma_f32_16x16x32_bf16 v[204:207], v[16:19], v[60:63], v[204:207]
    v_mfma_f32_16x16x32_bf16 v[208:211], v[20:23], v[48:51], v[208:211]
    v_mfma_f32_16x16x32_bf16 v[212:215], v[20:23], v[52:55], v[212:215]
    v_mfma_f32_16x16x32_bf16 v[216:219], v[20:23], v[56:59], v[216:219]
    v_mfma_f32_16x16x32_bf16 v[220:223], v[20:23], v[60:63], v[220:223]
    v_mfma_f32_16x16x32_bf16 v[224:227], v[24:27], v[48:51], v[224:227]
    v_mfma_f32_16x16x32_bf16 v[228:231], v[24:27], v[52:55], v[228:231]
    v_mfma_f32_16x16x32_bf16 v[232:235], v[24:27], v[56:59], v[232:235]
    v_mfma_f32_16x16x32_bf16 v[236:239], v[24:27], v[60:63], v[236:239]
    v_mfma_f32_16x16x32_bf16 v[240:243], v[28:31], v[48:51], v[240:243]
    v_mfma_f32_16x16x32_bf16 v[244:247], v[28:31], v[52:55], v[244:247]
    v_mfma_f32_16x16x32_bf16 v[248:251], v[28:31], v[56:59], v[248:251]
    v_mfma_f32_16x16x32_bf16 v[252:255], v[28:31], v[60:63], v[252:255]
    s_waitcnt vmcnt(12) lgkmcnt(0)
    s_barrier
    s_mov_b32 s98, 15360
    s_add_u32 m0, s49, 73728
    s_nop 0
    buffer_load_dwordx4 v4, s[4:7], s98 offen sc1 lds
    s_add_u32 m0, s49, 74752
    s_nop 0
    buffer_load_dwordx4 v5, s[4:7], s98 offen sc1 lds
    s_add_u32 m0, s49, 75776
    s_nop 0
    buffer_load_dwordx4 v6, s[4:7], s98 offen sc1 lds
    s_add_u32 m0, s49, 76800
    s_nop 0
    buffer_load_dwordx4 v7, s[4:7], s98 offen sc1 lds
    s_add_u32 m0, s49, 77824
    s_nop 0
    buffer_load_dwordx4 v8, s[4:7], s98 offen sc1 lds
    s_add_u32 m0, s49, 78848
    s_nop 0
    buffer_load_dwordx4 v9, s[4:7], s98 offen sc1 lds
    ds_read_b128 v[16:19], v10 offset:0
    ds_read_b128 v[20:23], v10 offset:1024
    ds_read_b128 v[24:27], v10 offset:2048
    ds_read_b128 v[28:31], v10 offset:3072
    ds_read_b128 v[32:35], v11 offset:0
    ds_read_b128 v[36:39], v11 offset:1024
    ds_read_b128 v[40:43], v11 offset:2048
    ds_read_b128 v[44:47], v11 offset:3072
    ds_read_b128 v[48:51], v11 offset:8192
    ds_read_b128 v[52:55], v11 offset:9216
    ds_read_b128 v[56:59], v11 offset:10240
    ds_read_b128 v[60:63], v11 offset:11264
    v_mfma_f32_16x16x32_bf16 v[128:131], v[80:83], v[64:67], v[128:131]
    v_mfma_f32_16x16x32_bf16 v[132:135], v[80:83], v[68:71], v[132:135]
    v_mfma_f32_16x16x32_bf16 v[136:139], v[80:83], v[72:75], v[136:139]
    v_mfma_f32_16x16x32_bf16 v[140:143], v[80:83], v[76:79], v[140:143]
    v_mfma_f32_16x16x32_bf16 v[144:147], v[84:87], v[64:67], v[144:147]
    v_mfma_f32_16x16x32_bf16 v[148:151], v[84:87], v[68:71], v[148:151]
    v_mfma_f32_16x16x32_bf16 v[152:155], v[84:87], v[72:75], v[152:155]
    v_mfma_f32_16x16x32_bf16 v[156:159], v[84:87], v[76:79], v[156:159]
    v_mfma_f32_16x16x32_bf16 v[160:163], v[88:91], v[64:67], v[160:163]
    v_mfma_f32_16x16x32_bf16 v[164:167], v[88:91], v[68:71], v[164:167]
    v_mfma_f32_16x16x32_bf16 v[168:171], v[88:91], v[72:75], v[168:171]
    v_mfma_f32_16x16x32_bf16 v[172:175], v[88:91], v[76:79], v[172:175]
    v_mfma_f32_16x16x32_bf16 v[176:179], v[92:95], v[64:67], v[176:179]
    v_mfma_f32_16x16x32_bf16 v[180:183], v[92:95], v[68:71], v[180:183]
    v_mfma_f32_16x16x32_bf16 v[184:187], v[92:95], v[72:75], v[184:187]
    v_mfma_f32_16x16x32_bf16 v[188:191], v[92:95], v[76:79], v[188:191]
    v_mfma_f32_16x16x32_bf16 v[192:195], v[64:67], v[96:99], v[192:195]
    v_mfma_f32_16x16x32_bf16 v[196:199], v[64:67], v[100:103], v[196:199]
    v_mfma_f32_16x16x32_bf16 v[200:203], v[64:67], v[104:107], v[200:203]
    v_mfma_f32_16x16x32_bf16 v[204:207], v[64:67], v[108:111], v[204:207]
    v_mfma_f32_16x16x32_bf16 v[208:211], v[68:71], v[96:99], v[208:211]
    v_mfma_f32_16x16x32_bf16 v[212:215], v[68:71], v[100:103], v[212:215]
    v_mfma_f32_16x16x32_bf16 v[216:219], v[68:71], v[104:107], v[216:219]
    v_mfma_f32_16x16x32_bf16 v[220:223], v[68:71], v[108:111], v[220:223]
    v_mfma_f32_16x16x32_bf16 v[224:227], v[72:75], v[96:99], v[224:227]
    v_mfma_f32_16x16x32_bf16 v[228:231], v[72:75], v[100:103], v[228:231]
    v_mfma_f32_16x16x32_bf16 v[232:235], v[72:75], v[104:107], v[232:235]
    v_mfma_f32_16x16x32_bf16 v[236:239], v[72:75], v[108:111], v[236:239]
    v_mfma_f32_16x16x32_bf16 v[240:243], v[76:79], v[96:99], v[240:243]
    v_mfma_f32_16x16x32_bf16 v[244:247], v[76:79], v[100:103], v[244:247]
    v_mfma_f32_16x16x32_bf16 v[248:251], v[76:79], v[104:107], v[248:251]
    v_mfma_f32_16x16x32_bf16 v[252:255], v[76:79], v[108:111], v[252:255]
    s_waitcnt vmcnt(12) lgkmcnt(0)
    s_barrier
    ds_read_b128 v[64:67], v10 offset:24576
    ds_read_b128 v[68:71], v10 offset:25600
    ds_read_b128 v[72:75], v10 offset:26624
    ds_read_b128 v[76:79], v10 offset:27648
    ds_read_b128 v[80:83], v11 offset:24576
    ds_read_b128 v[84:87], v11 offset:25600
    ds_read_b128 v[88:91], v11 offset:26624
    ds_read_b128 v[92:95], v11 offset:27648
    ds_read_b128 v[96:99], v11 offset:32768
    ds_read_b128 v[100:103], v11 offset:33792
    ds_read_b128 v[104:107], v11 offset:34816
    ds_read_b128 v[108:111], v11 offset:35840
    v_mfma_f32_16x16x32_bf16 v[128:131], v[32:35], v[16:19], v[128:131]
    v_mfma_f32_16x16x32_bf16 v[132:135], v[32:35], v[20:23], v[132:135]
    v_mfma_f32_16x16x32_bf16 v[136:139], v[32:35], v[24:27], v[136:139]
    v_mfma_f32_16x16x32_bf16 v[140:143], v[32:35], v[28:31], v[140:143]
    v_mfma_f32_16x16x32_bf16 v[144:147], v[36:39], v[16:19], v[144:147]
    v_mfma_f32_16x16x32_bf16 v[148:151], v[36:39], v[20:23], v[148:151]
    v_mfma_f32_16x16x32_bf16 v[152:155], v[36:39], v[24:27], v[152:155]
    v_mfma_f32_16x16x32_bf16 v[156:159], v[36:39], v[28:31], v[156:159]
    v_mfma_f32_16x16x32_bf16 v[160:163], v[40:43], v[16:19], v[160:163]
    v_mfma_f32_16x16x32_bf16 v[164:167], v[40:43], v[20:23], v[164:167]
    v_mfma_f32_16x16x32_bf16 v[168:171], v[40:43], v[24:27], v[168:171]
    v_mfma_f32_16x16x32_bf16 v[172:175], v[40:43], v[28:31], v[172:175]
    v_mfma_f32_16x16x32_bf16 v[176:179], v[44:47], v[16:19], v[176:179]
    v_mfma_f32_16x16x32_bf16 v[180:183], v[44:47], v[20:23], v[180:183]
    v_mfma_f32_16x16x32_bf16 v[184:187], v[44:47], v[24:27], v[184:187]
    v_mfma_f32_16x16x32_bf16 v[188:191], v[44:47], v[28:31], v[188:191]
    v_mfma_f32_16x16x32_bf16 v[192:195], v[16:19], v[48:51], v[192:195]
    v_mfma_f32_16x16x32_bf16 v[196:199], v[16:19], v[52:55], v[196:199]
    v_mfma_f32_16x16x32_bf16 v[200:203], v[16:19], v[56:59], v[200:203]
    v_mfma_f32_16x16x32_bf16 v[204:207], v[16:19], v[60:63], v[204:207]
    v_mfma_f32_16x16x32_bf16 v[208:211], v[20:23], v[48:51], v[208:211]
    v_mfma_f32_16x16x32_bf16 v[212:215], v[20:23], v[52:55], v[212:215]
    v_mfma_f32_16x16x32_bf16 v[216:219], v[20:23], v[56:59], v[216:219]
    v_mfma_f32_16x16x32_bf16 v[220:223], v[20:23], v[60:63], v[220:223]
    v_mfma_f32_16x16x32_bf16 v[224:227], v[24:27], v[48:51], v[224:227]
    v_mfma_f32_16x16x32_bf16 v[228:231], v[24:27], v[52:55], v[228:231]
    v_mfma_f32_16x16x32_bf16 v[232:235], v[24:27], v[56:59], v[232:235]
    v_mfma_f32_16x16x32_bf16 v[236:239], v[24:27], v[60:63], v[236:239]
    v_mfma_f32_16x16x32_bf16 v[240:243], v[28:31], v[48:51], v[240:243]
    v_mfma_f32_16x16x32_bf16 v[244:247], v[28:31], v[52:55], v[244:247]
    v_mfma_f32_16x16x32_bf16 v[248:251], v[28:31], v[56:59], v[248:251]
    v_mfma_f32_16x16x32_bf16 v[252:255], v[28:31], v[60:63], v[252:255]
    s_waitcnt vmcnt(6) lgkmcnt(0)
    s_barrier
    ds_read_b128 v[16:19], v12 offset:0
    ds_read_b128 v[20:23], v12 offset:1024
    ds_read_b128 v[24:27], v12 offset:2048
    ds_read_b128 v[28:31], v12 offset:3072
    ds_read_b128 v[32:35], v13 offset:0
    ds_read_b128 v[36:39], v13 offset:1024
    ds_read_b128 v[40:43], v13 offset:2048
    ds_read_b128 v[44:47], v13 offset:3072
    ds_read_b128 v[48:51], v13 offset:8192
    ds_read_b128 v[52:55], v13 offset:9216
    ds_read_b128 v[56:59], v13 offset:10240
    ds_read_b128 v[60:63], v13 offset:11264
    v_mfma_f32_16x16x32_bf16 v[128:131], v[80:83], v[64:67], v[128:131]
    v_mfma_f32_16x16x32_bf16 v[132:135], v[80:83], v[68:71], v[132:135]
    v_mfma_f32_16x16x32_bf16 v[136:139], v[80:83], v[72:75], v[136:139]
    v_mfma_f32_16x16x32_bf16 v[140:143], v[80:83], v[76:79], v[140:143]
    v_mfma_f32_16x16x32_bf16 v[144:147], v[84:87], v[64:67], v[144:147]
    v_mfma_f32_16x16x32_bf16 v[148:151], v[84:87], v[68:71], v[148:151]
    v_mfma_f32_16x16x32_bf16 v[152:155], v[84:87], v[72:75], v[152:155]
    v_mfma_f32_16x16x32_bf16 v[156:159], v[84:87], v[76:79], v[156:159]
    v_mfma_f32_16x16x32_bf16 v[160:163], v[88:91], v[64:67], v[160:163]
    v_mfma_f32_16x16x32_bf16 v[164:167], v[88:91], v[68:71], v[164:167]
    v_mfma_f32_16x16x32_bf16 v[168:171], v[88:91], v[72:75], v[168:171]
    v_mfma_f32_16x16x32_bf16 v[172:175], v[88:91], v[76:79], v[172:175]
    v_mfma_f32_16x16x32_bf16 v[176:179], v[92:95], v[64:67], v[176:179]
    v_mfma_f32_16x16x32_bf16 v[180:183], v[92:95], v[68:71], v[180:183]
    v_mfma_f32_16x16x32_bf16 v[184:187], v[92:95], v[72:75], v[184:187]
    v_mfma_f32_16x16x32_bf16 v[188:191], v[92:95], v[76:79], v[188:191]
    v_mfma_f32_16x16x32_bf16 v[192:195], v[64:67], v[96:99], v[192:195]
    v_mfma_f32_16x16x32_bf16 v[196:199], v[64:67], v[100:103], v[196:199]
    v_mfma_f32_16x16x32_bf16 v[200:203], v[64:67], v[104:107], v[200:203]
    v_mfma_f32_16x16x32_bf16 v[204:207], v[64:67], v[108:111], v[204:207]
    v_mfma_f32_16x16x32_bf16 v[208:211], v[68:71], v[96:99], v[208:211]
    v_mfma_f32_16x16x32_bf16 v[212:215], v[68:71], v[100:103], v[212:215]
    v_mfma_f32_16x16x32_bf16 v[216:219], v[68:71], v[104:107], v[216:219]
    v_mfma_f32_16x16x32_bf16 v[220:223], v[68:71], v[108:111], v[220:223]
    v_mfma_f32_16x16x32_bf16 v[224:227], v[72:75], v[96:99], v[224:227]
    v_mfma_f32_16x16x32_bf16 v[228:231], v[72:75], v[100:103], v[228:231]
    v_mfma_f32_16x16x32_bf16 v[232:235], v[72:75], v[104:107], v[232:235]
    v_mfma_f32_16x16x32_bf16 v[236:239], v[72:75], v[108:111], v[236:239]
    v_mfma_f32_16x16x32_bf16 v[240:243], v[76:79], v[96:99], v[240:243]
    v_mfma_f32_16x16x32_bf16 v[244:247], v[76:79], v[100:103], v[244:247]
    v_mfma_f32_16x16x32_bf16 v[248:251], v[76:79], v[104:107], v[248:251]
    v_mfma_f32_16x16x32_bf16 v[252:255], v[76:79], v[108:111], v[252:255]
    s_waitcnt vmcnt(0) lgkmcnt(0)
    s_barrier
    ds_read_b128 v[64:67], v12 offset:24576
    ds_read_b128 v[68:71], v12 offset:25600
    ds_read_b128 v[72:75], v12 offset:26624
    ds_read_b128 v[76:79], v12 offset:27648
    ds_read_b128 v[80:83], v13 offset:24576
    ds_read_b128 v[84:87], v13 offset:25600
    ds_read_b128 v[88:91], v13 offset:26624
    ds_read_b128 v[92:95], v13 offset:27648
    ds_read_b128 v[96:99], v13 offset:32768
    ds_read_b128 v[100:103], v13 offset:33792
    ds_read_b128 v[104:107], v13 offset:34816
    ds_read_b128 v[108:111], v13 offset:35840
    v_mfma_f32_16x16x32_bf16 v[128:131], v[32:35], v[16:19], v[128:131]
    v_mfma_f32_16x16x32_bf16 v[132:135], v[32:35], v[20:23], v[132:135]
    v_mfma_f32_16x16x32_bf16 v[136:139], v[32:35], v[24:27], v[136:139]
    v_mfma_f32_16x16x32_bf16 v[140:143], v[32:35], v[28:31], v[140:143]
    v_mfma_f32_16x16x32_bf16 v[144:147], v[36:39], v[16:19], v[144:147]
    v_mfma_f32_16x16x32_bf16 v[148:151], v[36:39], v[20:23], v[148:151]
    v_mfma_f32_16x16x32_bf16 v[152:155], v[36:39], v[24:27], v[152:155]
    v_mfma_f32_16x16x32_bf16 v[156:159], v[36:39], v[28:31], v[156:159]
    v_mfma_f32_16x16x32_bf16 v[160:163], v[40:43], v[16:19], v[160:163]
    v_mfma_f32_16x16x32_bf16 v[164:167], v[40:43], v[20:23], v[164:167]
    v_mfma_f32_16x16x32_bf16 v[168:171], v[40:43], v[24:27], v[168:171]
    v_mfma_f32_16x16x32_bf16 v[172:175], v[40:43], v[28:31], v[172:175]
    v_mfma_f32_16x16x32_bf16 v[176:179], v[44:47], v[16:19], v[176:179]
    v_mfma_f32_16x16x32_bf16 v[180:183], v[44:47], v[20:23], v[180:183]
    v_mfma_f32_16x16x32_bf16 v[184:187], v[44:47], v[24:27], v[184:187]
    v_mfma_f32_16x16x32_bf16 v[188:191], v[44:47], v[28:31], v[188:191]
    v_mfma_f32_16x16x32_bf16 v[192:195], v[16:19], v[48:51], v[192:195]
    v_mfma_f32_16x16x32_bf16 v[196:199], v[16:19], v[52:55], v[196:199]
    v_mfma_f32_16x16x32_bf16 v[200:203], v[16:19], v[56:59], v[200:203]
    v_mfma_f32_16x16x32_bf16 v[204:207], v[16:19], v[60:63], v[204:207]
    v_mfma_f32_16x16x32_bf16 v[208:211], v[20:23], v[48:51], v[208:211]
    v_mfma_f32_16x16x32_bf16 v[212:215], v[20:23], v[52:55], v[212:215]
    v_mfma_f32_16x16x32_bf16 v[216:219], v[20:23], v[56:59], v[216:219]
    v_mfma_f32_16x16x32_bf16 v[220:223], v[20:23], v[60:63], v[220:223]
    v_mfma_f32_16x16x32_bf16 v[224:227], v[24:27], v[48:51], v[224:227]
    v_mfma_f32_16x16x32_bf16 v[228:231], v[24:27], v[52:55], v[228:231]
    v_mfma_f32_16x16x32_bf16 v[232:235], v[24:27], v[56:59], v[232:235]
    v_mfma_f32_16x16x32_bf16 v[236:239], v[24:27], v[60:63], v[236:239]
    v_mfma_f32_16x16x32_bf16 v[240:243], v[28:31], v[48:51], v[240:243]
    v_mfma_f32_16x16x32_bf16 v[244:247], v[28:31], v[52:55], v[244:247]
    v_mfma_f32_16x16x32_bf16 v[248:251], v[28:31], v[56:59], v[248:251]
    v_mfma_f32_16x16x32_bf16 v[252:255], v[28:31], v[60:63], v[252:255]
    s_waitcnt lgkmcnt(0)
    v_mfma_f32_16x16x32_bf16 v[128:131], v[80:83], v[64:67], v[128:131]
    v_mfma_f32_16x16x32_bf16 v[132:135], v[80:83], v[68:71], v[132:135]
    v_mfma_f32_16x16x32_bf16 v[136:139], v[80:83], v[72:75], v[136:139]
    v_mfma_f32_16x16x32_bf16 v[140:143], v[80:83], v[76:79], v[140:143]
    v_mfma_f32_16x16x32_bf16 v[144:147], v[84:87], v[64:67], v[144:147]
    v_mfma_f32_16x16x32_bf16 v[148:151], v[84:87], v[68:71], v[148:151]
    v_mfma_f32_16x16x32_bf16 v[152:155], v[84:87], v[72:75], v[152:155]
    v_mfma_f32_16x16x32_bf16 v[156:159], v[84:87], v[76:79], v[156:159]
    v_mfma_f32_16x16x32_bf16 v[160:163], v[88:91], v[64:67], v[160:163]
    v_mfma_f32_16x16x32_bf16 v[164:167], v[88:91], v[68:71], v[164:167]
    v_mfma_f32_16x16x32_bf16 v[168:171], v[88:91], v[72:75], v[168:171]
    v_mfma_f32_16x16x32_bf16 v[172:175], v[88:91], v[76:79], v[172:175]
    v_mfma_f32_16x16x32_bf16 v[176:179], v[92:95], v[64:67], v[176:179]
    v_mfma_f32_16x16x32_bf16 v[180:183], v[92:95], v[68:71], v[180:183]
    v_mfma_f32_16x16x32_bf16 v[184:187], v[92:95], v[72:75], v[184:187]
    v_mfma_f32_16x16x32_bf16 v[188:191], v[92:95], v[76:79], v[188:191]
    v_mfma_f32_16x16x32_bf16 v[192:195], v[64:67], v[96:99], v[192:195]
    v_mfma_f32_16x16x32_bf16 v[196:199], v[64:67], v[100:103], v[196:199]
    v_mfma_f32_16x16x32_bf16 v[200:203], v[64:67], v[104:107], v[200:203]
    v_mfma_f32_16x16x32_bf16 v[204:207], v[64:67], v[108:111], v[204:207]
    v_mfma_f32_16x16x32_bf16 v[208:211], v[68:71], v[96:99], v[208:211]
    v_mfma_f32_16x16x32_bf16 v[212:215], v[68:71], v[100:103], v[212:215]
    v_mfma_f32_16x16x32_bf16 v[216:219], v[68:71], v[104:107], v[216:219]
    v_mfma_f32_16x16x32_bf16 v[220:223], v[68:71], v[108:111], v[220:223]
    v_mfma_f32_16x16x32_bf16 v[224:227], v[72:75], v[96:99], v[224:227]
    v_mfma_f32_16x16x32_bf16 v[228:231], v[72:75], v[100:103], v[228:231]
    v_mfma_f32_16x16x32_bf16 v[232:235], v[72:75], v[104:107], v[232:235]
    v_mfma_f32_16x16x32_bf16 v[236:239], v[72:75], v[108:111], v[236:239]
    v_mfma_f32_16x16x32_bf16 v[240:243], v[76:79], v[96:99], v[240:243]
    v_mfma_f32_16x16x32_bf16 v[244:247], v[76:79], v[100:103], v[244:247]
    v_mfma_f32_16x16x32_bf16 v[248:251], v[76:79], v[104:107], v[248:251]
    v_mfma_f32_16x16x32_bf16 v[252:255], v[76:79], v[108:111], v[252:255]
    s_lshl_b32 s46, s42, 19
    s_lshl_b32 s47, s41, 15
    s_add_u32 s46, s46, s47
    s_lshl_b32 s47, s44, 14
    s_add_u32 s46, s46, s47
    s_lshl_b32 s47, s45, 11
    s_add_u32 s46, s46, s47
    s_add_u32 s46, s46, 33554432
    s_add_u32 s46, s46, s88
    v_cvt_pk_bf16_f32 v16, v128, v129
    v_cvt_pk_bf16_f32 v17, v130, v131
    v_cvt_pk_bf16_f32 v18, v144, v145
    v_cvt_pk_bf16_f32 v19, v146, v147
    buffer_store_dwordx4 v[16:19], v3, s[4:7], s46 offen offset:0 sc1
    v_cvt_pk_bf16_f32 v20, v160, v161
    v_cvt_pk_bf16_f32 v21, v162, v163
    v_cvt_pk_bf16_f32 v22, v176, v177
    v_cvt_pk_bf16_f32 v23, v178, v179
    buffer_store_dwordx4 v[20:23], v3, s[4:7], s46 offen offset:1024 sc1
    s_add_u32 s46, s46, 4096
    v_cvt_pk_bf16_f32 v24, v132, v133
    v_cvt_pk_bf16_f32 v25, v134, v135
    v_cvt_pk_bf16_f32 v26, v148, v149
    v_cvt_pk_bf16_f32 v27, v150, v151
    buffer_store_dwordx4 v[24:27], v3, s[4:7], s46 offen offset:0 sc1
    v_cvt_pk_bf16_f32 v28, v164, v165
    v_cvt_pk_bf16_f32 v29, v166, v167
    v_cvt_pk_bf16_f32 v30, v180, v181
    v_cvt_pk_bf16_f32 v31, v182, v183
    buffer_store_dwordx4 v[28:31], v3, s[4:7], s46 offen offset:1024 sc1
    s_add_u32 s46, s46, 4096
    v_cvt_pk_bf16_f32 v32, v136, v137
    v_cvt_pk_bf16_f32 v33, v138, v139
    v_cvt_pk_bf16_f32 v34, v152, v153
    v_cvt_pk_bf16_f32 v35, v154, v155
    buffer_store_dwordx4 v[32:35], v3, s[4:7], s46 offen offset:0 sc1
    v_cvt_pk_bf16_f32 v36, v168, v169
    v_cvt_pk_bf16_f32 v37, v170, v171
    v_cvt_pk_bf16_f32 v38, v184, v185
    v_cvt_pk_bf16_f32 v39, v186, v187
    buffer_store_dwordx4 v[36:39], v3, s[4:7], s46 offen offset:1024 sc1
    s_add_u32 s46, s46, 4096
    v_cvt_pk_bf16_f32 v40, v140, v141
    v_cvt_pk_bf16_f32 v41, v142, v143
    v_cvt_pk_bf16_f32 v42, v156, v157
    v_cvt_pk_bf16_f32 v43, v158, v159
    buffer_store_dwordx4 v[40:43], v3, s[4:7], s46 offen offset:0 sc1
    v_cvt_pk_bf16_f32 v44, v172, v173
    v_cvt_pk_bf16_f32 v45, v174, v175
    v_cvt_pk_bf16_f32 v46, v188, v189
    v_cvt_pk_bf16_f32 v47, v190, v191
    buffer_store_dwordx4 v[44:47], v3, s[4:7], s46 offen offset:1024 sc1
    v_and_b32 v5, 15, v1
    v_lshrrev_b32 v6, 4, v1
    v_lshlrev_b32 v7, 6, v5
    v_lshl_add_u32 v7, v6, 4, v7
    s_lshl_b32 s46, s42, 19
    s_lshl_b32 s47, s41, 15
    s_add_u32 s46, s46, s47
    s_lshl_b32 s47, s44, 14
    s_add_u32 s46, s46, s47
    s_lshl_b32 s47, s45, 12
    s_add_u32 s46, s46, s47
    s_add_u32 s46, s46, 50331648
    s_add_u32 s46, s46, s88
    v_cvt_pk_bf16_f32 v48, v192, v193
    v_cvt_pk_bf16_f32 v49, v194, v195
    v_cvt_pk_bf16_f32 v50, v208, v209
    v_cvt_pk_bf16_f32 v51, v210, v211
    buffer_store_dwordx4 v[48:51], v7, s[4:7], s46 offen offset:0 sc1
    v_cvt_pk_bf16_f32 v52, v196, v197
    v_cvt_pk_bf16_f32 v53, v198, v199
    v_cvt_pk_bf16_f32 v54, v212, v213
    v_cvt_pk_bf16_f32 v55, v214, v215
    buffer_store_dwordx4 v[52:55], v7, s[4:7], s46 offen offset:1024 sc1
    v_cvt_pk_bf16_f32 v56, v200, v201
    v_cvt_pk_bf16_f32 v57, v202, v203
    v_cvt_pk_bf16_f32 v58, v216, v217
    v_cvt_pk_bf16_f32 v59, v218, v219
    buffer_store_dwordx4 v[56:59], v7, s[4:7], s46 offen offset:2048 sc1
    v_cvt_pk_bf16_f32 v60, v204, v205
    v_cvt_pk_bf16_f32 v61, v206, v207
    v_cvt_pk_bf16_f32 v62, v220, v221
    v_cvt_pk_bf16_f32 v63, v222, v223
    buffer_store_dwordx4 v[60:63], v7, s[4:7], s46 offen offset:3072 sc1
    s_add_u32 s46, s46, 8192
    v_cvt_pk_bf16_f32 v64, v224, v225
    v_cvt_pk_bf16_f32 v65, v226, v227
    v_cvt_pk_bf16_f32 v66, v240, v241
    v_cvt_pk_bf16_f32 v67, v242, v243
    buffer_store_dwordx4 v[64:67], v7, s[4:7], s46 offen offset:0 sc1
    v_cvt_pk_bf16_f32 v68, v228, v229
    v_cvt_pk_bf16_f32 v69, v230, v231
    v_cvt_pk_bf16_f32 v70, v244, v245
    v_cvt_pk_bf16_f32 v71, v246, v247
    buffer_store_dwordx4 v[68:71], v7, s[4:7], s46 offen offset:1024 sc1
    v_cvt_pk_bf16_f32 v72, v232, v233
    v_cvt_pk_bf16_f32 v73, v234, v235
    v_cvt_pk_bf16_f32 v74, v248, v249
    v_cvt_pk_bf16_f32 v75, v250, v251
    buffer_store_dwordx4 v[72:75], v7, s[4:7], s46 offen offset:2048 sc1
    v_cvt_pk_bf16_f32 v76, v236, v237
    v_cvt_pk_bf16_f32 v77, v238, v239
    v_cvt_pk_bf16_f32 v78, v252, v253
    v_cvt_pk_bf16_f32 v79, v254, v255
    buffer_store_dwordx4 v[76:79], v7, s[4:7], s46 offen offset:3072 sc1
    s_lshl_b32 s82, s41, 2
    s_waitcnt vmcnt(0)
    s_barrier
    s_cmp_lg_u32 s14, 0
    s_cbranch_scc1 sig_7
    s_mov_b64 exec, 1
    v_mov_b32 v2, s82
    v_mov_b32 v3, 1
    buffer_atomic_add v3, v2, s[4:7], s80 offen
    v_mov_b32 v2, 128
    buffer_atomic_add v3, v2, s[4:7], s80 offen
    s_mov_b64 exec, -1
sig_7:
    s_branch mega_kernel_next
mega_kernel_t23:
    s_sub_u32 s81, s81, 512
    s_cmp_ge_u32 s81, 2048
    s_cbranch_scc1 mega_kernel_b2
    s_lshr_b32 s83, s81, 7
    s_and_b32 s81, s81, 127
    s_cmp_ge_u32 s81, 32
    s_cbranch_scc1 mega_kernel_t3
    s_lshl_b32 s40, s83, 5
    s_add_u32 s40, s40, s81
    s_lshr_b32 s41, s40, 5
    s_and_b32 s42, s40, 31
    v_and_b32 v1, 63, v0
    v_lshrrev_b32 v2, 6, v0
    s_nop 0
    v_readfirstlane_b32 s43, v2
    s_lshl_b32 s44, s41, 2
    s_add_u32 s44, s44, s43
    v_and_b32 v3, 15, v1
    v_lshrrev_b32 v4, 4, v1
    v_lshlrev_b32 v5, 4, v1
    s_lshl_b32 s46, s44, 15
    s_add_u32 s46, s46, 18874368
    s_add_u32 s46, s46, s88
    v_add_u32 v6, s46, v5
    v_add_u32 v7, 16384, v6
    s_lshl_b32 s46, s42, 17
    s_add_u32 s46, s46, 0
    v_add_u32 v8, s46, v5
    s_add_u32 s46, s46, 16384
    v_add_u32 v9, s46, v5
    s_add_u32 s46, s46, 16384
    v_add_u32 v10, s46, v5
    s_add_u32 s46, s46, 16384
    v_add_u32 v11, s46, v5
    s_add_u32 s46, s46, 16384
    v_add_u32 v12, s46, v5
    s_add_u32 s46, s46, 16384
    v_add_u32 v13, s46, v5
    s_add_u32 s46, s46, 16384
    v_add_u32 v14, s46, v5
    s_add_u32 s46, s46, 16384
    v_add_u32 v15, s46, v5
    v_mov_b32 v128, 0
    v_mov_b32 v129, 0
    v_mov_b32 v130, 0
    v_mov_b32 v131, 0
    v_mov_b32 v132, 0
    v_mov_b32 v133, 0
    v_mov_b32 v134, 0
    v_mov_b32 v135, 0
    v_mov_b32 v136, 0
    v_mov_b32 v137, 0
    v_mov_b32 v138, 0
    v_mov_b32 v139, 0
    v_mov_b32 v140, 0
    v_mov_b32 v141, 0
    v_mov_b32 v142, 0
    v_mov_b32 v143, 0
    v_mov_b32 v144, 0
    v_mov_b32 v145, 0
    v_mov_b32 v146, 0
    v_mov_b32 v147, 0
    v_mov_b32 v148, 0
    v_mov_b32 v149, 0
    v_mov_b32 v150, 0
    v_mov_b32 v151, 0
    v_mov_b32 v152, 0
    v_mov_b32 v153, 0
    v_mov_b32 v154, 0
    v_mov_b32 v155, 0
    v_mov_b32 v156, 0
    v_mov_b32 v157, 0
    v_mov_b32 v158, 0
    v_mov_b32 v159, 0
    v_mov_b32 v160, 0
    v_mov_b32 v161, 0
    v_mov_b32 v162, 0
    v_mov_b32 v163, 0
    v_mov_b32 v164, 0
    v_mov_b32 v165, 0
    v_mov_b32 v166, 0
    v_mov_b32 v167, 0
    v_mov_b32 v168, 0
    v_mov_b32 v169, 0
    v_mov_b32 v170, 0
    v_mov_b32 v171, 0
    v_mov_b32 v172, 0
    v_mov_b32 v173, 0
    v_mov_b32 v174, 0
    v_mov_b32 v175, 0
    v_mov_b32 v176, 0
    v_mov_b32 v177, 0
    v_mov_b32 v178, 0
    v_mov_b32 v179, 0
    v_mov_b32 v180, 0
    v_mov_b32 v181, 0
    v_mov_b32 v182, 0
    v_mov_b32 v183, 0
    v_mov_b32 v184, 0
    v_mov_b32 v185, 0
    v_mov_b32 v186, 0
    v_mov_b32 v187, 0
    v_mov_b32 v188, 0
    v_mov_b32 v189, 0
    v_mov_b32 v190, 0
    v_mov_b32 v191, 0
    s_lshl_b32 s86, s41, 2
    s_mov_b32 s85, 0
poll_8:
    v_mov_b32 v254, s86
    buffer_load_dword v254, v254, s[4:7], s80 offen sc1
    s_waitcnt vmcnt(0)
    v_readfirstlane_b32 s84, v254
    s_cmp_ge_u32 s84, 32
    s_cbranch_scc1 poll_8_ok
    s_sleep 8
    s_add_u32 s85, s85, 1
    s_cmp_le_u32 s85, 262144
    s_cbranch_scc1 poll_8
poll_8_ok:
    s_mov_b32 s98, 0
    s_mov_b32 s99, 4096
    buffer_load_dwordx4 v[16:19], v6, s[4:7], s98 offen offset:0 sc1
    buffer_load_dwordx4 v[20:23], v7, s[4:7], s98 offen offset:0 sc1
    buffer_load_dwordx4 v[24:27], v8, s[4:7], s98 offen offset:0
    buffer_load_dwordx4 v[28:31], v9, s[4:7], s98 offen offset:0
    buffer_load_dwordx4 v[32:35], v10, s[4:7], s98 offen offset:0
    buffer_load_dwordx4 v[36:39], v11, s[4:7], s98 offen offset:0
    buffer_load_dwordx4 v[40:43], v12, s[4:7], s98 offen offset:0
    buffer_load_dwordx4 v[44:47], v13, s[4:7], s98 offen offset:0
    buffer_load_dwordx4 v[48:51], v14, s[4:7], s98 offen offset:0
    buffer_load_dwordx4 v[52:55], v15, s[4:7], s98 offen offset:0
    buffer_load_dwordx4 v[56:59], v6, s[4:7], s98 offen offset:1024 sc1
    buffer_load_dwordx4 v[60:63], v7, s[4:7], s98 offen offset:1024 sc1
    buffer_load_dwordx4 v[64:67], v8, s[4:7], s98 offen offset:1024
    buffer_load_dwordx4 v[68:71], v9, s[4:7], s98 offen offset:1024
    buffer_load_dwordx4 v[72:75], v10, s[4:7], s98 offen offset:1024
    buffer_load_dwordx4 v[76:79], v11, s[4:7], s98 offen offset:1024
    buffer_load_dwordx4 v[80:83], v12, s[4:7], s98 offen offset:1024
    buffer_load_dwordx4 v[84:87], v13, s[4:7], s98 offen offset:1024
    buffer_load_dwordx4 v[88:91], v14, s[4:7], s98 offen offset:1024
    buffer_load_dwordx4 v[92:95], v15, s[4:7], s98 offen offset:1024
    buffer_load_dwordx4 a[0:3], v6, s[4:7], s98 offen offset:2048 sc1
    buffer_load_dwordx4 a[4:7], v7, s[4:7], s98 offen offset:2048 sc1
    buffer_load_dwordx4 a[8:11], v8, s[4:7], s98 offen offset:2048
    buffer_load_dwordx4 a[12:15], v9, s[4:7], s98 offen offset:2048
    buffer_load_dwordx4 a[16:19], v10, s[4:7], s98 offen offset:2048
    buffer_load_dwordx4 a[20:23], v11, s[4:7], s98 offen offset:2048
    buffer_load_dwordx4 a[24:27], v12, s[4:7], s98 offen offset:2048
    buffer_load_dwordx4 a[28:31], v13, s[4:7], s98 offen offset:2048
    buffer_load_dwordx4 a[32:35], v14, s[4:7], s98 offen offset:2048
    buffer_load_dwordx4 a[36:39], v15, s[4:7], s98 offen offset:2048
gl_9:
    buffer_load_dwordx4 a[40:43], v6, s[4:7], s98 offen offset:3072 sc1
    buffer_load_dwordx4 a[44:47], v7, s[4:7], s98 offen offset:3072 sc1
    buffer_load_dwordx4 a[48:51], v8, s[4:7], s98 offen offset:3072
    buffer_load_dwordx4 a[52:55], v9, s[4:7], s98 offen offset:3072
    buffer_load_dwordx4 a[56:59], v10, s[4:7], s98 offen offset:3072
    buffer_load_dwordx4 a[60:63], v11, s[4:7], s98 offen offset:3072
    buffer_load_dwordx4 a[64:67], v12, s[4:7], s98 offen offset:3072
    buffer_load_dwordx4 a[68:71], v13, s[4:7], s98 offen offset:3072
    buffer_load_dwordx4 a[72:75], v14, s[4:7], s98 offen offset:3072
    buffer_load_dwordx4 a[76:79], v15, s[4:7], s98 offen offset:3072
    s_waitcnt vmcnt(30)
    v_mfma_f32_16x16x32_bf16 v[128:131], v[24:27], v[16:19], v[128:131]
    v_mfma_f32_16x16x32_bf16 v[132:135], v[24:27], v[20:23], v[132:135]
    v_mfma_f32_16x16x32_bf16 v[136:139], v[28:31], v[16:19], v[136:139]
    v_mfma_f32_16x16x32_bf16 v[140:143], v[28:31], v[20:23], v[140:143]
    v_mfma_f32_16x16x32_bf16 v[144:147], v[32:35], v[16:19], v[144:147]
    v_mfma_f32_16x16x32_bf16 v[148:151], v[32:35], v[20:23], v[148:151]
    v_mfma_f32_16x16x32_bf16 v[152:155], v[36:39], v[16:19], v[152:155]
    v_mfma_f32_16x16x32_bf16 v[156:159], v[36:39], v[20:23], v[156:159]
    v_mfma_f32_16x16x32_bf16 v[160:163], v[40:43], v[16:19], v[160:163]
    v_mfma_f32_16x16x32_bf16 v[164:167], v[40:43], v[20:23], v[164:167]
    v_mfma_f32_16x16x32_bf16 v[168:171], v[44:47], v[16:19], v[168:171]
    v_mfma_f32_16x16x32_bf16 v[172:175], v[44:47], v[20:23], v[172:175]
    v_mfma_f32_16x16x32_bf16 v[176:179], v[48:51], v[16:19], v[176:179]
    v_mfma_f32_16x16x32_bf16 v[180:183], v[48:51], v[20:23], v[180:183]
    v_mfma_f32_16x16x32_bf16 v[184:187], v[52:55], v[16:19], v[184:187]
    v_mfma_f32_16x16x32_bf16 v[188:191], v[52:55], v[20:23], v[188:191]
    buffer_load_dwordx4 v[16:19], v6, s[4:7], s99 offen offset:0 sc1
    buffer_load_dwordx4 v[20:23], v7, s[4:7], s99 offen offset:0 sc1
    buffer_load_dwordx4 v[24:27], v8, s[4:7], s99 offen offset:0
    buffer_load_dwordx4 v[28:31], v9, s[4:7], s99 offen offset:0
    buffer_load_dwordx4 v[32:35], v10, s[4:7], s99 offen offset:0
    buffer_load_dwordx4 v[36:39], v11, s[4:7], s99 offen offset:0
    buffer_load_dwordx4 v[40:43], v12, s[4:7], s99 offen offset:0
    buffer_load_dwordx4 v[44:47], v13, s[4:7], s99 offen offset:0
    buffer_load_dwordx4 v[48:51], v14, s[4:7], s99 offen offset:0
    buffer_load_dwordx4 v[52:55], v15, s[4:7], s99 offen offset:0
    s_waitcnt vmcnt(30)
    v_mfma_f32_16x16x32_bf16 v[128:131], v[64:67], v[56:59], v[128:131]
    v_mfma_f32_16x16x32_bf16 v[132:135], v[64:67], v[60:63], v[132:135]
    v_mfma_f32_16x16x32_bf16 v[136:139], v[68:71], v[56:59], v[136:139]
    v_mfma_f32_16x16x32_bf16 v[140:143], v[68:71], v[60:63], v[140:143]
    v_mfma_f32_16x16x32_bf16 v[144:147], v[72:75], v[56:59], v[144:147]
    v_mfma_f32_16x16x32_bf16 v[148:151], v[72:75], v[60:63], v[148:151]
    v_mfma_f32_16x16x32_bf16 v[152:155], v[76:79], v[56:59], v[152:155]
    v_mfma_f32_16x16x32_bf16 v[156:159], v[76:79], v[60:63], v[156:159]
    v_mfma_f32_16x16x32_bf16 v[160:163], v[80:83], v[56:59], v[160:163]
    v_mfma_f32_16x16x32_bf16 v[164:167], v[80:83], v[60:63], v[164:167]
    v_mfma_f32_16x16x32_bf16 v[168:171], v[84:87], v[56:59], v[168:171]
    v_mfma_f32_16x16x32_bf16 v[172:175], v[84:87], v[60:63], v[172:175]
    v_mfma_f32_16x16x32_bf16 v[176:179], v[88:91], v[56:59], v[176:179]
    v_mfma_f32_16x16x32_bf16 v[180:183], v[88:91], v[60:63], v[180:183]
    v_mfma_f32_16x16x32_bf16 v[184:187], v[92:95], v[56:59], v[184:187]
    v_mfma_f32_16x16x32_bf16 v[188:191], v[92:95], v[60:63], v[188:191]
    buffer_load_dwordx4 v[56:59], v6, s[4:7], s99 offen offset:1024 sc1
    buffer_load_dwordx4 v[60:63], v7, s[4:7], s99 offen offset:1024 sc1
    buffer_load_dwordx4 v[64:67], v8, s[4:7], s99 offen offset:1024
    buffer_load_dwordx4 v[68:71], v9, s[4:7], s99 offen offset:1024
    buffer_load_dwordx4 v[72:75], v10, s[4:7], s99 offen offset:1024
    buffer_load_dwordx4 v[76:79], v11, s[4:7], s99 offen offset:1024
    buffer_load_dwordx4 v[80:83], v12, s[4:7], s99 offen offset:1024
    buffer_load_dwordx4 v[84:87], v13, s[4:7], s99 offen offset:1024
    buffer_load_dwordx4 v[88:91], v14, s[4:7], s99 offen offset:1024
    buffer_load_dwordx4 v[92:95], v15, s[4:7], s99 offen offset:1024
    s_waitcnt vmcnt(30)
    v_mfma_f32_16x16x32_bf16 v[128:131], a[8:11], a[0:3], v[128:131]
    v_mfma_f32_16x16x32_bf16 v[132:135], a[8:11], a[4:7], v[132:135]
    v_mfma_f32_16x16x32_bf16 v[136:139], a[12:15], a[0:3], v[136:139]
    v_mfma_f32_16x16x32_bf16 v[140:143], a[12:15], a[4:7], v[140:143]
    v_mfma_f32_16x16x32_bf16 v[144:147], a[16:19], a[0:3], v[144:147]
    v_mfma_f32_16x16x32_bf16 v[148:151], a[16:19], a[4:7], v[148:151]
    v_mfma_f32_16x16x32_bf16 v[152:155], a[20:23], a[0:3], v[152:155]
    v_mfma_f32_16x16x32_bf16 v[156:159], a[20:23], a[4:7], v[156:159]
    v_mfma_f32_16x16x32_bf16 v[160:163], a[24:27], a[0:3], v[160:163]
    v_mfma_f32_16x16x32_bf16 v[164:167], a[24:27], a[4:7], v[164:167]
    v_mfma_f32_16x16x32_bf16 v[168:171], a[28:31], a[0:3], v[168:171]
    v_mfma_f32_16x16x32_bf16 v[172:175], a[28:31], a[4:7], v[172:175]
    v_mfma_f32_16x16x32_bf16 v[176:179], a[32:35], a[0:3], v[176:179]
    v_mfma_f32_16x16x32_bf16 v[180:183], a[32:35], a[4:7], v[180:183]
    v_mfma_f32_16x16x32_bf16 v[184:187], a[36:39], a[0:3], v[184:187]
    v_mfma_f32_16x16x32_bf16 v[188:191], a[36:39], a[4:7], v[188:191]
    buffer_load_dwordx4 a[0:3], v6, s[4:7], s99 offen offset:2048 sc1
    buffer_load_dwordx4 a[4:7], v7, s[4:7], s99 offen offset:2048 sc1
    buffer_load_dwordx4 a[8:11], v8, s[4:7], s99 offen offset:2048
    buffer_load_dwordx4 a[12:15], v9, s[4:7], s99 offen offset:2048
    buffer_load_dwordx4 a[16:19], v10, s[4:7], s99 offen offset:2048
    buffer_load_dwordx4 a[20:23], v11, s[4:7], s99 offen offset:2048
    buffer_load_dwordx4 a[24:27], v12, s[4:7], s99 offen offset:2048
    buffer_load_dwordx4 a[28:31], v13, s[4:7], s99 offen offset:2048
    buffer_load_dwordx4 a[32:35], v14, s[4:7], s99 offen offset:2048
    buffer_load_dwordx4 a[36:39], v15, s[4:7], s99 offen offset:2048
    s_waitcnt vmcnt(30)
    v_mfma_f32_16x16x32_bf16 v[128:131], a[48:51], a[40:43], v[128:131]
    v_mfma_f32_16x16x32_bf16 v[132:135], a[48:51], a[44:47], v[132:135]
    v_mfma_f32_16x16x32_bf16 v[136:139], a[52:55], a[40:43], v[136:139]
    v_mfma_f32_16x16x32_bf16 v[140:143], a[52:55], a[44:47], v[140:143]
    v_mfma_f32_16x16x32_bf16 v[144:147], a[56:59], a[40:43], v[144:147]
    v_mfma_f32_16x16x32_bf16 v[148:151], a[56:59], a[44:47], v[148:151]
    v_mfma_f32_16x16x32_bf16 v[152:155], a[60:63], a[40:43], v[152:155]
    v_mfma_f32_16x16x32_bf16 v[156:159], a[60:63], a[44:47], v[156:159]
    v_mfma_f32_16x16x32_bf16 v[160:163], a[64:67], a[40:43], v[160:163]
    v_mfma_f32_16x16x32_bf16 v[164:167], a[64:67], a[44:47], v[164:167]
    v_mfma_f32_16x16x32_bf16 v[168:171], a[68:71], a[40:43], v[168:171]
    v_mfma_f32_16x16x32_bf16 v[172:175], a[68:71], a[44:47], v[172:175]
    v_mfma_f32_16x16x32_bf16 v[176:179], a[72:75], a[40:43], v[176:179]
    v_mfma_f32_16x16x32_bf16 v[180:183], a[72:75], a[44:47], v[180:183]
    v_mfma_f32_16x16x32_bf16 v[184:187], a[76:79], a[40:43], v[184:187]
    v_mfma_f32_16x16x32_bf16 v[188:191], a[76:79], a[44:47], v[188:191]
    s_add_u32 s98, s98, 4096
    s_add_u32 s99, s99, 4096
    s_cmp_lt_u32 s98, 16384
    s_cbranch_scc1 gl_9
    s_waitcnt vmcnt(0)
    v_and_b32 v7, 7, v1
    v_lshlrev_b32 v7, 4, v7
    v_lshl_add_u32 v7, v4, 7, v7
    v_lshlrev_b32 v8, 6, v3
    v_lshl_add_u32 v8, v4, 4, v8
    v_and_b32 v9, 1, v4
    v_lshlrev_b32 v9, 3, v9
    v_lshl_add_u32 v9, v3, 4, v9
    s_lshl_b32 s46, s42, 19
    s_lshl_b32 s47, s44, 13
    s_add_u32 s46, s46, s47
    s_add_u32 s46, s46, s88
    s_add_u32 s60, s46, 33554432
    s_add_u32 s61, s60, 4096
    s_add_u32 s62, s46, 50331648
    s_add_u32 s63, s62, 4096
    s_lshl_b32 s46, s42, 17
    s_lshl_b32 s47, s44, 11
    s_add_u32 s46, s46, s47
    s_add_u32 s46, s46, s88
    s_add_u32 s64, s46, 67108864
    s_add_u32 s65, s46, 71303168
    buffer_load_dwordx4 v[16:19], v5, s[4:7], s60 offen offset:0 sc1
    buffer_load_dwordx4 v[20:23], v5, s[4:7], s60 offen offset:1024 sc1
    buffer_load_dwordx4 v[24:27], v5, s[4:7], s60 offen offset:2048 sc1
    buffer_load_dwordx4 v[28:31], v5, s[4:7], s60 offen offset:3072 sc1
    buffer_load_dwordx4 v[32:35], v5, s[4:7], s61 offen offset:0 sc1
    buffer_load_dwordx4 v[36:39], v5, s[4:7], s61 offen offset:1024 sc1
    buffer_load_dwordx4 v[40:43], v5, s[4:7], s61 offen offset:2048 sc1
    buffer_load_dwordx4 v[44:47], v5, s[4:7], s61 offen offset:3072 sc1
    buffer_load_dwordx4 v[192:195], v8, s[4:7], s62 offen offset:0 sc1
    buffer_load_dwordx4 v[196:199], v8, s[4:7], s62 offen offset:1024 sc1
    buffer_load_dwordx4 v[200:203], v8, s[4:7], s62 offen offset:2048 sc1
    buffer_load_dwordx4 v[204:207], v8, s[4:7], s62 offen offset:3072 sc1
    buffer_load_dwordx4 v[208:211], v8, s[4:7], s63 offen offset:0 sc1
    buffer_load_dwordx4 v[212:215], v8, s[4:7], s63 offen offset:1024 sc1
    buffer_load_dwordx4 v[216:219], v8, s[4:7], s63 offen offset:2048 sc1
    buffer_load_dwordx4 v[220:223], v8, s[4:7], s63 offen offset:3072 sc1
    v_cvt_pk_bf16_f32 v96, v128, v129
    v_cvt_pk_bf16_f32 v97, v130, v131
    v_cvt_pk_bf16_f32 v98, v136, v137
    v_cvt_pk_bf16_f32 v99, v138, v139
    v_cvt_pk_bf16_f32 v100, v132, v133
    v_cvt_pk_bf16_f32 v101, v134, v135
    v_cvt_pk_bf16_f32 v102, v140, v141
    v_cvt_pk_bf16_f32 v103, v142, v143
    v_cvt_pk_bf16_f32 v104, v144, v145
    v_cvt_pk_bf16_f32 v105, v146, v147
    v_cvt_pk_bf16_f32 v106, v152, v153
    v_cvt_pk_bf16_f32 v107, v154, v155
    v_cvt_pk_bf16_f32 v108, v148, v149
    v_cvt_pk_bf16_f32 v109, v150, v151
    v_cvt_pk_bf16_f32 v110, v156, v157
    v_cvt_pk_bf16_f32 v111, v158, v159
    v_cvt_pk_bf16_f32 v112, v160, v161
    v_cvt_pk_bf16_f32 v113, v162, v163
    v_cvt_pk_bf16_f32 v114, v168, v169
    v_cvt_pk_bf16_f32 v115, v170, v171
    v_cvt_pk_bf16_f32 v116, v164, v165
    v_cvt_pk_bf16_f32 v117, v166, v167
    v_cvt_pk_bf16_f32 v118, v172, v173
    v_cvt_pk_bf16_f32 v119, v174, v175
    v_cvt_pk_bf16_f32 v120, v176, v177
    v_cvt_pk_bf16_f32 v121, v178, v179
    v_cvt_pk_bf16_f32 v122, v184, v185
    v_cvt_pk_bf16_f32 v123, v186, v187
    v_cvt_pk_bf16_f32 v124, v180, v181
    v_cvt_pk_bf16_f32 v125, v182, v183
    v_cvt_pk_bf16_f32 v126, v188, v189
    v_cvt_pk_bf16_f32 v127, v190, v191
    v_lshlrev_b32 v10, 2, v4
    v_add_u32 v11, 0, v10
    v_cmp_le_u32 s[66:67], v11, v3
    v_add_u32 v11, 1, v10
    v_cmp_le_u32 s[68:69], v11, v3
    v_add_u32 v11, 2, v10
    v_cmp_le_u32 s[70:71], v11, v3
    v_add_u32 v11, 3, v10
    v_cmp_le_u32 s[72:73], v11, v3
    v_cmp_gt_u32 s[74:75], 2, v4
    s_waitcnt vmcnt(8)
    v_mfma_f32_16x16x32_bf16 v[128:131], v[16:19], v[96:99], 0
    v_mfma_f32_16x16x32_bf16 v[128:131], v[20:23], v[104:107], v[128:131]
    v_mfma_f32_16x16x32_bf16 v[128:131], v[24:27], v[112:115], v[128:131]
    v_mfma_f32_16x16x32_bf16 v[128:131], v[28:31], v[120:123], v[128:131]
    v_mfma_f32_16x16x32_bf16 v[132:135], v[16:19], v[100:103], 0
    v_mfma_f32_16x16x32_bf16 v[132:135], v[20:23], v[108:111], v[132:135]
    v_mfma_f32_16x16x32_bf16 v[132:135], v[24:27], v[116:119], v[132:135]
    v_mfma_f32_16x16x32_bf16 v[132:135], v[28:31], v[124:127], v[132:135]
    v_mfma_f32_16x16x32_bf16 v[136:139], v[32:35], v[100:103], 0
    v_mfma_f32_16x16x32_bf16 v[136:139], v[36:39], v[108:111], v[136:139]
    v_mfma_f32_16x16x32_bf16 v[136:139], v[40:43], v[116:119], v[136:139]
    v_mfma_f32_16x16x32_bf16 v[136:139], v[44:47], v[124:127], v[136:139]
    s_lshl_b32 s86, s41, 2
    s_mov_b32 s85, 0
poll_10:
    v_mov_b32 v254, s86
    buffer_load_dword v254, v254, s[4:7], s80 offen sc1
    s_waitcnt vmcnt(0)
    v_readfirstlane_b32 s84, v254
    s_cmp_ge_u32 s84, 32
    s_cbranch_scc1 poll_10_ok
    s_sleep 8
    s_add_u32 s85, s85, 1
    s_cmp_le_u32 s85, 262144
    s_cbranch_scc1 poll_10
poll_10_ok:
    s_lshl_b32 s86, s42, 2
    s_add_u32 s86, s86, 512
    s_lshl_b32 s87, s41, 2
    s_add_u32 s87, s87, 4
    s_mov_b32 s85, 0
poll_11:
    v_mov_b32 v254, s86
    buffer_load_dword v254, v254, s[4:7], s80 offen sc1
    s_waitcnt vmcnt(0)
    v_readfirstlane_b32 s84, v254
    s_cmp_ge_u32 s84, s87
    s_cbranch_scc1 poll_11_ok
    s_sleep 8
    s_add_u32 s85, s85, 1
    s_cmp_le_u32 s85, 262144
    s_cbranch_scc1 poll_11
poll_11_ok:
    buffer_load_dwordx4 v[48:51], v7, s[4:7], s64 offen offset:0 sc1
    buffer_load_dwordx4 v[52:55], v7, s[4:7], s64 offen offset:512 sc1
    buffer_load_dwordx4 v[56:59], v7, s[4:7], s64 offen offset:1024 sc1
    buffer_load_dwordx4 v[60:63], v7, s[4:7], s64 offen offset:1536 sc1
    buffer_load_dwordx2 v[224:225], v9, s[4:7], s65 offen offset:0 sc1
    v_mov_b32 v226, 0
    v_mov_b32 v227, 0
    buffer_load_dwordx2 v[228:229], v9, s[4:7], s65 offen offset:256 sc1
    v_mov_b32 v230, 0
    v_mov_b32 v231, 0
    buffer_load_dwordx2 v[232:233], v9, s[4:7], s65 offen offset:512 sc1
    v_mov_b32 v234, 0
    v_mov_b32 v235, 0
    buffer_load_dwordx2 v[236:237], v9, s[4:7], s65 offen offset:768 sc1
    v_mov_b32 v238, 0
    v_mov_b32 v239, 0
    buffer_load_dwordx2 v[240:241], v9, s[4:7], s65 offen offset:1024 sc1
    v_mov_b32 v242, 0
    v_mov_b32 v243, 0
    buffer_load_dwordx2 v[244:245], v9, s[4:7], s65 offen offset:1280 sc1
    v_mov_b32 v246, 0
    v_mov_b32 v247, 0
    buffer_load_dwordx2 v[248:249], v9, s[4:7], s65 offen offset:1536 sc1
    v_mov_b32 v250, 0
    v_mov_b32 v251, 0
    buffer_load_dwordx2 v[252:253], v9, s[4:7], s65 offen offset:1792 sc1
    v_mov_b32 v254, 0
    v_mov_b32 v255, 0
    s_waitcnt vmcnt(8)
    v_mfma_f32_16x16x32_bf16 v[140:143], v[48:51], v[96:99], 0
    v_mfma_f32_16x16x32_bf16 v[140:143], v[52:55], v[104:107], v[140:143]
    v_mfma_f32_16x16x32_bf16 v[140:143], v[56:59], v[112:115], v[140:143]
    v_mfma_f32_16x16x32_bf16 v[140:143], v[60:63], v[120:123], v[140:143]
    v_mfma_f32_16x16x32_bf16 v[144:147], v[48:51], v[100:103], 0
    v_mfma_f32_16x16x32_bf16 v[144:147], v[52:55], v[108:111], v[144:147]
    v_mfma_f32_16x16x32_bf16 v[144:147], v[56:59], v[116:119], v[144:147]
    v_mfma_f32_16x16x32_bf16 v[144:147], v[60:63], v[124:127], v[144:147]
    v_mov_b32 v12, 0xf149f2ca
    v_cvt_pk_bf16_f32 v13, v128, v129
    v_lshlrev_b32 v128, 16, v13
    v_and_b32 v129, 0xffff0000, v13
    v_cvt_pk_bf16_f32 v13, v130, v131
    v_lshlrev_b32 v130, 16, v13
    v_and_b32 v131, 0xffff0000, v13
    v_cvt_pk_bf16_f32 v13, v140, v141
    v_lshlrev_b32 v140, 16, v13
    v_and_b32 v141, 0xffff0000, v13
    v_cvt_pk_bf16_f32 v13, v142, v143
    v_lshlrev_b32 v142, 16, v13
    v_and_b32 v143, 0xffff0000, v13
    v_mul_f32 v128, 0x3db504f3, v128
    v_mul_f32 v129, 0x3db504f3, v129
    v_mul_f32 v130, 0x3db504f3, v130
    v_mul_f32 v131, 0x3db504f3, v131
    v_mul_f32 v140, 0x3db504f3, v140
    v_mul_f32 v141, 0x3db504f3, v141
    v_mul_f32 v142, 0x3db504f3, v142
    v_mul_f32 v143, 0x3db504f3, v143
    v_cvt_pk_bf16_f32 v13, v128, v129
    v_lshlrev_b32 v128, 16, v13
    v_and_b32 v129, 0xffff0000, v13
    v_cvt_pk_bf16_f32 v13, v130, v131
    v_lshlrev_b32 v130, 16, v13
    v_and_b32 v131, 0xffff0000, v13
    v_cvt_pk_bf16_f32 v13, v140, v141
    v_lshlrev_b32 v140, 16, v13
    v_and_b32 v141, 0xffff0000, v13
    v_cvt_pk_bf16_f32 v13, v142, v143
    v_lshlrev_b32 v142, 16, v13
    v_and_b32 v143, 0xffff0000, v13
    v_cndmask_b32 v128, v12, v128, s[66:67]
    v_cndmask_b32 v129, v12, v129, s[68:69]
    v_cndmask_b32 v130, v12, v130, s[70:71]
    v_cndmask_b32 v131, v12, v131, s[72:73]
    v_cndmask_b32 v140, v12, v140, s[74:75]
    v_cndmask_b32 v141, v12, v141, s[74:75]
    v_cndmask_b32 v142, v12, v142, s[74:75]
    v_cndmask_b32 v143, v12, v143, s[74:75]
    v_max_f32 v14, v128, v129
    v_max3_f32 v14, v14, v130, v131
    v_max3_f32 v14, v14, v140, v141
    v_max3_f32 v14, v14, v142, v143
    v_mov_b32 v15, v14
    s_nop 1
    v_permlane16_swap_b32 v14, v15
    v_max_f32 v14, v14, v15
    v_mov_b32 v15, v14
    s_nop 1
    v_permlane32_swap_b32 v14, v15
    v_max_f32 v14, v14, v15
    v_mul_f32 v14, 0xbfb8aa3b, v14
    v_mov_b32 v13, 0x3fb8aa3b
    v_fma_f32 v128, v128, v13, v14
    v_exp_f32 v128, v128
    v_fma_f32 v129, v129, v13, v14
    v_exp_f32 v129, v129
    v_fma_f32 v130, v130, v13, v14
    v_exp_f32 v130, v130
    v_fma_f32 v131, v131, v13, v14
    v_exp_f32 v131, v131
    v_fma_f32 v140, v140, v13, v14
    v_exp_f32 v140, v140
    v_fma_f32 v141, v141, v13, v14
    v_exp_f32 v141, v141
    v_fma_f32 v142, v142, v13, v14
    v_exp_f32 v142, v142
    v_fma_f32 v143, v143, v13, v14
    v_exp_f32 v143, v143
    v_add_f32 v14, v128, v129
    v_add_f32 v14, v14, v130
    v_add_f32 v14, v14, v131
    v_add_f32 v14, v14, v140
    v_add_f32 v14, v14, v141
    v_add_f32 v14, v14, v142
    v_add_f32 v14, v14, v143
    v_mov_b32 v15, v14
    s_nop 1
    v_permlane16_swap_b32 v14, v15
    v_add_f32 v14, v14, v15
    v_mov_b32 v15, v14
    s_nop 1
    v_permlane32_swap_b32 v14, v15
    v_add_f32 v14, v14, v15
    v_rcp_f32 v14, v14
    s_nop 0
    v_mul_f32 v128, v128, v14
    v_mul_f32 v129, v129, v14
    v_mul_f32 v130, v130, v14
    v_mul_f32 v131, v131, v14
    v_mul_f32 v140, v140, v14
    v_mul_f32 v141, v141, v14
    v_mul_f32 v142, v142, v14
    v_mul_f32 v143, v143, v14
    v_cvt_pk_bf16_f32 v13, v132, v133
    v_lshlrev_b32 v132, 16, v13
    v_and_b32 v133, 0xffff0000, v13
    v_cvt_pk_bf16_f32 v13, v134, v135
    v_lshlrev_b32 v134, 16, v13
    v_and_b32 v135, 0xffff0000, v13
    v_cvt_pk_bf16_f32 v13, v136, v137
    v_lshlrev_b32 v136, 16, v13
    v_and_b32 v137, 0xffff0000, v13
    v_cvt_pk_bf16_f32 v13, v138, v139
    v_lshlrev_b32 v138, 16, v13
    v_and_b32 v139, 0xffff0000, v13
    v_cvt_pk_bf16_f32 v13, v144, v145
    v_lshlrev_b32 v144, 16, v13
    v_and_b32 v145, 0xffff0000, v13
    v_cvt_pk_bf16_f32 v13, v146, v147
    v_lshlrev_b32 v146, 16, v13
    v_and_b32 v147, 0xffff0000, v13
    v_mul_f32 v132, 0x3db504f3, v132
    v_mul_f32 v133, 0x3db504f3, v133
    v_mul_f32 v134, 0x3db504f3, v134
    v_mul_f32 v135, 0x3db504f3, v135
    v_mul_f32 v136, 0x3db504f3, v136
    v_mul_f32 v137, 0x3db504f3, v137
    v_mul_f32 v138, 0x3db504f3, v138
    v_mul_f32 v139, 0x3db504f3, v139
    v_mul_f32 v144, 0x3db504f3, v144
    v_mul_f32 v145, 0x3db504f3, v145
    v_mul_f32 v146, 0x3db504f3, v146
    v_mul_f32 v147, 0x3db504f3, v147
    v_cvt_pk_bf16_f32 v13, v132, v133
    v_lshlrev_b32 v132, 16, v13
    v_and_b32 v133, 0xffff0000, v13
    v_cvt_pk_bf16_f32 v13, v134, v135
    v_lshlrev_b32 v134, 16, v13
    v_and_b32 v135, 0xffff0000, v13
    v_cvt_pk_bf16_f32 v13, v136, v137
    v_lshlrev_b32 v136, 16, v13
    v_and_b32 v137, 0xffff0000, v13
    v_cvt_pk_bf16_f32 v13, v138, v139
    v_lshlrev_b32 v138, 16, v13
    v_and_b32 v139, 0xffff0000, v13
    v_cvt_pk_bf16_f32 v13, v144, v145
    v_lshlrev_b32 v144, 16, v13
    v_and_b32 v145, 0xffff0000, v13
    v_cvt_pk_bf16_f32 v13, v146, v147
    v_lshlrev_b32 v146, 16, v13
    v_and_b32 v147, 0xffff0000, v13
    v_cndmask_b32 v136, v12, v136, s[66:67]
    v_cndmask_b32 v137, v12, v137, s[68:69]
    v_cndmask_b32 v138, v12, v138, s[70:71]
    v_cndmask_b32 v139, v12, v139, s[72:73]
    v_cndmask_b32 v144, v12, v144, s[74:75]
    v_cndmask_b32 v145, v12, v145, s[74:75]
    v_cndmask_b32 v146, v12, v146, s[74:75]
    v_cndmask_b32 v147, v12, v147, s[74:75]
    v_max_f32 v14, v132, v133
    v_max3_f32 v14, v14, v134, v135
    v_max3_f32 v14, v14, v136, v137
    v_max3_f32 v14, v14, v138, v139
    v_max3_f32 v14, v14, v144, v145
    v_max3_f32 v14, v14, v146, v147
    v_mov_b32 v15, v14
    s_nop 1
    v_permlane16_swap_b32 v14, v15
    v_max_f32 v14, v14, v15
    v_mov_b32 v15, v14
    s_nop 1
    v_permlane32_swap_b32 v14, v15
    v_max_f32 v14, v14, v15
    v_mul_f32 v14, 0xbfb8aa3b, v14
    v_mov_b32 v13, 0x3fb8aa3b
    v_fma_f32 v132, v132, v13, v14
    v_exp_f32 v132, v132
    v_fma_f32 v133, v133, v13, v14
    v_exp_f32 v133, v133
    v_fma_f32 v134, v134, v13, v14
    v_exp_f32 v134, v134
    v_fma_f32 v135, v135, v13, v14
    v_exp_f32 v135, v135
    v_fma_f32 v136, v136, v13, v14
    v_exp_f32 v136, v136
    v_fma_f32 v137, v137, v13, v14
    v_exp_f32 v137, v137
    v_fma_f32 v138, v138, v13, v14
    v_exp_f32 v138, v138
    v_fma_f32 v139, v139, v13, v14
    v_exp_f32 v139, v139
    v_fma_f32 v144, v144, v13, v14
    v_exp_f32 v144, v144
    v_fma_f32 v145, v145, v13, v14
    v_exp_f32 v145, v145
    v_fma_f32 v146, v146, v13, v14
    v_exp_f32 v146, v146
    v_fma_f32 v147, v147, v13, v14
    v_exp_f32 v147, v147
    v_add_f32 v14, v132, v133
    v_add_f32 v14, v14, v134
    v_add_f32 v14, v14, v135
    v_add_f32 v14, v14, v136
    v_add_f32 v14, v14, v137
    v_add_f32 v14, v14, v138
    v_add_f32 v14, v14, v139
    v_add_f32 v14, v14, v144
    v_add_f32 v14, v14, v145
    v_add_f32 v14, v14, v146
    v_add_f32 v14, v14, v147
    v_mov_b32 v15, v14
    s_nop 1
    v_permlane16_swap_b32 v14, v15
    v_add_f32 v14, v14, v15
    v_mov_b32 v15, v14
    s_nop 1
    v_permlane32_swap_b32 v14, v15
    v_add_f32 v14, v14, v15
    v_rcp_f32 v14, v14
    s_nop 0
    v_mul_f32 v132, v132, v14
    v_mul_f32 v133, v133, v14
    v_mul_f32 v134, v134, v14
    v_mul_f32 v135, v135, v14
    v_mul_f32 v136, v136, v14
    v_mul_f32 v137, v137, v14
    v_mul_f32 v138, v138, v14
    v_mul_f32 v139, v139, v14
    v_mul_f32 v144, v144, v14
    v_mul_f32 v145, v145, v14
    v_mul_f32 v146, v146, v14
    v_mul_f32 v147, v147, v14
    v_cvt_pk_bf16_f32 v80, v128, v129
    v_cvt_pk_bf16_f32 v81, v130, v131
    v_mov_b32 v82, 0
    v_mov_b32 v83, 0
    v_cvt_pk_bf16_f32 v84, v140, v141
    v_cvt_pk_bf16_f32 v85, v142, v143
    v_mov_b32 v86, 0
    v_mov_b32 v87, 0
    v_cvt_pk_bf16_f32 v88, v132, v133
    v_cvt_pk_bf16_f32 v89, v134, v135
    v_cvt_pk_bf16_f32 v90, v136, v137
    v_cvt_pk_bf16_f32 v91, v138, v139
    v_cvt_pk_bf16_f32 v92, v144, v145
    v_cvt_pk_bf16_f32 v93, v146, v147
    v_mov_b32 v94, 0
    v_mov_b32 v95, 0
    s_waitcnt vmcnt(0)
    v_mfma_f32_16x16x32_bf16 v[16:19], v[192:195], v[80:83], 0
    v_mfma_f32_16x16x32_bf16 v[20:23], v[192:195], v[88:91], 0
    v_mfma_f32_16x16x32_bf16 v[24:27], v[196:199], v[80:83], 0
    v_mfma_f32_16x16x32_bf16 v[28:31], v[196:199], v[88:91], 0
    v_mfma_f32_16x16x32_bf16 v[32:35], v[200:203], v[80:83], 0
    v_mfma_f32_16x16x32_bf16 v[36:39], v[200:203], v[88:91], 0
    v_mfma_f32_16x16x32_bf16 v[40:43], v[204:207], v[80:83], 0
    v_mfma_f32_16x16x32_bf16 v[44:47], v[204:207], v[88:91], 0
    v_mfma_f32_16x16x32_bf16 v[48:51], v[208:211], v[80:83], 0
    v_mfma_f32_16x16x32_bf16 v[52:55], v[208:211], v[88:91], 0
    v_mfma_f32_16x16x32_bf16 v[56:59], v[212:215], v[80:83], 0
    v_mfma_f32_16x16x32_bf16 v[60:63], v[212:215], v[88:91], 0
    v_mfma_f32_16x16x32_bf16 v[64:67], v[216:219], v[80:83], 0
    v_mfma_f32_16x16x32_bf16 v[68:71], v[216:219], v[88:91], 0
    v_mfma_f32_16x16x32_bf16 v[72:75], v[220:223], v[80:83], 0
    v_mfma_f32_16x16x32_bf16 v[76:79], v[220:223], v[88:91], 0
    v_mfma_f32_16x16x32_bf16 v[16:19], v[224:227], v[84:87], v[16:19]
    v_mfma_f32_16x16x32_bf16 v[20:23], v[224:227], v[92:95], v[20:23]
    v_mfma_f32_16x16x32_bf16 v[24:27], v[228:231], v[84:87], v[24:27]
    v_mfma_f32_16x16x32_bf16 v[28:31], v[228:231], v[92:95], v[28:31]
    v_mfma_f32_16x16x32_bf16 v[32:35], v[232:235], v[84:87], v[32:35]
    v_mfma_f32_16x16x32_bf16 v[36:39], v[232:235], v[92:95], v[36:39]
    v_mfma_f32_16x16x32_bf16 v[40:43], v[236:239], v[84:87], v[40:43]
    v_mfma_f32_16x16x32_bf16 v[44:47], v[236:239], v[92:95], v[44:47]
    v_mfma_f32_16x16x32_bf16 v[48:51], v[240:243], v[84:87], v[48:51]
    v_mfma_f32_16x16x32_bf16 v[52:55], v[240:243], v[92:95], v[52:55]
    v_mfma_f32_16x16x32_bf16 v[56:59], v[244:247], v[84:87], v[56:59]
    v_mfma_f32_16x16x32_bf16 v[60:63], v[244:247], v[92:95], v[60:63]
    v_mfma_f32_16x16x32_bf16 v[64:67], v[248:251], v[84:87], v[64:67]
    v_mfma_f32_16x16x32_bf16 v[68:71], v[248:251], v[92:95], v[68:71]
    v_mfma_f32_16x16x32_bf16 v[72:75], v[252:255], v[84:87], v[72:75]
    v_mfma_f32_16x16x32_bf16 v[76:79], v[252:255], v[92:95], v[76:79]
    s_lshl_b32 s46, s44, 18
    s_lshl_b32 s47, s42, 12
    s_add_u32 s46, s46, s47
    s_add_u32 s46, s46, 83886080
    s_add_u32 s46, s46, s88
    s_add_u32 s47, s46, 131072
    v_cvt_pk_bf16_f32 v96, v16, v17
    v_cvt_pk_bf16_f32 v97, v18, v19
    v_cvt_pk_bf16_f32 v98, v24, v25
    v_cvt_pk_bf16_f32 v99, v26, v27
    buffer_store_dwordx4 v[96:99], v5, s[4:7], s46 offen offset:0 sc1
    v_cvt_pk_bf16_f32 v100, v20, v21
    v_cvt_pk_bf16_f32 v101, v22, v23
    v_cvt_pk_bf16_f32 v102, v28, v29
    v_cvt_pk_bf16_f32 v103, v30, v31
    buffer_store_dwordx4 v[100:103], v5, s[4:7], s47 offen offset:0 sc1
    v_cvt_pk_bf16_f32 v104, v32, v33
    v_cvt_pk_bf16_f32 v105, v34, v35
    v_cvt_pk_bf16_f32 v106, v40, v41
    v_cvt_pk_bf16_f32 v107, v42, v43
    buffer_store_dwordx4 v[104:107], v5, s[4:7], s46 offen offset:1024 sc1
    v_cvt_pk_bf16_f32 v108, v36, v37
    v_cvt_pk_bf16_f32 v109, v38, v39
    v_cvt_pk_bf16_f32 v110, v44, v45
    v_cvt_pk_bf16_f32 v111, v46, v47
    buffer_store_dwordx4 v[108:111], v5, s[4:7], s47 offen offset:1024 sc1
    v_cvt_pk_bf16_f32 v112, v48, v49
    v_cvt_pk_bf16_f32 v113, v50, v51
    v_cvt_pk_bf16_f32 v114, v56, v57
    v_cvt_pk_bf16_f32 v115, v58, v59
    buffer_store_dwordx4 v[112:115], v5, s[4:7], s46 offen offset:2048 sc1
    v_cvt_pk_bf16_f32 v116, v52, v53
    v_cvt_pk_bf16_f32 v117, v54, v55
    v_cvt_pk_bf16_f32 v118, v60, v61
    v_cvt_pk_bf16_f32 v119, v62, v63
    buffer_store_dwordx4 v[116:119], v5, s[4:7], s47 offen offset:2048 sc1
    v_cvt_pk_bf16_f32 v120, v64, v65
    v_cvt_pk_bf16_f32 v121, v66, v67
    v_cvt_pk_bf16_f32 v122, v72, v73
    v_cvt_pk_bf16_f32 v123, v74, v75
    buffer_store_dwordx4 v[120:123], v5, s[4:7], s46 offen offset:3072 sc1
    v_cvt_pk_bf16_f32 v124, v68, v69
    v_cvt_pk_bf16_f32 v125, v70, v71
    v_cvt_pk_bf16_f32 v126, v76, v77
    v_cvt_pk_bf16_f32 v127, v78, v79
    buffer_store_dwordx4 v[124:127], v5, s[4:7], s47 offen offset:3072 sc1
    s_lshl_b32 s82, s41, 2
    s_add_u32 s82, s82, 256
    s_waitcnt vmcnt(0)
    s_barrier
    s_cmp_lg_u32 s14, 0
    s_cbranch_scc1 sig_12
    s_mov_b64 exec, 1
    v_mov_b32 v2, s82
    v_mov_b32 v3, 1
    buffer_atomic_add v3, v2, s[4:7], s80 offen
    s_mov_b64 exec, -1
sig_12:
    s_branch mega_kernel_next
mega_kernel_t3:
    s_sub_u32 s81, s81, 32
    s_cmp_ge_u32 s81, 64
    s_cbranch_scc1 mega_kernel_lnb
    s_lshl_b32 s40, s83, 6
    s_add_u32 s40, s40, s81
    s_lshr_b32 s41, s40, 4
    s_and_b32 s42, s40, 15
    v_and_b32 v1, 63, v0
    v_lshrrev_b32 v2, 6, v0
    s_nop 0
    v_readfirstlane_b32 s43, v2
    v_and_b32 v3, 15, v1
    v_lshrrev_b32 v4, 4, v1
    v_lshlrev_b32 v5, 4, v1
    s_lshl_b32 s46, s42, 18
    s_lshl_b32 s47, s43, 15
    s_add_u32 s46, s46, s47
    s_add_u32 s46, s46, 12582912
    s_add_u32 s48, s46, 0
    buffer_load_dwordx4 a[0:3], v5, s[4:7], s48 offen offset:0
    buffer_load_dwordx4 a[4:7], v5, s[4:7], s48 offen offset:1024
    buffer_load_dwordx4 a[8:11], v5, s[4:7], s48 offen offset:2048
    buffer_load_dwordx4 a[12:15], v5, s[4:7], s48 offen offset:3072
    s_add_u32 s48, s46, 4096
    buffer_load_dwordx4 a[16:19], v5, s[4:7], s48 offen offset:0
    buffer_load_dwordx4 a[20:23], v5, s[4:7], s48 offen offset:1024
    buffer_load_dwordx4 a[24:27], v5, s[4:7], s48 offen offset:2048
    buffer_load_dwordx4 a[28:31], v5, s[4:7], s48 offen offset:3072
    s_add_u32 s48, s46, 8192
    buffer_load_dwordx4 a[32:35], v5, s[4:7], s48 offen offset:0
    buffer_load_dwordx4 a[36:39], v5, s[4:7], s48 offen offset:1024
    buffer_load_dwordx4 a[40:43], v5, s[4:7], s48 offen offset:2048
    buffer_load_dwordx4 a[44:47], v5, s[4:7], s48 offen offset:3072
    s_add_u32 s48, s46, 12288
    buffer_load_dwordx4 a[48:51], v5, s[4:7], s48 offen offset:0
    buffer_load_dwordx4 a[52:55], v5, s[4:7], s48 offen offset:1024
    buffer_load_dwordx4 a[56:59], v5, s[4:7], s48 offen offset:2048
    buffer_load_dwordx4 a[60:63], v5, s[4:7], s48 offen offset:3072
    s_add_u32 s48, s46, 16384
    buffer_load_dwordx4 a[64:67], v5, s[4:7], s48 offen offset:0
    buffer_load_dwordx4 a[68:71], v5, s[4:7], s48 offen offset:1024
    buffer_load_dwordx4 a[72:75], v5, s[4:7], s48 offen offset:2048
    buffer_load_dwordx4 a[76:79], v5, s[4:7], s48 offen offset:3072
    s_add_u32 s48, s46, 20480
    buffer_load_dwordx4 a[80:83], v5, s[4:7], s48 offen offset:0
    buffer_load_dwordx4 a[84:87], v5, s[4:7], s48 offen offset:1024
    buffer_load_dwordx4 a[88:91], v5, s[4:7], s48 offen offset:2048
    buffer_load_dwordx4 a[92:95], v5, s[4:7], s48 offen offset:3072
    s_add_u32 s48, s46, 24576
    buffer_load_dwordx4 a[96:99], v5, s[4:7], s48 offen offset:0
    buffer_load_dwordx4 a[100:103], v5, s[4:7], s48 offen offset:1024
    buffer_load_dwordx4 a[104:107], v5, s[4:7], s48 offen offset:2048
    buffer_load_dwordx4 a[108:111], v5, s[4:7], s48 offen offset:3072
    s_add_u32 s48, s46, 28672
    buffer_load_dwordx4 a[112:115], v5, s[4:7], s48 offen offset:0
    buffer_load_dwordx4 a[116:119], v5, s[4:7], s48 offen offset:1024
    buffer_load_dwordx4 a[120:123], v5, s[4:7], s48 offen offset:2048
    buffer_load_dwordx4 a[124:127], v5, s[4:7], s48 offen offset:3072
    s_add_u32 s48, s46, 131072
    buffer_load_dwordx4 a[128:131], v5, s[4:7], s48 offen offset:0
    buffer_load_dwordx4 a[132:135], v5, s[4:7], s48 offen offset:1024
    buffer_load_dwordx4 a[136:139], v5, s[4:7], s48 offen offset:2048
    buffer_load_dwordx4 a[140:143], v5, s[4:7], s48 offen offset:3072
    s_add_u32 s48, s46, 135168
    buffer_load_dwordx4 a[144:147], v5, s[4:7], s48 offen offset:0
    buffer_load_dwordx4 a[148:151], v5, s[4:7], s48 offen offset:1024
    buffer_load_dwordx4 a[152:155], v5, s[4:7], s48 offen offset:2048
    buffer_load_dwordx4 a[156:159], v5, s[4:7], s48 offen offset:3072
    s_add_u32 s48, s46, 139264
    buffer_load_dwordx4 a[160:163], v5, s[4:7], s48 offen offset:0
    buffer_load_dwordx4 a[164:167], v5, s[4:7], s48 offen offset:1024
    buffer_load_dwordx4 a[168:171], v5, s[4:7], s48 offen offset:2048
    buffer_load_dwordx4 a[172:175], v5, s[4:7], s48 offen offset:3072
    s_add_u32 s48, s46, 143360
    buffer_load_dwordx4 a[176:179], v5, s[4:7], s48 offen offset:0
    buffer_load_dwordx4 a[180:183], v5, s[4:7], s48 offen offset:1024
    buffer_load_dwordx4 a[184:187], v5, s[4:7], s48 offen offset:2048
    buffer_load_dwordx4 a[188:191], v5, s[4:7], s48 offen offset:3072
    s_add_u32 s48, s46, 147456
    buffer_load_dwordx4 a[192:195], v5, s[4:7], s48 offen offset:0
    buffer_load_dwordx4 a[196:199], v5, s[4:7], s48 offen offset:1024
    buffer_load_dwordx4 a[200:203], v5, s[4:7], s48 offen offset:2048
    buffer_load_dwordx4 a[204:207], v5, s[4:7], s48 offen offset:3072
    s_add_u32 s48, s46, 151552
    buffer_load_dwordx4 a[208:211], v5, s[4:7], s48 offen offset:0
    buffer_load_dwordx4 a[212:215], v5, s[4:7], s48 offen offset:1024
    buffer_load_dwordx4 a[216:219], v5, s[4:7], s48 offen offset:2048
    buffer_load_dwordx4 a[220:223], v5, s[4:7], s48 offen offset:3072
    s_add_u32 s48, s46, 155648
    buffer_load_dwordx4 a[224:227], v5, s[4:7], s48 offen offset:0
    buffer_load_dwordx4 a[228:231], v5, s[4:7], s48 offen offset:1024
    buffer_load_dwordx4 a[232:235], v5, s[4:7], s48 offen offset:2048
    buffer_load_dwordx4 a[236:239], v5, s[4:7], s48 offen offset:3072
    s_add_u32 s48, s46, 159744
    buffer_load_dwordx4 a[240:243], v5, s[4:7], s48 offen offset:0
    buffer_load_dwordx4 a[244:247], v5, s[4:7], s48 offen offset:1024
    buffer_load_dwordx4 a[248:251], v5, s[4:7], s48 offen offset:2048
    buffer_load_dwordx4 a[252:255], v5, s[4:7], s48 offen offset:3072
    s_lshl_b32 s46, s41, 18
    s_add_u32 s46, s46, s47
    s_add_u32 s46, s46, 83886080
    s_add_u32 s46, s46, s88
    v_add_u32 v12, s46, v5
    v_add_u32 v13, 131072, v12
    v_lshlrev_b32 v6, 10, v3
    v_lshl_add_u32 v6, v4, 3, v6
    s_lshl_b32 s46, s41, 15
    s_and_b32 s47, s43, 1
    s_lshl_b32 s47, s47, 14
    s_add_u32 s46, s46, s47
    s_lshl_b32 s47, s42, 6
    s_add_u32 s46, s46, s47
    s_lshr_b32 s47, s43, 1
    s_lshl_b32 s47, s47, 5
    s_add_u32 s46, s46, s47
    s_lshl_b32 s47, s89, 22
    s_add_u32 s46, s46, s47
    s_add_u32 s47, s46, 23068672
    s_add_u32 s46, s46, 20971520
    s_lshl_b32 s86, s83, 2
    s_add_u32 s86, s86, 256
    s_mov_b32 s85, 0
poll_13:
    v_mov_b32 v254, s86
    buffer_load_dword v254, v254, s[4:7], s80 offen sc1
    s_waitcnt vmcnt(0)
    v_readfirstlane_b32 s84, v254
    s_cmp_ge_u32 s84, 32
    s_cbranch_scc1 poll_13_ok
    s_sleep 8
    s_add_u32 s85, s85, 1
    s_cmp_le_u32 s85, 262144
    s_cbranch_scc1 poll_13
poll_13_ok:
    buffer_load_dwordx2 v[96:97], v6, s[4:7], s46 offen sc1
    s_mov_b32 s98, 0
    buffer_load_dwordx4 v[16:19], v12, s[4:7], s98 offen offset:0 sc1
    buffer_load_dwordx4 v[20:23], v13, s[4:7], s98 offen offset:0 sc1
    buffer_load_dwordx4 v[24:27], v12, s[4:7], s98 offen offset:1024 sc1
    buffer_load_dwordx4 v[28:31], v13, s[4:7], s98 offen offset:1024 sc1
    buffer_load_dwordx4 v[32:35], v12, s[4:7], s98 offen offset:2048 sc1
    buffer_load_dwordx4 v[36:39], v13, s[4:7], s98 offen offset:2048 sc1
    buffer_load_dwordx4 v[40:43], v12, s[4:7], s98 offen offset:3072 sc1
    buffer_load_dwordx4 v[44:47], v13, s[4:7], s98 offen offset:3072 sc1
    s_mov_b32 s98, 4096
    buffer_load_dwordx4 v[48:51], v12, s[4:7], s98 offen offset:0 sc1
    buffer_load_dwordx4 v[52:55], v13, s[4:7], s98 offen offset:0 sc1
    buffer_load_dwordx4 v[56:59], v12, s[4:7], s98 offen offset:1024 sc1
    buffer_load_dwordx4 v[60:63], v13, s[4:7], s98 offen offset:1024 sc1
    s_waitcnt vmcnt(10)
    v_mfma_f32_16x16x32_bf16 v[128:131], a[0:3], v[16:19], 0
    v_mfma_f32_16x16x32_bf16 v[132:135], a[0:3], v[20:23], 0
    v_mfma_f32_16x16x32_bf16 v[136:139], a[128:131], v[16:19], 0
    v_mfma_f32_16x16x32_bf16 v[140:143], a[128:131], v[20:23], 0
    buffer_load_dwordx4 v[16:19], v12, s[4:7], s98 offen offset:2048 sc1
    buffer_load_dwordx4 v[20:23], v13, s[4:7], s98 offen offset:2048 sc1
    s_waitcnt vmcnt(10)
    v_mfma_f32_16x16x32_bf16 v[128:131], a[4:7], v[24:27], v[128:131]
    v_mfma_f32_16x16x32_bf16 v[132:135], a[4:7], v[28:31], v[132:135]
    v_mfma_f32_16x16x32_bf16 v[136:139], a[132:135], v[24:27], v[136:139]
    v_mfma_f32_16x16x32_bf16 v[140:143], a[132:135], v[28:31], v[140:143]
    buffer_load_dwordx4 v[24:27], v12, s[4:7], s98 offen offset:3072 sc1
    buffer_load_dwordx4 v[28:31], v13, s[4:7], s98 offen offset:3072 sc1
    s_waitcnt vmcnt(10)
    v_mfma_f32_16x16x32_bf16 v[128:131], a[8:11], v[32:35], v[128:131]
    v_mfma_f32_16x16x32_bf16 v[132:135], a[8:11], v[36:39], v[132:135]
    v_mfma_f32_16x16x32_bf16 v[136:139], a[136:139], v[32:35], v[136:139]
    v_mfma_f32_16x16x32_bf16 v[140:143], a[136:139], v[36:39], v[140:143]
    s_mov_b32 s98, 8192
    buffer_load_dwordx4 v[32:35], v12, s[4:7], s98 offen offset:0 sc1
    buffer_load_dwordx4 v[36:39], v13, s[4:7], s98 offen offset:0 sc1
    s_waitcnt vmcnt(10)
    v_mfma_f32_16x16x32_bf16 v[128:131], a[12:15], v[40:43], v[128:131]
    v_mfma_f32_16x16x32_bf16 v[132:135], a[12:15], v[44:47], v[132:135]
    v_mfma_f32_16x16x32_bf16 v[136:139], a[140:143], v[40:43], v[136:139]
    v_mfma_f32_16x16x32_bf16 v[140:143], a[140:143], v[44:47], v[140:143]
    buffer_load_dwordx4 v[40:43], v12, s[4:7], s98 offen offset:1024 sc1
    buffer_load_dwordx4 v[44:47], v13, s[4:7], s98 offen offset:1024 sc1
    s_waitcnt vmcnt(10)
    v_mfma_f32_16x16x32_bf16 v[128:131], a[16:19], v[48:51], v[128:131]
    v_mfma_f32_16x16x32_bf16 v[132:135], a[16:19], v[52:55], v[132:135]
    v_mfma_f32_16x16x32_bf16 v[136:139], a[144:147], v[48:51], v[136:139]
    v_mfma_f32_16x16x32_bf16 v[140:143], a[144:147], v[52:55], v[140:143]
    buffer_load_dwordx4 v[48:51], v12, s[4:7], s98 offen offset:2048 sc1
    buffer_load_dwordx4 v[52:55], v13, s[4:7], s98 offen offset:2048 sc1
    s_waitcnt vmcnt(10)
    v_mfma_f32_16x16x32_bf16 v[128:131], a[20:23], v[56:59], v[128:131]
    v_mfma_f32_16x16x32_bf16 v[132:135], a[20:23], v[60:63], v[132:135]
    v_mfma_f32_16x16x32_bf16 v[136:139], a[148:151], v[56:59], v[136:139]
    v_mfma_f32_16x16x32_bf16 v[140:143], a[148:151], v[60:63], v[140:143]
    buffer_load_dwordx4 v[56:59], v12, s[4:7], s98 offen offset:3072 sc1
    buffer_load_dwordx4 v[60:63], v13, s[4:7], s98 offen offset:3072 sc1
    s_waitcnt vmcnt(10)
    v_mfma_f32_16x16x32_bf16 v[128:131], a[24:27], v[16:19], v[128:131]
    v_mfma_f32_16x16x32_bf16 v[132:135], a[24:27], v[20:23], v[132:135]
    v_mfma_f32_16x16x32_bf16 v[136:139], a[152:155], v[16:19], v[136:139]
    v_mfma_f32_16x16x32_bf16 v[140:143], a[152:155], v[20:23], v[140:143]
    s_mov_b32 s98, 12288
    buffer_load_dwordx4 v[16:19], v12, s[4:7], s98 offen offset:0 sc1
    buffer_load_dwordx4 v[20:23], v13, s[4:7], s98 offen offset:0 sc1
    s_waitcnt vmcnt(10)
    v_mfma_f32_16x16x32_bf16 v[128:131], a[28:31], v[24:27], v[128:131]
    v_mfma_f32_16x16x32_bf16 v[132:135], a[28:31], v[28:31], v[132:135]
    v_mfma_f32_16x16x32_bf16 v[136:139], a[156:159], v[24:27], v[136:139]
    v_mfma_f32_16x16x32_bf16 v[140:143], a[156:159], v[28:31], v[140:143]
    buffer_load_dwordx4 v[24:27], v12, s[4:7], s98 offen offset:1024 sc1
    buffer_load_dwordx4 v[28:31], v13, s[4:7], s98 offen offset:1024 sc1
    s_waitcnt vmcnt(10)
    v_mfma_f32_16x16x32_bf16 v[128:131], a[32:35], v[32:35], v[128:131]
    v_mfma_f32_16x16x32_bf16 v[132:135], a[32:35], v[36:39], v[132:135]
    v_mfma_f32_16x16x32_bf16 v[136:139], a[160:163], v[32:35], v[136:139]
    v_mfma_f32_16x16x32_bf16 v[140:143], a[160:163], v[36:39], v[140:143]
    buffer_load_dwordx4 v[32:35], v12, s[4:7], s98 offen offset:2048 sc1
    buffer_load_dwordx4 v[36:39], v13, s[4:7], s98 offen offset:2048 sc1
    s_waitcnt vmcnt(10)
    v_mfma_f32_16x16x32_bf16 v[128:131], a[36:39], v[40:43], v[128:131]
    v_mfma_f32_16x16x32_bf16 v[132:135], a[36:39], v[44:47], v[132:135]
    v_mfma_f32_16x16x32_bf16 v[136:139], a[164:167], v[40:43], v[136:139]
    v_mfma_f32_16x16x32_bf16 v[140:143], a[164:167], v[44:47], v[140:143]
    buffer_load_dwordx4 v[40:43], v12, s[4:7], s98 offen offset:3072 sc1
    buffer_load_dwordx4 v[44:47], v13, s[4:7], s98 offen offset:3072 sc1
    s_waitcnt vmcnt(10)
    v_mfma_f32_16x16x32_bf16 v[128:131], a[40:43], v[48:51], v[128:131]
    v_mfma_f32_16x16x32_bf16 v[132:135], a[40:43], v[52:55], v[132:135]
    v_mfma_f32_16x16x32_bf16 v[136:139], a[168:171], v[48:51], v[136:139]
    v_mfma_f32_16x16x32_bf16 v[140:143], a[168:171], v[52:55], v[140:143]
    s_mov_b32 s98, 16384
    buffer_load_dwordx4 v[48:51], v12, s[4:7], s98 offen offset:0 sc1
    buffer_load_dwordx4 v[52:55], v13, s[4:7], s98 offen offset:0 sc1
    s_waitcnt vmcnt(10)
    v_mfma_f32_16x16x32_bf16 v[128:131], a[44:47], v[56:59], v[128:131]
    v_mfma_f32_16x16x32_bf16 v[132:135], a[44:47], v[60:63], v[132:135]
    v_mfma_f32_16x16x32_bf16 v[136:139], a[172:175], v[56:59], v[136:139]
    v_mfma_f32_16x16x32_bf16 v[140:143], a[172:175], v[60:63], v[140:143]
    buffer_load_dwordx4 v[56:59], v12, s[4:7], s98 offen offset:1024 sc1
    buffer_load_dwordx4 v[60:63], v13, s[4:7], s98 offen offset:1024 sc1
    s_waitcnt vmcnt(10)
    v_mfma_f32_16x16x32_bf16 v[128:131], a[48:51], v[16:19], v[128:131]
    v_mfma_f32_16x16x32_bf16 v[132:135], a[48:51], v[20:23], v[132:135]
    v_mfma_f32_16x16x32_bf16 v[136:139], a[176:179], v[16:19], v[136:139]
    v_mfma_f32_16x16x32_bf16 v[140:143], a[176:179], v[20:23], v[140:143]
    buffer_load_dwordx4 v[16:19], v12, s[4:7], s98 offen offset:2048 sc1
    buffer_load_dwordx4 v[20:23], v13, s[4:7], s98 offen offset:2048 sc1
    s_waitcnt vmcnt(10)
    v_mfma_f32_16x16x32_bf16 v[128:131], a[52:55], v[24:27], v[128:131]
    v_mfma_f32_16x16x32_bf16 v[132:135], a[52:55], v[28:31], v[132:135]
    v_mfma_f32_16x16x32_bf16 v[136:139], a[180:183], v[24:27], v[136:139]
    v_mfma_f32_16x16x32_bf16 v[140:143], a[180:183], v[28:31], v[140:143]
    buffer_load_dwordx4 v[24:27], v12, s[4:7], s98 offen offset:3072 sc1
    buffer_load_dwordx4 v[28:31], v13, s[4:7], s98 offen offset:3072 sc1
    s_waitcnt vmcnt(10)
    v_mfma_f32_16x16x32_bf16 v[128:131], a[56:59], v[32:35], v[128:131]
    v_mfma_f32_16x16x32_bf16 v[132:135], a[56:59], v[36:39], v[132:135]
    v_mfma_f32_16x16x32_bf16 v[136:139], a[184:187], v[32:35], v[136:139]
    v_mfma_f32_16x16x32_bf16 v[140:143], a[184:187], v[36:39], v[140:143]
    s_mov_b32 s98, 20480
    buffer_load_dwordx4 v[32:35], v12, s[4:7], s98 offen offset:0 sc1
    buffer_load_dwordx4 v[36:39], v13, s[4:7], s98 offen offset:0 sc1
    s_waitcnt vmcnt(10)
    v_mfma_f32_16x16x32_bf16 v[128:131], a[60:63], v[40:43], v[128:131]
    v_mfma_f32_16x16x32_bf16 v[132:135], a[60:63], v[44:47], v[132:135]
    v_mfma_f32_16x16x32_bf16 v[136:139], a[188:191], v[40:43], v[136:139]
    v_mfma_f32_16x16x32_bf16 v[140:143], a[188:191], v[44:47], v[140:143]
    buffer_load_dwordx4 v[40:43], v12, s[4:7], s98 offen offset:1024 sc1
    buffer_load_dwordx4 v[44:47], v13, s[4:7], s98 offen offset:1024 sc1
    s_waitcnt vmcnt(10)
    v_mfma_f32_16x16x32_bf16 v[128:131], a[64:67], v[48:51], v[128:131]
    v_mfma_f32_16x16x32_bf16 v[132:135], a[64:67], v[52:55], v[132:135]
    v_mfma_f32_16x16x32_bf16 v[136:139], a[192:195], v[48:51], v[136:139]
    v_mfma_f32_16x16x32_bf16 v[140:143], a[192:195], v[52:55], v[140:143]
    buffer_load_dwordx4 v[48:51], v12, s[4:7], s98 offen offset:2048 sc1
    buffer_load_dwordx4 v[52:55], v13, s[4:7], s98 offen offset:2048 sc1
    s_waitcnt vmcnt(10)
    v_mfma_f32_16x16x32_bf16 v[128:131], a[68:71], v[56:59], v[128:131]
    v_mfma_f32_16x16x32_bf16 v[132:135], a[68:71], v[60:63], v[132:135]
    v_mfma_f32_16x16x32_bf16 v[136:139], a[196:199], v[56:59], v[136:139]
    v_mfma_f32_16x16x32_bf16 v[140:143], a[196:199], v[60:63], v[140:143]
    buffer_load_dwordx4 v[56:59], v12, s[4:7], s98 offen offset:3072 sc1
    buffer_load_dwordx4 v[60:63], v13, s[4:7], s98 offen offset:3072 sc1
    s_waitcnt vmcnt(10)
    v_mfma_f32_16x16x32_bf16 v[128:131], a[72:75], v[16:19], v[128:131]
    v_mfma_f32_16x16x32_bf16 v[132:135], a[72:75], v[20:23], v[132:135]
    v_mfma_f32_16x16x32_bf16 v[136:139], a[200:203], v[16:19], v[136:139]
    v_mfma_f32_16x16x32_bf16 v[140:143], a[200:203], v[20:23], v[140:143]
    s_mov_b32 s98, 24576
    buffer_load_dwordx4 v[16:19], v12, s[4:7], s98 offen offset:0 sc1
    buffer_load_dwordx4 v[20:23], v13, s[4:7], s98 offen offset:0 sc1
    s_waitcnt vmcnt(10)
    v_mfma_f32_16x16x32_bf16 v[128:131], a[76:79], v[24:27], v[128:131]
    v_mfma_f32_16x16x32_bf16 v[132:135], a[76:79], v[28:31], v[132:135]
    v_mfma_f32_16x16x32_bf16 v[136:139], a[204:207], v[24:27], v[136:139]
    v_mfma_f32_16x16x32_bf16 v[140:143], a[204:207], v[28:31], v[140:143]
    buffer_load_dwordx4 v[24:27], v12, s[4:7], s98 offen offset:1024 sc1
    buffer_load_dwordx4 v[28:31], v13, s[4:7], s98 offen offset:1024 sc1
    s_waitcnt vmcnt(10)
    v_mfma_f32_16x16x32_bf16 v[128:131], a[80:83], v[32:35], v[128:131]
    v_mfma_f32_16x16x32_bf16 v[132:135], a[80:83], v[36:39], v[132:135]
    v_mfma_f32_16x16x32_bf16 v[136:139], a[208:211], v[32:35], v[136:139]
    v_mfma_f32_16x16x32_bf16 v[140:143], a[208:211], v[36:39], v[140:143]
    buffer_load_dwordx4 v[32:35], v12, s[4:7], s98 offen offset:2048 sc1
    buffer_load_dwordx4 v[36:39], v13, s[4:7], s98 offen offset:2048 sc1
    s_waitcnt vmcnt(10)
    v_mfma_f32_16x16x32_bf16 v[128:131], a[84:87], v[40:43], v[128:131]
    v_mfma_f32_16x16x32_bf16 v[132:135], a[84:87], v[44:47], v[132:135]
    v_mfma_f32_16x16x32_bf16 v[136:139], a[212:215], v[40:43], v[136:139]
    v_mfma_f32_16x16x32_bf16 v[140:143], a[212:215], v[44:47], v[140:143]
    buffer_load_dwordx4 v[40:43], v12, s[4:7], s98 offen offset:3072 sc1
    buffer_load_dwordx4 v[44:47], v13, s[4:7], s98 offen offset:3072 sc1
    s_waitcnt vmcnt(10)
    v_mfma_f32_16x16x32_bf16 v[128:131], a[88:91], v[48:51], v[128:131]
    v_mfma_f32_16x16x32_bf16 v[132:135], a[88:91], v[52:55], v[132:135]
    v_mfma_f32_16x16x32_bf16 v[136:139], a[216:219], v[48:51], v[136:139]
    v_mfma_f32_16x16x32_bf16 v[140:143], a[216:219], v[52:55], v[140:143]
    s_mov_b32 s98, 28672
    buffer_load_dwordx4 v[48:51], v12, s[4:7], s98 offen offset:0 sc1
    buffer_load_dwordx4 v[52:55], v13, s[4:7], s98 offen offset:0 sc1
    s_waitcnt vmcnt(10)
    v_mfma_f32_16x16x32_bf16 v[128:131], a[92:95], v[56:59], v[128:131]
    v_mfma_f32_16x16x32_bf16 v[132:135], a[92:95], v[60:63], v[132:135]
    v_mfma_f32_16x16x32_bf16 v[136:139], a[220:223], v[56:59], v[136:139]
    v_mfma_f32_16x16x32_bf16 v[140:143], a[220:223], v[60:63], v[140:143]
    buffer_load_dwordx4 v[56:59], v12, s[4:7], s98 offen offset:1024 sc1
    buffer_load_dwordx4 v[60:63], v13, s[4:7], s98 offen offset:1024 sc1
    s_waitcnt vmcnt(10)
    v_mfma_f32_16x16x32_bf16 v[128:131], a[96:99], v[16:19], v[128:131]
    v_mfma_f32_16x16x32_bf16 v[132:135], a[96:99], v[20:23], v[132:135]
    v_mfma_f32_16x16x32_bf16 v[136:139], a[224:227], v[16:19], v[136:139]
    v_mfma_f32_16x16x32_bf16 v[140:143], a[224:227], v[20:23], v[140:143]
    buffer_load_dwordx4 v[16:19], v12, s[4:7], s98 offen offset:2048 sc1
    buffer_load_dwordx4 v[20:23], v13, s[4:7], s98 offen offset:2048 sc1
    s_waitcnt vmcnt(10)
    v_mfma_f32_16x16x32_bf16 v[128:131], a[100:103], v[24:27], v[128:131]
    v_mfma_f32_16x16x32_bf16 v[132:135], a[100:103], v[28:31], v[132:135]
    v_mfma_f32_16x16x32_bf16 v[136:139], a[228:231], v[24:27], v[136:139]
    v_mfma_f32_16x16x32_bf16 v[140:143], a[228:231], v[28:31], v[140:143]
    buffer_load_dwordx4 v[24:27], v12, s[4:7], s98 offen offset:3072 sc1
    buffer_load_dwordx4 v[28:31], v13, s[4:7], s98 offen offset:3072 sc1
    s_waitcnt vmcnt(10)
    v_mfma_f32_16x16x32_bf16 v[128:131], a[104:107], v[32:35], v[128:131]
    v_mfma_f32_16x16x32_bf16 v[132:135], a[104:107], v[36:39], v[132:135]
    v_mfma_f32_16x16x32_bf16 v[136:139], a[232:235], v[32:35], v[136:139]
    v_mfma_f32_16x16x32_bf16 v[140:143], a[232:235], v[36:39], v[140:143]
    s_waitcnt vmcnt(8)
    v_mfma_f32_16x16x32_bf16 v[128:131], a[108:111], v[40:43], v[128:131]
    v_mfma_f32_16x16x32_bf16 v[132:135], a[108:111], v[44:47], v[132:135]
    v_mfma_f32_16x16x32_bf16 v[136:139], a[236:239], v[40:43], v[136:139]
    v_mfma_f32_16x16x32_bf16 v[140:143], a[236:239], v[44:47], v[140:143]
    s_waitcnt vmcnt(6)
    v_mfma_f32_16x16x32_bf16 v[128:131], a[112:115], v[48:51], v[128:131]
    v_mfma_f32_16x16x32_bf16 v[132:135], a[112:115], v[52:55], v[132:135]
    v_mfma_f32_16x16x32_bf16 v[136:139], a[240:243], v[48:51], v[136:139]
    v_mfma_f32_16x16x32_bf16 v[140:143], a[240:243], v[52:55], v[140:143]
    s_waitcnt vmcnt(4)
    v_mfma_f32_16x16x32_bf16 v[128:131], a[116:119], v[56:59], v[128:131]
    v_mfma_f32_16x16x32_bf16 v[132:135], a[116:119], v[60:63], v[132:135]
    v_mfma_f32_16x16x32_bf16 v[136:139], a[244:247], v[56:59], v[136:139]
    v_mfma_f32_16x16x32_bf16 v[140:143], a[244:247], v[60:63], v[140:143]
    s_waitcnt vmcnt(2)
    v_mfma_f32_16x16x32_bf16 v[128:131], a[120:123], v[16:19], v[128:131]
    v_mfma_f32_16x16x32_bf16 v[132:135], a[120:123], v[20:23], v[132:135]
    v_mfma_f32_16x16x32_bf16 v[136:139], a[248:251], v[16:19], v[136:139]
    v_mfma_f32_16x16x32_bf16 v[140:143], a[248:251], v[20:23], v[140:143]
    s_waitcnt vmcnt(0)
    v_mfma_f32_16x16x32_bf16 v[128:131], a[124:127], v[24:27], v[128:131]
    v_mfma_f32_16x16x32_bf16 v[132:135], a[124:127], v[28:31], v[132:135]
    v_mfma_f32_16x16x32_bf16 v[136:139], a[252:255], v[24:27], v[136:139]
    v_mfma_f32_16x16x32_bf16 v[140:143], a[252:255], v[28:31], v[140:143]
    s_lshl_b32 s44, s43, 12
    v_add_u32 v8, s44, v5
    s_nop 2
    ds_write_b128 v8, v[128:131] offset:0
    ds_write_b128 v8, v[132:135] offset:1024
    ds_write_b128 v8, v[136:139] offset:2048
    ds_write_b128 v8, v[140:143] offset:3072
    s_waitcnt lgkmcnt(0)
    s_barrier
    s_lshl_b32 s44, s43, 10
    v_add_u32 v8, s44, v5
    ds_read_b128 v[16:19], v8 offset:0
    ds_read_b128 v[20:23], v8 offset:4096
    ds_read_b128 v[24:27], v8 offset:8192
    ds_read_b128 v[28:31], v8 offset:12288
    s_waitcnt lgkmcnt(0)
    v_add_f32 v16, v16, v20
    v_add_f32 v24, v24, v28
    v_add_f32 v16, v16, v24
    v_add_f32 v17, v17, v21
    v_add_f32 v25, v25, v29
    v_add_f32 v17, v17, v25
    v_add_f32 v18, v18, v22
    v_add_f32 v26, v26, v30
    v_add_f32 v18, v18, v26
    v_add_f32 v19, v19, v23
    v_add_f32 v27, v27, v31
    v_add_f32 v19, v19, v27
    v_cvt_pk_bf16_f32 v9, v16, v17
    v_lshlrev_b32 v16, 16, v9
    v_and_b32 v17, 0xffff0000, v9
    v_cvt_pk_bf16_f32 v9, v18, v19
    v_lshlrev_b32 v18, 16, v9
    v_and_b32 v19, 0xffff0000, v9
    v_lshlrev_b32 v9, 16, v96
    v_add_f32 v16, v16, v9
    v_and_b32 v9, 0xffff0000, v96
    v_add_f32 v17, v17, v9
    v_lshlrev_b32 v9, 16, v97
    v_add_f32 v18, v18, v9
    v_and_b32 v9, 0xffff0000, v97
    v_add_f32 v19, v19, v9
    v_cvt_pk_bf16_f32 v96, v16, v17
    v_cvt_pk_bf16_f32 v97, v18, v19
    buffer_store_dwordx2 v[96:97], v6, s[4:7], s47 offen offset:0 sc1
    s_waitcnt vmcnt(0)
    s_barrier
    s_cmp_lg_u32 s14, 0
    s_cbranch_scc1 mega_kernel_x1w
    s_mov_b64 exec, 1
    s_lshl_b32 s82, s41, 2
    s_add_u32 s82, s82, 768
    v_mov_b32 v2, s82
    v_mov_b32 v3, 1
    buffer_atomic_add v3, v2, s[4:7], s80 offen sc0
    s_waitcnt vmcnt(0)
    v_mov_b32 v2, 163712
    ds_write_b32 v2, v3
    s_waitcnt lgkmcnt(0)
    s_mov_b64 exec, -1
mega_kernel_x1w:
    s_barrier
    v_mov_b32 v2, 163712
    ds_read_b32 v3, v2
    s_waitcnt lgkmcnt(0)
    v_readfirstlane_b32 s82, v3
    s_cmp_lg_u32 s82, 15
    s_cbranch_scc1 mega_kernel_next
    s_lshl_b32 s40, s41, 1
    v_and_b32 v1, 63, v0
    v_lshlrev_b32 v2, 4, v1
    s_lshl_b32 s46, s40, 14
    s_lshl_b32 s47, s14, 12
    s_add_u32 s46, s46, s47
    s_lshl_b32 s47, s89, 22
    s_add_u32 s46, s46, s47
    s_add_u32 s46, s46, 23068672
    buffer_load_dwordx4 v[32:35], v2, s[4:7], s46 offen offset:0 sc1
    buffer_load_dwordx4 v[36:39], v2, s[4:7], s46 offen offset:1024 sc1
    buffer_load_dwordx4 v[40:43], v2, s[4:7], s46 offen offset:2048 sc1
    buffer_load_dwordx4 v[44:47], v2, s[4:7], s46 offen offset:3072 sc1
    v_lshrrev_b32 v22, 2, v1
    v_lshlrev_b32 v23, 10, v22
    v_and_b32 v22, 3, v1
    v_lshl_add_u32 v23, v22, 8, v23
    s_lshl_b32 s46, s40, 14
    s_lshl_b32 s47, s14, 6
    s_add_u32 s46, s46, s47
    s_add_u32 s46, s46, s88
    s_add_u32 s46, s46, 31457280
    s_waitcnt vmcnt(3)
    v_mov_b32 v4, v32
    v_mov_b32 v5, v33
    v_mov_b32 v6, v34
    v_mov_b32 v7, v35
    v_lshlrev_b32 v8, 16, v4
    v_and_b32 v9, 0xffff0000, v4
    v_lshlrev_b32 v10, 16, v5
    v_and_b32 v11, 0xffff0000, v5
    v_lshlrev_b32 v12, 16, v6
    v_and_b32 v13, 0xffff0000, v6
    v_lshlrev_b32 v14, 16, v7
    v_and_b32 v15, 0xffff0000, v7
    v_add_f32 v16, v8, v9
    v_add_f32 v16, v16, v10
    v_add_f32 v16, v16, v11
    v_add_f32 v16, v16, v12
    v_add_f32 v16, v16, v13
    v_add_f32 v16, v16, v14
    v_add_f32 v16, v16, v15
    s_nop 1
    v_add_f32_dpp v16, v16, v16 quad_perm:[1,0,3,2] row_mask:0xf bank_mask:0xf
    s_nop 1
    v_add_f32_dpp v16, v16, v16 quad_perm:[2,3,0,1] row_mask:0xf bank_mask:0xf
    s_nop 1
    v_add_f32_dpp v16, v16, v16 row_half_mirror row_mask:0xf bank_mask:0xf
    s_nop 1
    v_add_f32_dpp v16, v16, v16 row_mirror row_mask:0xf bank_mask:0xf
    v_mov_b32 v17, v16
    s_nop 1
    v_permlane16_swap_b32 v16, v17
    v_add_f32 v16, v16, v17
    v_mov_b32 v17, v16
    s_nop 1
    v_permlane32_swap_b32 v16, v17
    v_add_f32 v16, v16, v17
    v_mul_f32 v16, 0x3b000000, v16
    v_mov_b32 v18, 0
    v_sub_f32 v17, v8, v16
    v_fmac_f32 v18, v17, v17
    v_sub_f32 v17, v9, v16
    v_fmac_f32 v18, v17, v17
    v_sub_f32 v17, v10, v16
    v_fmac_f32 v18, v17, v17
    v_sub_f32 v17, v11, v16
    v_fmac_f32 v18, v17, v17
    v_sub_f32 v17, v12, v16
    v_fmac_f32 v18, v17, v17
    v_sub_f32 v17, v13, v16
    v_fmac_f32 v18, v17, v17
    v_sub_f32 v17, v14, v16
    v_fmac_f32 v18, v17, v17
    v_sub_f32 v17, v15, v16
    v_fmac_f32 v18, v17, v17
    s_nop 1
    v_add_f32_dpp v18, v18, v18 quad_perm:[1,0,3,2] row_mask:0xf bank_mask:0xf
    s_nop 1
    v_add_f32_dpp v18, v18, v18 quad_perm:[2,3,0,1] row_mask:0xf bank_mask:0xf
    s_nop 1
    v_add_f32_dpp v18, v18, v18 row_half_mirror row_mask:0xf bank_mask:0xf
    s_nop 1
    v_add_f32_dpp v18, v18, v18 row_mirror row_mask:0xf bank_mask:0xf
    v_mov_b32 v17, v18
    s_nop 1
    v_permlane16_swap_b32 v18, v17
    v_add_f32 v18, v18, v17
    v_mov_b32 v17, v18
    s_nop 1
    v_permlane32_swap_b32 v18, v17
    v_add_f32 v18, v18, v17
    v_mul_f32 v18, 0x3b000000, v18
    v_cvt_pk_bf16_f32 v17, v18, v18
    v_lshlrev_b32 v18, 16, v17
    v_add_f32 v18, 0x3727c5ac, v18
    v_cvt_pk_bf16_f32 v17, v18, v18
    v_lshlrev_b32 v18, 16, v17
    v_sqrt_f32 v18, v18
    s_nop 0
    v_cvt_pk_bf16_f32 v17, v18, v18
    v_lshlrev_b32 v18, 16, v17
    v_cvt_pk_bf16_f32 v17, v16, v16
    v_lshlrev_b32 v16, 16, v17
    v_rcp_f32 v19, v18
    v_sub_f32 v8, v8, v16
    v_sub_f32 v9, v9, v16
    v_cvt_pk_bf16_f32 v17, v8, v9
    v_lshlrev_b32 v8, 16, v17
    v_and_b32 v9, 0xffff0000, v17
    v_mul_f32 v20, v8, v19
    v_fma_f32 v21, -v20, v18, v8
    v_fma_f32 v8, v21, v19, v20
    v_mul_f32 v20, v9, v19
    v_fma_f32 v21, -v20, v18, v9
    v_fma_f32 v9, v21, v19, v20
    v_cvt_pk_bf16_f32 v48, v8, v9
    v_sub_f32 v10, v10, v16
    v_sub_f32 v11, v11, v16
    v_cvt_pk_bf16_f32 v17, v10, v11
    v_lshlrev_b32 v10, 16, v17
    v_and_b32 v11, 0xffff0000, v17
    v_mul_f32 v20, v10, v19
    v_fma_f32 v21, -v20, v18, v10
    v_fma_f32 v10, v21, v19, v20
    v_mul_f32 v20, v11, v19
    v_fma_f32 v21, -v20, v18, v11
    v_fma_f32 v11, v21, v19, v20
    v_cvt_pk_bf16_f32 v49, v10, v11
    v_sub_f32 v12, v12, v16
    v_sub_f32 v13, v13, v16
    v_cvt_pk_bf16_f32 v17, v12, v13
    v_lshlrev_b32 v12, 16, v17
    v_and_b32 v13, 0xffff0000, v17
    v_mul_f32 v20, v12, v19
    v_fma_f32 v21, -v20, v18, v12
    v_fma_f32 v12, v21, v19, v20
    v_mul_f32 v20, v13, v19
    v_fma_f32 v21, -v20, v18, v13
    v_fma_f32 v13, v21, v19, v20
    v_cvt_pk_bf16_f32 v50, v12, v13
    v_sub_f32 v14, v14, v16
    v_sub_f32 v15, v15, v16
    v_cvt_pk_bf16_f32 v17, v14, v15
    v_lshlrev_b32 v14, 16, v17
    v_and_b32 v15, 0xffff0000, v17
    v_mul_f32 v20, v14, v19
    v_fma_f32 v21, -v20, v18, v14
    v_fma_f32 v14, v21, v19, v20
    v_mul_f32 v20, v15, v19
    v_fma_f32 v21, -v20, v18, v15
    v_fma_f32 v15, v21, v19, v20
    v_cvt_pk_bf16_f32 v51, v14, v15
    buffer_store_dwordx4 v[48:51], v23, s[4:7], s46 offen offset:0 sc1
    s_waitcnt vmcnt(3)
    v_mov_b32 v4, v36
    v_mov_b32 v5, v37
    v_mov_b32 v6, v38
    v_mov_b32 v7, v39
    v_lshlrev_b32 v8, 16, v4
    v_and_b32 v9, 0xffff0000, v4
    v_lshlrev_b32 v10, 16, v5
    v_and_b32 v11, 0xffff0000, v5
    v_lshlrev_b32 v12, 16, v6
    v_and_b32 v13, 0xffff0000, v6
    v_lshlrev_b32 v14, 16, v7
    v_and_b32 v15, 0xffff0000, v7
    v_add_f32 v16, v8, v9
    v_add_f32 v16, v16, v10
    v_add_f32 v16, v16, v11
    v_add_f32 v16, v16, v12
    v_add_f32 v16, v16, v13
    v_add_f32 v16, v16, v14
    v_add_f32 v16, v16, v15
    s_nop 1
    v_add_f32_dpp v16, v16, v16 quad_perm:[1,0,3,2] row_mask:0xf bank_mask:0xf
    s_nop 1
    v_add_f32_dpp v16, v16, v16 quad_perm:[2,3,0,1] row_mask:0xf bank_mask:0xf
    s_nop 1
    v_add_f32_dpp v16, v16, v16 row_half_mirror row_mask:0xf bank_mask:0xf
    s_nop 1
    v_add_f32_dpp v16, v16, v16 row_mirror row_mask:0xf bank_mask:0xf
    v_mov_b32 v17, v16
    s_nop 1
    v_permlane16_swap_b32 v16, v17
    v_add_f32 v16, v16, v17
    v_mov_b32 v17, v16
    s_nop 1
    v_permlane32_swap_b32 v16, v17
    v_add_f32 v16, v16, v17
    v_mul_f32 v16, 0x3b000000, v16
    v_mov_b32 v18, 0
    v_sub_f32 v17, v8, v16
    v_fmac_f32 v18, v17, v17
    v_sub_f32 v17, v9, v16
    v_fmac_f32 v18, v17, v17
    v_sub_f32 v17, v10, v16
    v_fmac_f32 v18, v17, v17
    v_sub_f32 v17, v11, v16
    v_fmac_f32 v18, v17, v17
    v_sub_f32 v17, v12, v16
    v_fmac_f32 v18, v17, v17
    v_sub_f32 v17, v13, v16
    v_fmac_f32 v18, v17, v17
    v_sub_f32 v17, v14, v16
    v_fmac_f32 v18, v17, v17
    v_sub_f32 v17, v15, v16
    v_fmac_f32 v18, v17, v17
    s_nop 1
    v_add_f32_dpp v18, v18, v18 quad_perm:[1,0,3,2] row_mask:0xf bank_mask:0xf
    s_nop 1
    v_add_f32_dpp v18, v18, v18 quad_perm:[2,3,0,1] row_mask:0xf bank_mask:0xf
    s_nop 1
    v_add_f32_dpp v18, v18, v18 row_half_mirror row_mask:0xf bank_mask:0xf
    s_nop 1
    v_add_f32_dpp v18, v18, v18 row_mirror row_mask:0xf bank_mask:0xf
    v_mov_b32 v17, v18
    s_nop 1
    v_permlane16_swap_b32 v18, v17
    v_add_f32 v18, v18, v17
    v_mov_b32 v17, v18
    s_nop 1
    v_permlane32_swap_b32 v18, v17
    v_add_f32 v18, v18, v17
    v_mul_f32 v18, 0x3b000000, v18
    v_cvt_pk_bf16_f32 v17, v18, v18
    v_lshlrev_b32 v18, 16, v17
    v_add_f32 v18, 0x3727c5ac, v18
    v_cvt_pk_bf16_f32 v17, v18, v18
    v_lshlrev_b32 v18, 16, v17
    v_sqrt_f32 v18, v18
    s_nop 0
    v_cvt_pk_bf16_f32 v17, v18, v18
    v_lshlrev_b32 v18, 16, v17
    v_cvt_pk_bf16_f32 v17, v16, v16
    v_lshlrev_b32 v16, 16, v17
    v_rcp_f32 v19, v18
    v_sub_f32 v8, v8, v16
    v_sub_f32 v9, v9, v16
    v_cvt_pk_bf16_f32 v17, v8, v9
    v_lshlrev_b32 v8, 16, v17
    v_and_b32 v9, 0xffff0000, v17
    v_mul_f32 v20, v8, v19
    v_fma_f32 v21, -v20, v18, v8
    v_fma_f32 v8, v21, v19, v20
    v_mul_f32 v20, v9, v19
    v_fma_f32 v21, -v20, v18, v9
    v_fma_f32 v9, v21, v19, v20
    v_cvt_pk_bf16_f32 v52, v8, v9
    v_sub_f32 v10, v10, v16
    v_sub_f32 v11, v11, v16
    v_cvt_pk_bf16_f32 v17, v10, v11
    v_lshlrev_b32 v10, 16, v17
    v_and_b32 v11, 0xffff0000, v17
    v_mul_f32 v20, v10, v19
    v_fma_f32 v21, -v20, v18, v10
    v_fma_f32 v10, v21, v19, v20
    v_mul_f32 v20, v11, v19
    v_fma_f32 v21, -v20, v18, v11
    v_fma_f32 v11, v21, v19, v20
    v_cvt_pk_bf16_f32 v53, v10, v11
    v_sub_f32 v12, v12, v16
    v_sub_f32 v13, v13, v16
    v_cvt_pk_bf16_f32 v17, v12, v13
    v_lshlrev_b32 v12, 16, v17
    v_and_b32 v13, 0xffff0000, v17
    v_mul_f32 v20, v12, v19
    v_fma_f32 v21, -v20, v18, v12
    v_fma_f32 v12, v21, v19, v20
    v_mul_f32 v20, v13, v19
    v_fma_f32 v21, -v20, v18, v13
    v_fma_f32 v13, v21, v19, v20
    v_cvt_pk_bf16_f32 v54, v12, v13
    v_sub_f32 v14, v14, v16
    v_sub_f32 v15, v15, v16
    v_cvt_pk_bf16_f32 v17, v14, v15
    v_lshlrev_b32 v14, 16, v17
    v_and_b32 v15, 0xffff0000, v17
    v_mul_f32 v20, v14, v19
    v_fma_f32 v21, -v20, v18, v14
    v_fma_f32 v14, v21, v19, v20
    v_mul_f32 v20, v15, v19
    v_fma_f32 v21, -v20, v18, v15
    v_fma_f32 v15, v21, v19, v20
    v_cvt_pk_bf16_f32 v55, v14, v15
    buffer_store_dwordx4 v[52:55], v23, s[4:7], s46 offen offset:16 sc1
    s_waitcnt vmcnt(3)
    v_mov_b32 v4, v40
    v_mov_b32 v5, v41
    v_mov_b32 v6, v42
    v_mov_b32 v7, v43
    v_lshlrev_b32 v8, 16, v4
    v_and_b32 v9, 0xffff0000, v4
    v_lshlrev_b32 v10, 16, v5
    v_and_b32 v11, 0xffff0000, v5
    v_lshlrev_b32 v12, 16, v6
    v_and_b32 v13, 0xffff0000, v6
    v_lshlrev_b32 v14, 16, v7
    v_and_b32 v15, 0xffff0000, v7
    v_add_f32 v16, v8, v9
    v_add_f32 v16, v16, v10
    v_add_f32 v16, v16, v11
    v_add_f32 v16, v16, v12
    v_add_f32 v16, v16, v13
    v_add_f32 v16, v16, v14
    v_add_f32 v16, v16, v15
    s_nop 1
    v_add_f32_dpp v16, v16, v16 quad_perm:[1,0,3,2] row_mask:0xf bank_mask:0xf
    s_nop 1
    v_add_f32_dpp v16, v16, v16 quad_perm:[2,3,0,1] row_mask:0xf bank_mask:0xf
    s_nop 1
    v_add_f32_dpp v16, v16, v16 row_half_mirror row_mask:0xf bank_mask:0xf
    s_nop 1
    v_add_f32_dpp v16, v16, v16 row_mirror row_mask:0xf bank_mask:0xf
    v_mov_b32 v17, v16
    s_nop 1
    v_permlane16_swap_b32 v16, v17
    v_add_f32 v16, v16, v17
    v_mov_b32 v17, v16
    s_nop 1
    v_permlane32_swap_b32 v16, v17
    v_add_f32 v16, v16, v17
    v_mul_f32 v16, 0x3b000000, v16
    v_mov_b32 v18, 0
    v_sub_f32 v17, v8, v16
    v_fmac_f32 v18, v17, v17
    v_sub_f32 v17, v9, v16
    v_fmac_f32 v18, v17, v17
    v_sub_f32 v17, v10, v16
    v_fmac_f32 v18, v17, v17
    v_sub_f32 v17, v11, v16
    v_fmac_f32 v18, v17, v17
    v_sub_f32 v17, v12, v16
    v_fmac_f32 v18, v17, v17
    v_sub_f32 v17, v13, v16
    v_fmac_f32 v18, v17, v17
    v_sub_f32 v17, v14, v16
    v_fmac_f32 v18, v17, v17
    v_sub_f32 v17, v15, v16
    v_fmac_f32 v18, v17, v17
    s_nop 1
    v_add_f32_dpp v18, v18, v18 quad_perm:[1,0,3,2] row_mask:0xf bank_mask:0xf
    s_nop 1
    v_add_f32_dpp v18, v18, v18 quad_perm:[2,3,0,1] row_mask:0xf bank_mask:0xf
    s_nop 1
    v_add_f32_dpp v18, v18, v18 row_half_mirror row_mask:0xf bank_mask:0xf
    s_nop 1
    v_add_f32_dpp v18, v18, v18 row_mirror row_mask:0xf bank_mask:0xf
    v_mov_b32 v17, v18
    s_nop 1
    v_permlane16_swap_b32 v18, v17
    v_add_f32 v18, v18, v17
    v_mov_b32 v17, v18
    s_nop 1
    v_permlane32_swap_b32 v18, v17
    v_add_f32 v18, v18, v17
    v_mul_f32 v18, 0x3b000000, v18
    v_cvt_pk_bf16_f32 v17, v18, v18
    v_lshlrev_b32 v18, 16, v17
    v_add_f32 v18, 0x3727c5ac, v18
    v_cvt_pk_bf16_f32 v17, v18, v18
    v_lshlrev_b32 v18, 16, v17
    v_sqrt_f32 v18, v18
    s_nop 0
    v_cvt_pk_bf16_f32 v17, v18, v18
    v_lshlrev_b32 v18, 16, v17
    v_cvt_pk_bf16_f32 v17, v16, v16
    v_lshlrev_b32 v16, 16, v17
    v_rcp_f32 v19, v18
    v_sub_f32 v8, v8, v16
    v_sub_f32 v9, v9, v16
    v_cvt_pk_bf16_f32 v17, v8, v9
    v_lshlrev_b32 v8, 16, v17
    v_and_b32 v9, 0xffff0000, v17
    v_mul_f32 v20, v8, v19
    v_fma_f32 v21, -v20, v18, v8
    v_fma_f32 v8, v21, v19, v20
    v_mul_f32 v20, v9, v19
    v_fma_f32 v21, -v20, v18, v9
    v_fma_f32 v9, v21, v19, v20
    v_cvt_pk_bf16_f32 v56, v8, v9
    v_sub_f32 v10, v10, v16
    v_sub_f32 v11, v11, v16
    v_cvt_pk_bf16_f32 v17, v10, v11
    v_lshlrev_b32 v10, 16, v17
    v_and_b32 v11, 0xffff0000, v17
    v_mul_f32 v20, v10, v19
    v_fma_f32 v21, -v20, v18, v10
    v_fma_f32 v10, v21, v19, v20
    v_mul_f32 v20, v11, v19
    v_fma_f32 v21, -v20, v18, v11
    v_fma_f32 v11, v21, v19, v20
    v_cvt_pk_bf16_f32 v57, v10, v11
    v_sub_f32 v12, v12, v16
    v_sub_f32 v13, v13, v16
    v_cvt_pk_bf16_f32 v17, v12, v13
    v_lshlrev_b32 v12, 16, v17
    v_and_b32 v13, 0xffff0000, v17
    v_mul_f32 v20, v12, v19
    v_fma_f32 v21, -v20, v18, v12
    v_fma_f32 v12, v21, v19, v20
    v_mul_f32 v20, v13, v19
    v_fma_f32 v21, -v20, v18, v13
    v_fma_f32 v13, v21, v19, v20
    v_cvt_pk_bf16_f32 v58, v12, v13
    v_sub_f32 v14, v14, v16
    v_sub_f32 v15, v15, v16
    v_cvt_pk_bf16_f32 v17, v14, v15
    v_lshlrev_b32 v14, 16, v17
    v_and_b32 v15, 0xffff0000, v17
    v_mul_f32 v20, v14, v19
    v_fma_f32 v21, -v20, v18, v14
    v_fma_f32 v14, v21, v19, v20
    v_mul_f32 v20, v15, v19
    v_fma_f32 v21, -v20, v18, v15
    v_fma_f32 v15, v21, v19, v20
    v_cvt_pk_bf16_f32 v59, v14, v15
    buffer_store_dwordx4 v[56:59], v23, s[4:7], s46 offen offset:32 sc1
    s_waitcnt vmcnt(3)
    v_mov_b32 v4, v44
    v_mov_b32 v5, v45
    v_mov_b32 v6, v46
    v_mov_b32 v7, v47
    v_lshlrev_b32 v8, 16, v4
    v_and_b32 v9, 0xffff0000, v4
    v_lshlrev_b32 v10, 16, v5
    v_and_b32 v11, 0xffff0000, v5
    v_lshlrev_b32 v12, 16, v6
    v_and_b32 v13, 0xffff0000, v6
    v_lshlrev_b32 v14, 16, v7
    v_and_b32 v15, 0xffff0000, v7
    v_add_f32 v16, v8, v9
    v_add_f32 v16, v16, v10
    v_add_f32 v16, v16, v11
    v_add_f32 v16, v16, v12
    v_add_f32 v16, v16, v13
    v_add_f32 v16, v16, v14
    v_add_f32 v16, v16, v15
    s_nop 1
    v_add_f32_dpp v16, v16, v16 quad_perm:[1,0,3,2] row_mask:0xf bank_mask:0xf
    s_nop 1
    v_add_f32_dpp v16, v16, v16 quad_perm:[2,3,0,1] row_mask:0xf bank_mask:0xf
    s_nop 1
    v_add_f32_dpp v16, v16, v16 row_half_mirror row_mask:0xf bank_mask:0xf
    s_nop 1
    v_add_f32_dpp v16, v16, v16 row_mirror row_mask:0xf bank_mask:0xf
    v_mov_b32 v17, v16
    s_nop 1
    v_permlane16_swap_b32 v16, v17
    v_add_f32 v16, v16, v17
    v_mov_b32 v17, v16
    s_nop 1
    v_permlane32_swap_b32 v16, v17
    v_add_f32 v16, v16, v17
    v_mul_f32 v16, 0x3b000000, v16
    v_mov_b32 v18, 0
    v_sub_f32 v17, v8, v16
    v_fmac_f32 v18, v17, v17
    v_sub_f32 v17, v9, v16
    v_fmac_f32 v18, v17, v17
    v_sub_f32 v17, v10, v16
    v_fmac_f32 v18, v17, v17
    v_sub_f32 v17, v11, v16
    v_fmac_f32 v18, v17, v17
    v_sub_f32 v17, v12, v16
    v_fmac_f32 v18, v17, v17
    v_sub_f32 v17, v13, v16
    v_fmac_f32 v18, v17, v17
    v_sub_f32 v17, v14, v16
    v_fmac_f32 v18, v17, v17
    v_sub_f32 v17, v15, v16
    v_fmac_f32 v18, v17, v17
    s_nop 1
    v_add_f32_dpp v18, v18, v18 quad_perm:[1,0,3,2] row_mask:0xf bank_mask:0xf
    s_nop 1
    v_add_f32_dpp v18, v18, v18 quad_perm:[2,3,0,1] row_mask:0xf bank_mask:0xf
    s_nop 1
    v_add_f32_dpp v18, v18, v18 row_half_mirror row_mask:0xf bank_mask:0xf
    s_nop 1
    v_add_f32_dpp v18, v18, v18 row_mirror row_mask:0xf bank_mask:0xf
    v_mov_b32 v17, v18
    s_nop 1
    v_permlane16_swap_b32 v18, v17
    v_add_f32 v18, v18, v17
    v_mov_b32 v17, v18
    s_nop 1
    v_permlane32_swap_b32 v18, v17
    v_add_f32 v18, v18, v17
    v_mul_f32 v18, 0x3b000000, v18
    v_cvt_pk_bf16_f32 v17, v18, v18
    v_lshlrev_b32 v18, 16, v17
    v_add_f32 v18, 0x3727c5ac, v18
    v_cvt_pk_bf16_f32 v17, v18, v18
    v_lshlrev_b32 v18, 16, v17
    v_sqrt_f32 v18, v18
    s_nop 0
    v_cvt_pk_bf16_f32 v17, v18, v18
    v_lshlrev_b32 v18, 16, v17
    v_cvt_pk_bf16_f32 v17, v16, v16
    v_lshlrev_b32 v16, 16, v17
    v_rcp_f32 v19, v18
    v_sub_f32 v8, v8, v16
    v_sub_f32 v9, v9, v16
    v_cvt_pk_bf16_f32 v17, v8, v9
    v_lshlrev_b32 v8, 16, v17
    v_and_b32 v9, 0xffff0000, v17
    v_mul_f32 v20, v8, v19
    v_fma_f32 v21, -v20, v18, v8
    v_fma_f32 v8, v21, v19, v20
    v_mul_f32 v20, v9, v19
    v_fma_f32 v21, -v20, v18, v9
    v_fma_f32 v9, v21, v19, v20
    v_cvt_pk_bf16_f32 v60, v8, v9
    v_sub_f32 v10, v10, v16
    v_sub_f32 v11, v11, v16
    v_cvt_pk_bf16_f32 v17, v10, v11
    v_lshlrev_b32 v10, 16, v17
    v_and_b32 v11, 0xffff0000, v17
    v_mul_f32 v20, v10, v19
    v_fma_f32 v21, -v20, v18, v10
    v_fma_f32 v10, v21, v19, v20
    v_mul_f32 v20, v11, v19
    v_fma_f32 v21, -v20, v18, v11
    v_fma_f32 v11, v21, v19, v20
    v_cvt_pk_bf16_f32 v61, v10, v11
    v_sub_f32 v12, v12, v16
    v_sub_f32 v13, v13, v16
    v_cvt_pk_bf16_f32 v17, v12, v13
    v_lshlrev_b32 v12, 16, v17
    v_and_b32 v13, 0xffff0000, v17
    v_mul_f32 v20, v12, v19
    v_fma_f32 v21, -v20, v18, v12
    v_fma_f32 v12, v21, v19, v20
    v_mul_f32 v20, v13, v19
    v_fma_f32 v21, -v20, v18, v13
    v_fma_f32 v13, v21, v19, v20
    v_cvt_pk_bf16_f32 v62, v12, v13
    v_sub_f32 v14, v14, v16
    v_sub_f32 v15, v15, v16
    v_cvt_pk_bf16_f32 v17, v14, v15
    v_lshlrev_b32 v14, 16, v17
    v_and_b32 v15, 0xffff0000, v17
    v_mul_f32 v20, v14, v19
    v_fma_f32 v21, -v20, v18, v14
    v_fma_f32 v14, v21, v19, v20
    v_mul_f32 v20, v15, v19
    v_fma_f32 v21, -v20, v18, v15
    v_fma_f32 v15, v21, v19, v20
    v_cvt_pk_bf16_f32 v63, v14, v15
    buffer_store_dwordx4 v[60:63], v23, s[4:7], s46 offen offset:48 sc1
    s_add_u32 s40, s40, 1
    v_and_b32 v1, 63, v0
    v_lshlrev_b32 v2, 4, v1
    s_lshl_b32 s46, s40, 14
    s_lshl_b32 s47, s14, 12
    s_add_u32 s46, s46, s47
    s_lshl_b32 s47, s89, 22
    s_add_u32 s46, s46, s47
    s_add_u32 s46, s46, 23068672
    buffer_load_dwordx4 v[32:35], v2, s[4:7], s46 offen offset:0 sc1
    buffer_load_dwordx4 v[36:39], v2, s[4:7], s46 offen offset:1024 sc1
    buffer_load_dwordx4 v[40:43], v2, s[4:7], s46 offen offset:2048 sc1
    buffer_load_dwordx4 v[44:47], v2, s[4:7], s46 offen offset:3072 sc1
    v_lshrrev_b32 v22, 2, v1
    v_lshlrev_b32 v23, 10, v22
    v_and_b32 v22, 3, v1
    v_lshl_add_u32 v23, v22, 8, v23
    s_lshl_b32 s46, s40, 14
    s_lshl_b32 s47, s14, 6
    s_add_u32 s46, s46, s47
    s_add_u32 s46, s46, s88
    s_add_u32 s46, s46, 31457280
    s_waitcnt vmcnt(3)
    v_mov_b32 v4, v32
    v_mov_b32 v5, v33
    v_mov_b32 v6, v34
    v_mov_b32 v7, v35
    v_lshlrev_b32 v8, 16, v4
    v_and_b32 v9, 0xffff0000, v4
    v_lshlrev_b32 v10, 16, v5
    v_and_b32 v11, 0xffff0000, v5
    v_lshlrev_b32 v12, 16, v6
    v_and_b32 v13, 0xffff0000, v6
    v_lshlrev_b32 v14, 16, v7
    v_and_b32 v15, 0xffff0000, v7
    v_add_f32 v16, v8, v9
    v_add_f32 v16, v16, v10
    v_add_f32 v16, v16, v11
    v_add_f32 v16, v16, v12
    v_add_f32 v16, v16, v13
    v_add_f32 v16, v16, v14
    v_add_f32 v16, v16, v15
    s_nop 1
    v_add_f32_dpp v16, v16, v16 quad_perm:[1,0,3,2] row_mask:0xf bank_mask:0xf
    s_nop 1
    v_add_f32_dpp v16, v16, v16 quad_perm:[2,3,0,1] row_mask:0xf bank_mask:0xf
    s_nop 1
    v_add_f32_dpp v16, v16, v16 row_half_mirror row_mask:0xf bank_mask:0xf
    s_nop 1
    v_add_f32_dpp v16, v16, v16 row_mirror row_mask:0xf bank_mask:0xf
    v_mov_b32 v17, v16
    s_nop 1
    v_permlane16_swap_b32 v16, v17
    v_add_f32 v16, v16, v17
    v_mov_b32 v17, v16
    s_nop 1
    v_permlane32_swap_b32 v16, v17
    v_add_f32 v16, v16, v17
    v_mul_f32 v16, 0x3b000000, v16
    v_mov_b32 v18, 0
    v_sub_f32 v17, v8, v16
    v_fmac_f32 v18, v17, v17
    v_sub_f32 v17, v9, v16
    v_fmac_f32 v18, v17, v17
    v_sub_f32 v17, v10, v16
    v_fmac_f32 v18, v17, v17
    v_sub_f32 v17, v11, v16
    v_fmac_f32 v18, v17, v17
    v_sub_f32 v17, v12, v16
    v_fmac_f32 v18, v17, v17
    v_sub_f32 v17, v13, v16
    v_fmac_f32 v18, v17, v17
    v_sub_f32 v17, v14, v16
    v_fmac_f32 v18, v17, v17
    v_sub_f32 v17, v15, v16
    v_fmac_f32 v18, v17, v17
    s_nop 1
    v_add_f32_dpp v18, v18, v18 quad_perm:[1,0,3,2] row_mask:0xf bank_mask:0xf
    s_nop 1
    v_add_f32_dpp v18, v18, v18 quad_perm:[2,3,0,1] row_mask:0xf bank_mask:0xf
    s_nop 1
    v_add_f32_dpp v18, v18, v18 row_half_mirror row_mask:0xf bank_mask:0xf
    s_nop 1
    v_add_f32_dpp v18, v18, v18 row_mirror row_mask:0xf bank_mask:0xf
    v_mov_b32 v17, v18
    s_nop 1
    v_permlane16_swap_b32 v18, v17
    v_add_f32 v18, v18, v17
    v_mov_b32 v17, v18
    s_nop 1
    v_permlane32_swap_b32 v18, v17
    v_add_f32 v18, v18, v17
    v_mul_f32 v18, 0x3b000000, v18
    v_cvt_pk_bf16_f32 v17, v18, v18
    v_lshlrev_b32 v18, 16, v17
    v_add_f32 v18, 0x3727c5ac, v18
    v_cvt_pk_bf16_f32 v17, v18, v18
    v_lshlrev_b32 v18, 16, v17
    v_sqrt_f32 v18, v18
    s_nop 0
    v_cvt_pk_bf16_f32 v17, v18, v18
    v_lshlrev_b32 v18, 16, v17
    v_cvt_pk_bf16_f32 v17, v16, v16
    v_lshlrev_b32 v16, 16, v17
    v_rcp_f32 v19, v18
    v_sub_f32 v8, v8, v16
    v_sub_f32 v9, v9, v16
    v_cvt_pk_bf16_f32 v17, v8, v9
    v_lshlrev_b32 v8, 16, v17
    v_and_b32 v9, 0xffff0000, v17
    v_mul_f32 v20, v8, v19
    v_fma_f32 v21, -v20, v18, v8
    v_fma_f32 v8, v21, v19, v20
    v_mul_f32 v20, v9, v19
    v_fma_f32 v21, -v20, v18, v9
    v_fma_f32 v9, v21, v19, v20
    v_cvt_pk_bf16_f32 v48, v8, v9
    v_sub_f32 v10, v10, v16
    v_sub_f32 v11, v11, v16
    v_cvt_pk_bf16_f32 v17, v10, v11
    v_lshlrev_b32 v10, 16, v17
    v_and_b32 v11, 0xffff0000, v17
    v_mul_f32 v20, v10, v19
    v_fma_f32 v21, -v20, v18, v10
    v_fma_f32 v10, v21, v19, v20
    v_mul_f32 v20, v11, v19
    v_fma_f32 v21, -v20, v18, v11
    v_fma_f32 v11, v21, v19, v20
    v_cvt_pk_bf16_f32 v49, v10, v11
    v_sub_f32 v12, v12, v16
    v_sub_f32 v13, v13, v16
    v_cvt_pk_bf16_f32 v17, v12, v13
    v_lshlrev_b32 v12, 16, v17
    v_and_b32 v13, 0xffff0000, v17
    v_mul_f32 v20, v12, v19
    v_fma_f32 v21, -v20, v18, v12
    v_fma_f32 v12, v21, v19, v20
    v_mul_f32 v20, v13, v19
    v_fma_f32 v21, -v20, v18, v13
    v_fma_f32 v13, v21, v19, v20
    v_cvt_pk_bf16_f32 v50, v12, v13
    v_sub_f32 v14, v14, v16
    v_sub_f32 v15, v15, v16
    v_cvt_pk_bf16_f32 v17, v14, v15
    v_lshlrev_b32 v14, 16, v17
    v_and_b32 v15, 0xffff0000, v17
    v_mul_f32 v20, v14, v19
    v_fma_f32 v21, -v20, v18, v14
    v_fma_f32 v14, v21, v19, v20
    v_mul_f32 v20, v15, v19
    v_fma_f32 v21, -v20, v18, v15
    v_fma_f32 v15, v21, v19, v20
    v_cvt_pk_bf16_f32 v51, v14, v15
    buffer_store_dwordx4 v[48:51], v23, s[4:7], s46 offen offset:0 sc1
    s_waitcnt vmcnt(3)
    v_mov_b32 v4, v36
    v_mov_b32 v5, v37
    v_mov_b32 v6, v38
    v_mov_b32 v7, v39
    v_lshlrev_b32 v8, 16, v4
    v_and_b32 v9, 0xffff0000, v4
    v_lshlrev_b32 v10, 16, v5
    v_and_b32 v11, 0xffff0000, v5
    v_lshlrev_b32 v12, 16, v6
    v_and_b32 v13, 0xffff0000, v6
    v_lshlrev_b32 v14, 16, v7
    v_and_b32 v15, 0xffff0000, v7
    v_add_f32 v16, v8, v9
    v_add_f32 v16, v16, v10
    v_add_f32 v16, v16, v11
    v_add_f32 v16, v16, v12
    v_add_f32 v16, v16, v13
    v_add_f32 v16, v16, v14
    v_add_f32 v16, v16, v15
    s_nop 1
    v_add_f32_dpp v16, v16, v16 quad_perm:[1,0,3,2] row_mask:0xf bank_mask:0xf
    s_nop 1
    v_add_f32_dpp v16, v16, v16 quad_perm:[2,3,0,1] row_mask:0xf bank_mask:0xf
    s_nop 1
    v_add_f32_dpp v16, v16, v16 row_half_mirror row_mask:0xf bank_mask:0xf
    s_nop 1
    v_add_f32_dpp v16, v16, v16 row_mirror row_mask:0xf bank_mask:0xf
    v_mov_b32 v17, v16
    s_nop 1
    v_permlane16_swap_b32 v16, v17
    v_add_f32 v16, v16, v17
    v_mov_b32 v17, v16
    s_nop 1
    v_permlane32_swap_b32 v16, v17
    v_add_f32 v16, v16, v17
    v_mul_f32 v16, 0x3b000000, v16
    v_mov_b32 v18, 0
    v_sub_f32 v17, v8, v16
    v_fmac_f32 v18, v17, v17
    v_sub_f32 v17, v9, v16
    v_fmac_f32 v18, v17, v17
    v_sub_f32 v17, v10, v16
    v_fmac_f32 v18, v17, v17
    v_sub_f32 v17, v11, v16
    v_fmac_f32 v18, v17, v17
    v_sub_f32 v17, v12, v16
    v_fmac_f32 v18, v17, v17
    v_sub_f32 v17, v13, v16
    v_fmac_f32 v18, v17, v17
    v_sub_f32 v17, v14, v16
    v_fmac_f32 v18, v17, v17
    v_sub_f32 v17, v15, v16
    v_fmac_f32 v18, v17, v17
    s_nop 1
    v_add_f32_dpp v18, v18, v18 quad_perm:[1,0,3,2] row_mask:0xf bank_mask:0xf
    s_nop 1
    v_add_f32_dpp v18, v18, v18 quad_perm:[2,3,0,1] row_mask:0xf bank_mask:0xf
    s_nop 1
    v_add_f32_dpp v18, v18, v18 row_half_mirror row_mask:0xf bank_mask:0xf
    s_nop 1
    v_add_f32_dpp v18, v18, v18 row_mirror row_mask:0xf bank_mask:0xf
    v_mov_b32 v17, v18
    s_nop 1
    v_permlane16_swap_b32 v18, v17
    v_add_f32 v18, v18, v17
    v_mov_b32 v17, v18
    s_nop 1
    v_permlane32_swap_b32 v18, v17
    v_add_f32 v18, v18, v17
    v_mul_f32 v18, 0x3b000000, v18
    v_cvt_pk_bf16_f32 v17, v18, v18
    v_lshlrev_b32 v18, 16, v17
    v_add_f32 v18, 0x3727c5ac, v18
    v_cvt_pk_bf16_f32 v17, v18, v18
    v_lshlrev_b32 v18, 16, v17
    v_sqrt_f32 v18, v18
    s_nop 0
    v_cvt_pk_bf16_f32 v17, v18, v18
    v_lshlrev_b32 v18, 16, v17
    v_cvt_pk_bf16_f32 v17, v16, v16
    v_lshlrev_b32 v16, 16, v17
    v_rcp_f32 v19, v18
    v_sub_f32 v8, v8, v16
    v_sub_f32 v9, v9, v16
    v_cvt_pk_bf16_f32 v17, v8, v9
    v_lshlrev_b32 v8, 16, v17
    v_and_b32 v9, 0xffff0000, v17
    v_mul_f32 v20, v8, v19
    v_fma_f32 v21, -v20, v18, v8
    v_fma_f32 v8, v21, v19, v20
    v_mul_f32 v20, v9, v19
    v_fma_f32 v21, -v20, v18, v9
    v_fma_f32 v9, v21, v19, v20
    v_cvt_pk_bf16_f32 v52, v8, v9
    v_sub_f32 v10, v10, v16
    v_sub_f32 v11, v11, v16
    v_cvt_pk_bf16_f32 v17, v10, v11
    v_lshlrev_b32 v10, 16, v17
    v_and_b32 v11, 0xffff0000, v17
    v_mul_f32 v20, v10, v19
    v_fma_f32 v21, -v20, v18, v10
    v_fma_f32 v10, v21, v19, v20
    v_mul_f32 v20, v11, v19
    v_fma_f32 v21, -v20, v18, v11
    v_fma_f32 v11, v21, v19, v20
    v_cvt_pk_bf16_f32 v53, v10, v11
    v_sub_f32 v12, v12, v16
    v_sub_f32 v13, v13, v16
    v_cvt_pk_bf16_f32 v17, v12, v13
    v_lshlrev_b32 v12, 16, v17
    v_and_b32 v13, 0xffff0000, v17
    v_mul_f32 v20, v12, v19
    v_fma_f32 v21, -v20, v18, v12
    v_fma_f32 v12, v21, v19, v20
    v_mul_f32 v20, v13, v19
    v_fma_f32 v21, -v20, v18, v13
    v_fma_f32 v13, v21, v19, v20
    v_cvt_pk_bf16_f32 v54, v12, v13
    v_sub_f32 v14, v14, v16
    v_sub_f32 v15, v15, v16
    v_cvt_pk_bf16_f32 v17, v14, v15
    v_lshlrev_b32 v14, 16, v17
    v_and_b32 v15, 0xffff0000, v17
    v_mul_f32 v20, v14, v19
    v_fma_f32 v21, -v20, v18, v14
    v_fma_f32 v14, v21, v19, v20
    v_mul_f32 v20, v15, v19
    v_fma_f32 v21, -v20, v18, v15
    v_fma_f32 v15, v21, v19, v20
    v_cvt_pk_bf16_f32 v55, v14, v15
    buffer_store_dwordx4 v[52:55], v23, s[4:7], s46 offen offset:16 sc1
    s_waitcnt vmcnt(3)
    v_mov_b32 v4, v40
    v_mov_b32 v5, v41
    v_mov_b32 v6, v42
    v_mov_b32 v7, v43
    v_lshlrev_b32 v8, 16, v4
    v_and_b32 v9, 0xffff0000, v4
    v_lshlrev_b32 v10, 16, v5
    v_and_b32 v11, 0xffff0000, v5
    v_lshlrev_b32 v12, 16, v6
    v_and_b32 v13, 0xffff0000, v6
    v_lshlrev_b32 v14, 16, v7
    v_and_b32 v15, 0xffff0000, v7
    v_add_f32 v16, v8, v9
    v_add_f32 v16, v16, v10
    v_add_f32 v16, v16, v11
    v_add_f32 v16, v16, v12
    v_add_f32 v16, v16, v13
    v_add_f32 v16, v16, v14
    v_add_f32 v16, v16, v15
    s_nop 1
    v_add_f32_dpp v16, v16, v16 quad_perm:[1,0,3,2] row_mask:0xf bank_mask:0xf
    s_nop 1
    v_add_f32_dpp v16, v16, v16 quad_perm:[2,3,0,1] row_mask:0xf bank_mask:0xf
    s_nop 1
    v_add_f32_dpp v16, v16, v16 row_half_mirror row_mask:0xf bank_mask:0xf
    s_nop 1
    v_add_f32_dpp v16, v16, v16 row_mirror row_mask:0xf bank_mask:0xf
    v_mov_b32 v17, v16
    s_nop 1
    v_permlane16_swap_b32 v16, v17
    v_add_f32 v16, v16, v17
    v_mov_b32 v17, v16
    s_nop 1
    v_permlane32_swap_b32 v16, v17
    v_add_f32 v16, v16, v17
    v_mul_f32 v16, 0x3b000000, v16
    v_mov_b32 v18, 0
    v_sub_f32 v17, v8, v16
    v_fmac_f32 v18, v17, v17
    v_sub_f32 v17, v9, v16
    v_fmac_f32 v18, v17, v17
    v_sub_f32 v17, v10, v16
    v_fmac_f32 v18, v17, v17
    v_sub_f32 v17, v11, v16
    v_fmac_f32 v18, v17, v17
    v_sub_f32 v17, v12, v16
    v_fmac_f32 v18, v17, v17
    v_sub_f32 v17, v13, v16
    v_fmac_f32 v18, v17, v17
    v_sub_f32 v17, v14, v16
    v_fmac_f32 v18, v17, v17
    v_sub_f32 v17, v15, v16
    v_fmac_f32 v18, v17, v17
    s_nop 1
    v_add_f32_dpp v18, v18, v18 quad_perm:[1,0,3,2] row_mask:0xf bank_mask:0xf
    s_nop 1
    v_add_f32_dpp v18, v18, v18 quad_perm:[2,3,0,1] row_mask:0xf bank_mask:0xf
    s_nop 1
    v_add_f32_dpp v18, v18, v18 row_half_mirror row_mask:0xf bank_mask:0xf
    s_nop 1
    v_add_f32_dpp v18, v18, v18 row_mirror row_mask:0xf bank_mask:0xf
    v_mov_b32 v17, v18
    s_nop 1
    v_permlane16_swap_b32 v18, v17
    v_add_f32 v18, v18, v17
    v_mov_b32 v17, v18
    s_nop 1
    v_permlane32_swap_b32 v18, v17
    v_add_f32 v18, v18, v17
    v_mul_f32 v18, 0x3b000000, v18
    v_cvt_pk_bf16_f32 v17, v18, v18
    v_lshlrev_b32 v18, 16, v17
    v_add_f32 v18, 0x3727c5ac, v18
    v_cvt_pk_bf16_f32 v17, v18, v18
    v_lshlrev_b32 v18, 16, v17
    v_sqrt_f32 v18, v18
    s_nop 0
    v_cvt_pk_bf16_f32 v17, v18, v18
    v_lshlrev_b32 v18, 16, v17
    v_cvt_pk_bf16_f32 v17, v16, v16
    v_lshlrev_b32 v16, 16, v17
    v_rcp_f32 v19, v18
    v_sub_f32 v8, v8, v16
    v_sub_f32 v9, v9, v16
    v_cvt_pk_bf16_f32 v17, v8, v9
    v_lshlrev_b32 v8, 16, v17
    v_and_b32 v9, 0xffff0000, v17
    v_mul_f32 v20, v8, v19
    v_fma_f32 v21, -v20, v18, v8
    v_fma_f32 v8, v21, v19, v20
    v_mul_f32 v20, v9, v19
    v_fma_f32 v21, -v20, v18, v9
    v_fma_f32 v9, v21, v19, v20
    v_cvt_pk_bf16_f32 v56, v8, v9
    v_sub_f32 v10, v10, v16
    v_sub_f32 v11, v11, v16
    v_cvt_pk_bf16_f32 v17, v10, v11
    v_lshlrev_b32 v10, 16, v17
    v_and_b32 v11, 0xffff0000, v17
    v_mul_f32 v20, v10, v19
    v_fma_f32 v21, -v20, v18, v10
    v_fma_f32 v10, v21, v19, v20
    v_mul_f32 v20, v11, v19
    v_fma_f32 v21, -v20, v18, v11
    v_fma_f32 v11, v21, v19, v20
    v_cvt_pk_bf16_f32 v57, v10, v11
    v_sub_f32 v12, v12, v16
    v_sub_f32 v13, v13, v16
    v_cvt_pk_bf16_f32 v17, v12, v13
    v_lshlrev_b32 v12, 16, v17
    v_and_b32 v13, 0xffff0000, v17
    v_mul_f32 v20, v12, v19
    v_fma_f32 v21, -v20, v18, v12
    v_fma_f32 v12, v21, v19, v20
    v_mul_f32 v20, v13, v19
    v_fma_f32 v21, -v20, v18, v13
    v_fma_f32 v13, v21, v19, v20
    v_cvt_pk_bf16_f32 v58, v12, v13
    v_sub_f32 v14, v14, v16
    v_sub_f32 v15, v15, v16
    v_cvt_pk_bf16_f32 v17, v14, v15
    v_lshlrev_b32 v14, 16, v17
    v_and_b32 v15, 0xffff0000, v17
    v_mul_f32 v20, v14, v19
    v_fma_f32 v21, -v20, v18, v14
    v_fma_f32 v14, v21, v19, v20
    v_mul_f32 v20, v15, v19
    v_fma_f32 v21, -v20, v18, v15
    v_fma_f32 v15, v21, v19, v20
    v_cvt_pk_bf16_f32 v59, v14, v15
    buffer_store_dwordx4 v[56:59], v23, s[4:7], s46 offen offset:32 sc1
    s_waitcnt vmcnt(3)
    v_mov_b32 v4, v44
    v_mov_b32 v5, v45
    v_mov_b32 v6, v46
    v_mov_b32 v7, v47
    v_lshlrev_b32 v8, 16, v4
    v_and_b32 v9, 0xffff0000, v4
    v_lshlrev_b32 v10, 16, v5
    v_and_b32 v11, 0xffff0000, v5
    v_lshlrev_b32 v12, 16, v6
    v_and_b32 v13, 0xffff0000, v6
    v_lshlrev_b32 v14, 16, v7
    v_and_b32 v15, 0xffff0000, v7
    v_add_f32 v16, v8, v9
    v_add_f32 v16, v16, v10
    v_add_f32 v16, v16, v11
    v_add_f32 v16, v16, v12
    v_add_f32 v16, v16, v13
    v_add_f32 v16, v16, v14
    v_add_f32 v16, v16, v15
    s_nop 1
    v_add_f32_dpp v16, v16, v16 quad_perm:[1,0,3,2] row_mask:0xf bank_mask:0xf
    s_nop 1
    v_add_f32_dpp v16, v16, v16 quad_perm:[2,3,0,1] row_mask:0xf bank_mask:0xf
    s_nop 1
    v_add_f32_dpp v16, v16, v16 row_half_mirror row_mask:0xf bank_mask:0xf
    s_nop 1
    v_add_f32_dpp v16, v16, v16 row_mirror row_mask:0xf bank_mask:0xf
    v_mov_b32 v17, v16
    s_nop 1
    v_permlane16_swap_b32 v16, v17
    v_add_f32 v16, v16, v17
    v_mov_b32 v17, v16
    s_nop 1
    v_permlane32_swap_b32 v16, v17
    v_add_f32 v16, v16, v17
    v_mul_f32 v16, 0x3b000000, v16
    v_mov_b32 v18, 0
    v_sub_f32 v17, v8, v16
    v_fmac_f32 v18, v17, v17
    v_sub_f32 v17, v9, v16
    v_fmac_f32 v18, v17, v17
    v_sub_f32 v17, v10, v16
    v_fmac_f32 v18, v17, v17
    v_sub_f32 v17, v11, v16
    v_fmac_f32 v18, v17, v17
    v_sub_f32 v17, v12, v16
    v_fmac_f32 v18, v17, v17
    v_sub_f32 v17, v13, v16
    v_fmac_f32 v18, v17, v17
    v_sub_f32 v17, v14, v16
    v_fmac_f32 v18, v17, v17
    v_sub_f32 v17, v15, v16
    v_fmac_f32 v18, v17, v17
    s_nop 1
    v_add_f32_dpp v18, v18, v18 quad_perm:[1,0,3,2] row_mask:0xf bank_mask:0xf
    s_nop 1
    v_add_f32_dpp v18, v18, v18 quad_perm:[2,3,0,1] row_mask:0xf bank_mask:0xf
    s_nop 1
    v_add_f32_dpp v18, v18, v18 row_half_mirror row_mask:0xf bank_mask:0xf
    s_nop 1
    v_add_f32_dpp v18, v18, v18 row_mirror row_mask:0xf bank_mask:0xf
    v_mov_b32 v17, v18
    s_nop 1
    v_permlane16_swap_b32 v18, v17
    v_add_f32 v18, v18, v17
    v_mov_b32 v17, v18
    s_nop 1
    v_permlane32_swap_b32 v18, v17
    v_add_f32 v18, v18, v17
    v_mul_f32 v18, 0x3b000000, v18
    v_cvt_pk_bf16_f32 v17, v18, v18
    v_lshlrev_b32 v18, 16, v17
    v_add_f32 v18, 0x3727c5ac, v18
    v_cvt_pk_bf16_f32 v17, v18, v18
    v_lshlrev_b32 v18, 16, v17
    v_sqrt_f32 v18, v18
    s_nop 0
    v_cvt_pk_bf16_f32 v17, v18, v18
    v_lshlrev_b32 v18, 16, v17
    v_cvt_pk_bf16_f32 v17, v16, v16
    v_lshlrev_b32 v16, 16, v17
    v_rcp_f32 v19, v18
    v_sub_f32 v8, v8, v16
    v_sub_f32 v9, v9, v16
    v_cvt_pk_bf16_f32 v17, v8, v9
    v_lshlrev_b32 v8, 16, v17
    v_and_b32 v9, 0xffff0000, v17
    v_mul_f32 v20, v8, v19
    v_fma_f32 v21, -v20, v18, v8
    v_fma_f32 v8, v21, v19, v20
    v_mul_f32 v20, v9, v19
    v_fma_f32 v21, -v20, v18, v9
    v_fma_f32 v9, v21, v19, v20
    v_cvt_pk_bf16_f32 v60, v8, v9
    v_sub_f32 v10, v10, v16
    v_sub_f32 v11, v11, v16
    v_cvt_pk_bf16_f32 v17, v10, v11
    v_lshlrev_b32 v10, 16, v17
    v_and_b32 v11, 0xffff0000, v17
    v_mul_f32 v20, v10, v19
    v_fma_f32 v21, -v20, v18, v10
    v_fma_f32 v10, v21, v19, v20
    v_mul_f32 v20, v11, v19
    v_fma_f32 v21, -v20, v18, v11
    v_fma_f32 v11, v21, v19, v20
    v_cvt_pk_bf16_f32 v61, v10, v11
    v_sub_f32 v12, v12, v16
    v_sub_f32 v13, v13, v16
    v_cvt_pk_bf16_f32 v17, v12, v13
    v_lshlrev_b32 v12, 16, v17
    v_and_b32 v13, 0xffff0000, v17
    v_mul_f32 v20, v12, v19
    v_fma_f32 v21, -v20, v18, v12
    v_fma_f32 v12, v21, v19, v20
    v_mul_f32 v20, v13, v19
    v_fma_f32 v21, -v20, v18, v13
    v_fma_f32 v13, v21, v19, v20
    v_cvt_pk_bf16_f32 v62, v12, v13
    v_sub_f32 v14, v14, v16
    v_sub_f32 v15, v15, v16
    v_cvt_pk_bf16_f32 v17, v14, v15
    v_lshlrev_b32 v14, 16, v17
    v_and_b32 v15, 0xffff0000, v17
    v_mul_f32 v20, v14, v19
    v_fma_f32 v21, -v20, v18, v14
    v_fma_f32 v14, v21, v19, v20
    v_mul_f32 v20, v15, v19
    v_fma_f32 v21, -v20, v18, v15
    v_fma_f32 v15, v21, v19, v20
    v_cvt_pk_bf16_f32 v63, v14, v15
    buffer_store_dwordx4 v[60:63], v23, s[4:7], s46 offen offset:48 sc1
    s_lshl_b32 s82, s83, 2
    s_add_u32 s82, s82, 1024
    s_waitcnt vmcnt(0)
    s_barrier
    s_cmp_lg_u32 s14, 0
    s_cbranch_scc1 sig_14
    s_mov_b64 exec, 1
    v_mov_b32 v2, s82
    v_mov_b32 v3, 1
    buffer_atomic_add v3, v2, s[4:7], s80 offen
    s_mov_b64 exec, -1
sig_14:
    s_branch mega_kernel_next
mega_kernel_lnb:
    s_sub_u32 s81, s81, 64
    s_lshl_b32 s40, s83, 5
    s_add_u32 s40, s40, s81
    s_lshr_b32 s41, s40, 5
    s_and_b32 s42, s40, 31
    v_and_b32 v1, 63, v0
    v_lshrrev_b32 v2, 6, v0
    s_nop 0
    v_readfirstlane_b32 s43, v2
    v_and_b32 v3, 15, v1
    v_lshrrev_b32 v4, 4, v1
    v_lshlrev_b32 v5, 4, v1
    s_lshl_b32 s44, s41, 3
    s_lshl_b32 s45, s43, 1
    s_add_u32 s44, s44, s45
    s_lshl_b32 s46, s42, 14
    s_add_u32 s46, s46, 16777216
    s_add_u32 s48, s46, 0
    buffer_load_dwordx4 a[0:3], v5, s[4:7], s48 offen offset:0
    buffer_load_dwordx4 a[4:7], v5, s[4:7], s48 offen offset:1024
    buffer_load_dwordx4 a[8:11], v5, s[4:7], s48 offen offset:2048
    buffer_load_dwordx4 a[12:15], v5, s[4:7], s48 offen offset:3072
    s_add_u32 s48, s46, 4096
    buffer_load_dwordx4 a[16:19], v5, s[4:7], s48 offen offset:0
    buffer_load_dwordx4 a[20:23], v5, s[4:7], s48 offen offset:1024
    buffer_load_dwordx4 a[24:27], v5, s[4:7], s48 offen offset:2048
    buffer_load_dwordx4 a[28:31], v5, s[4:7], s48 offen offset:3072
    s_add_u32 s48, s46, 8192
    buffer_load_dwordx4 a[32:35], v5, s[4:7], s48 offen offset:0
    buffer_load_dwordx4 a[36:39], v5, s[4:7], s48 offen offset:1024
    buffer_load_dwordx4 a[40:43], v5, s[4:7], s48 offen offset:2048
    buffer_load_dwordx4 a[44:47], v5, s[4:7], s48 offen offset:3072
    s_add_u32 s48, s46, 12288
    buffer_load_dwordx4 a[48:51], v5, s[4:7], s48 offen offset:0
    buffer_load_dwordx4 a[52:55], v5, s[4:7], s48 offen offset:1024
    buffer_load_dwordx4 a[56:59], v5, s[4:7], s48 offen offset:2048
    buffer_load_dwordx4 a[60:63], v5, s[4:7], s48 offen offset:3072
    s_add_u32 s48, s46, 524288
    buffer_load_dwordx4 a[64:67], v5, s[4:7], s48 offen offset:0
    buffer_load_dwordx4 a[68:71], v5, s[4:7], s48 offen offset:1024
    buffer_load_dwordx4 a[72:75], v5, s[4:7], s48 offen offset:2048
    buffer_load_dwordx4 a[76:79], v5, s[4:7], s48 offen offset:3072
    s_add_u32 s48, s46, 528384
    buffer_load_dwordx4 a[80:83], v5, s[4:7], s48 offen offset:0
    buffer_load_dwordx4 a[84:87], v5, s[4:7], s48 offen offset:1024
    buffer_load_dwordx4 a[88:91], v5, s[4:7], s48 offen offset:2048
    buffer_load_dwordx4 a[92:95], v5, s[4:7], s48 offen offset:3072
    s_add_u32 s48, s46, 532480
    buffer_load_dwordx4 a[96:99], v5, s[4:7], s48 offen offset:0
    buffer_load_dwordx4 a[100:103], v5, s[4:7], s48 offen offset:1024
    buffer_load_dwordx4 a[104:107], v5, s[4:7], s48 offen offset:2048
    buffer_load_dwordx4 a[108:111], v5, s[4:7], s48 offen offset:3072
    s_add_u32 s48, s46, 536576
    buffer_load_dwordx4 a[112:115], v5, s[4:7], s48 offen offset:0
    buffer_load_dwordx4 a[116:119], v5, s[4:7], s48 offen offset:1024
    buffer_load_dwordx4 a[120:123], v5, s[4:7], s48 offen offset:2048
    buffer_load_dwordx4 a[124:127], v5, s[4:7], s48 offen offset:3072
    s_add_u32 s48, s46, 1048576
    buffer_load_dwordx4 a[128:131], v5, s[4:7], s48 offen offset:0
    buffer_load_dwordx4 a[132:135], v5, s[4:7], s48 offen offset:1024
    buffer_load_dwordx4 a[136:139], v5, s[4:7], s48 offen offset:2048
    buffer_load_dwordx4 a[140:143], v5, s[4:7], s48 offen offset:3072
    s_add_u32 s48, s46, 1052672
    buffer_load_dwordx4 a[144:147], v5, s[4:7], s48 offen offset:0
    buffer_load_dwordx4 a[148:151], v5, s[4:7], s48 offen offset:1024
    buffer_load_dwordx4 a[152:155], v5, s[4:7], s48 offen offset:2048
    buffer_load_dwordx4 a[156:159], v5, s[4:7], s48 offen offset:3072
    s_add_u32 s48, s46, 1056768
    buffer_load_dwordx4 a[160:163], v5, s[4:7], s48 offen offset:0
    buffer_load_dwordx4 a[164:167], v5, s[4:7], s48 offen offset:1024
    buffer_load_dwordx4 a[168:171], v5, s[4:7], s48 offen offset:2048
    buffer_load_dwordx4 a[172:175], v5, s[4:7], s48 offen offset:3072
    s_add_u32 s48, s46, 1060864
    buffer_load_dwordx4 a[176:179], v5, s[4:7], s48 offen offset:0
    buffer_load_dwordx4 a[180:183], v5, s[4:7], s48 offen offset:1024
    buffer_load_dwordx4 a[184:187], v5, s[4:7], s48 offen offset:2048
    buffer_load_dwordx4 a[188:191], v5, s[4:7], s48 offen offset:3072
    s_lshl_b32 s46, s44, 14
    s_add_u32 s46, s46, 31457280
    s_add_u32 s46, s46, s88
    s_lshl_b32 s86, s83, 2
    s_add_u32 s86, s86, 1024
    s_mov_b32 s85, 0
poll_15:
    v_mov_b32 v254, s86
    buffer_load_dword v254, v254, s[4:7], s80 offen sc1
    s_waitcnt vmcnt(0)
    v_readfirstlane_b32 s84, v254
    s_cmp_ge_u32 s84, 4
    s_cbranch_scc1 poll_15_ok
    s_sleep 8
    s_add_u32 s85, s85, 1
    s_cmp_le_u32 s85, 262144
    s_cbranch_scc1 poll_15
poll_15_ok:
    s_add_u32 s48, s46, 0
    buffer_load_dwordx4 v[128:131], v5, s[4:7], s48 offen offset:0 sc1
    buffer_load_dwordx4 v[136:139], v5, s[4:7], s48 offen offset:1024 sc1
    buffer_load_dwordx4 v[144:147], v5, s[4:7], s48 offen offset:2048 sc1
    buffer_load_dwordx4 v[152:155], v5, s[4:7], s48 offen offset:3072 sc1
    s_add_u32 s48, s46, 4096
    buffer_load_dwordx4 v[160:163], v5, s[4:7], s48 offen offset:0 sc1
    buffer_load_dwordx4 v[168:171], v5, s[4:7], s48 offen offset:1024 sc1
    buffer_load_dwordx4 v[176:179], v5, s[4:7], s48 offen offset:2048 sc1
    buffer_load_dwordx4 v[184:187], v5, s[4:7], s48 offen offset:3072 sc1
    s_add_u32 s48, s46, 8192
    buffer_load_dwordx4 v[192:195], v5, s[4:7], s48 offen offset:0 sc1
    buffer_load_dwordx4 v[200:203], v5, s[4:7], s48 offen offset:1024 sc1
    buffer_load_dwordx4 v[208:211], v5, s[4:7], s48 offen offset:2048 sc1
    buffer_load_dwordx4 v[216:219], v5, s[4:7], s48 offen offset:3072 sc1
    s_add_u32 s48, s46, 12288
    buffer_load_dwordx4 v[224:227], v5, s[4:7], s48 offen offset:0 sc1
    buffer_load_dwordx4 v[232:235], v5, s[4:7], s48 offen offset:1024 sc1
    buffer_load_dwordx4 v[240:243], v5, s[4:7], s48 offen offset:2048 sc1
    buffer_load_dwordx4 v[248:251], v5, s[4:7], s48 offen offset:3072 sc1
    s_add_u32 s48, s46, 16384
    buffer_load_dwordx4 v[132:135], v5, s[4:7], s48 offen offset:0 sc1
    buffer_load_dwordx4 v[140:143], v5, s[4:7], s48 offen offset:1024 sc1
    buffer_load_dwordx4 v[148:151], v5, s[4:7], s48 offen offset:2048 sc1
    buffer_load_dwordx4 v[156:159], v5, s[4:7], s48 offen offset:3072 sc1
    s_add_u32 s48, s46, 20480
    buffer_load_dwordx4 v[164:167], v5, s[4:7], s48 offen offset:0 sc1
    buffer_load_dwordx4 v[172:175], v5, s[4:7], s48 offen offset:1024 sc1
    buffer_load_dwordx4 v[180:183], v5, s[4:7], s48 offen offset:2048 sc1
    buffer_load_dwordx4 v[188:191], v5, s[4:7], s48 offen offset:3072 sc1
    s_add_u32 s48, s46, 24576
    buffer_load_dwordx4 v[196:199], v5, s[4:7], s48 offen offset:0 sc1
    buffer_load_dwordx4 v[204:207], v5, s[4:7], s48 offen offset:1024 sc1
    buffer_load_dwordx4 v[212:215], v5, s[4:7], s48 offen offset:2048 sc1
    buffer_load_dwordx4 v[220:223], v5, s[4:7], s48 offen offset:3072 sc1
    s_add_u32 s48, s46, 28672
    buffer_load_dwordx4 v[228:231], v5, s[4:7], s48 offen offset:0 sc1
    buffer_load_dwordx4 v[236:239], v5, s[4:7], s48 offen offset:1024 sc1
    buffer_load_dwordx4 v[244:247], v5, s[4:7], s48 offen offset:2048 sc1
    buffer_load_dwordx4 v[252:255], v5, s[4:7], s48 offen offset:3072 sc1
    s_waitcnt vmcnt(15)
    v_mfma_f32_16x16x32_bf16 v[64:67], a[0:3], v[128:131], 0
    v_mfma_f32_16x16x32_bf16 v[72:75], v[128:131], a[64:67], 0
    v_mfma_f32_16x16x32_bf16 v[80:83], v[128:131], a[128:131], 0
    v_mfma_f32_16x16x32_bf16 v[68:71], a[0:3], v[132:135], 0
    v_mfma_f32_16x16x32_bf16 v[76:79], v[132:135], a[64:67], 0
    v_mfma_f32_16x16x32_bf16 v[84:87], v[132:135], a[128:131], 0
    s_waitcnt vmcnt(14)
    v_mfma_f32_16x16x32_bf16 v[64:67], a[4:7], v[136:139], v[64:67]
    v_mfma_f32_16x16x32_bf16 v[72:75], v[136:139], a[68:71], v[72:75]
    v_mfma_f32_16x16x32_bf16 v[80:83], v[136:139], a[132:135], v[80:83]
    v_mfma_f32_16x16x32_bf16 v[68:71], a[4:7], v[140:143], v[68:71]
    v_mfma_f32_16x16x32_bf16 v[76:79], v[140:143], a[68:71], v[76:79]
    v_mfma_f32_16x16x32_bf16 v[84:87], v[140:143], a[132:135], v[84:87]
    s_waitcnt vmcnt(13)
    v_mfma_f32_16x16x32_bf16 v[64:67], a[8:11], v[144:147], v[64:67]
    v_mfma_f32_16x16x32_bf16 v[72:75], v[144:147], a[72:75], v[72:75]
    v_mfma_f32_16x16x32_bf16 v[80:83], v[144:147], a[136:139], v[80:83]
    v_mfma_f32_16x16x32_bf16 v[68:71], a[8:11], v[148:151], v[68:71]
    v_mfma_f32_16x16x32_bf16 v[76:79], v[148:151], a[72:75], v[76:79]
    v_mfma_f32_16x16x32_bf16 v[84:87], v[148:151], a[136:139], v[84:87]
    s_waitcnt vmcnt(12)
    v_mfma_f32_16x16x32_bf16 v[64:67], a[12:15], v[152:155], v[64:67]
    v_mfma_f32_16x16x32_bf16 v[72:75], v[152:155], a[76:79], v[72:75]
    v_mfma_f32_16x16x32_bf16 v[80:83], v[152:155], a[140:143], v[80:83]
    v_mfma_f32_16x16x32_bf16 v[68:71], a[12:15], v[156:159], v[68:71]
    v_mfma_f32_16x16x32_bf16 v[76:79], v[156:159], a[76:79], v[76:79]
    v_mfma_f32_16x16x32_bf16 v[84:87], v[156:159], a[140:143], v[84:87]
    s_waitcnt vmcnt(11)
    v_mfma_f32_16x16x32_bf16 v[64:67], a[16:19], v[160:163], v[64:67]
    v_mfma_f32_16x16x32_bf16 v[72:75], v[160:163], a[80:83], v[72:75]
    v_mfma_f32_16x16x32_bf16 v[80:83], v[160:163], a[144:147], v[80:83]
    v_mfma_f32_16x16x32_bf16 v[68:71], a[16:19], v[164:167], v[68:71]
    v_mfma_f32_16x16x32_bf16 v[76:79], v[164:167], a[80:83], v[76:79]
    v_mfma_f32_16x16x32_bf16 v[84:87], v[164:167], a[144:147], v[84:87]
    s_waitcnt vmcnt(10)
    v_mfma_f32_16x16x32_bf16 v[64:67], a[20:23], v[168:171], v[64:67]
    v_mfma_f32_16x16x32_bf16 v[72:75], v[168:171], a[84:87], v[72:75]
    v_mfma_f32_16x16x32_bf16 v[80:83], v[168:171], a[148:151], v[80:83]
    v_mfma_f32_16x16x32_bf16 v[68:71], a[20:23], v[172:175], v[68:71]
    v_mfma_f32_16x16x32_bf16 v[76:79], v[172:175], a[84:87], v[76:79]
    v_mfma_f32_16x16x32_bf16 v[84:87], v[172:175], a[148:151], v[84:87]
    s_waitcnt vmcnt(9)
    v_mfma_f32_16x16x32_bf16 v[64:67], a[24:27], v[176:179], v[64:67]
    v_mfma_f32_16x16x32_bf16 v[72:75], v[176:179], a[88:91], v[72:75]
    v_mfma_f32_16x16x32_bf16 v[80:83], v[176:179], a[152:155], v[80:83]
    v_mfma_f32_16x16x32_bf16 v[68:71], a[24:27], v[180:183], v[68:71]
    v_mfma_f32_16x16x32_bf16 v[76:79], v[180:183], a[88:91], v[76:79]
    v_mfma_f32_16x16x32_bf16 v[84:87], v[180:183], a[152:155], v[84:87]
    s_waitcnt vmcnt(8)
    v_mfma_f32_16x16x32_bf16 v[64:67], a[28:31], v[184:187], v[64:67]
    v_mfma_f32_16x16x32_bf16 v[72:75], v[184:187], a[92:95], v[72:75]
    v_mfma_f32_16x16x32_bf16 v[80:83], v[184:187], a[156:159], v[80:83]
    v_mfma_f32_16x16x32_bf16 v[68:71], a[28:31], v[188:191], v[68:71]
    v_mfma_f32_16x16x32_bf16 v[76:79], v[188:191], a[92:95], v[76:79]
    v_mfma_f32_16x16x32_bf16 v[84:87], v[188:191], a[156:159], v[84:87]
    s_waitcnt vmcnt(7)
    v_mfma_f32_16x16x32_bf16 v[64:67], a[32:35], v[192:195], v[64:67]
    v_mfma_f32_16x16x32_bf16 v[72:75], v[192:195], a[96:99], v[72:75]
    v_mfma_f32_16x16x32_bf16 v[80:83], v[192:195], a[160:163], v[80:83]
    v_mfma_f32_16x16x32_bf16 v[68:71], a[32:35], v[196:199], v[68:71]
    v_mfma_f32_16x16x32_bf16 v[76:79], v[196:199], a[96:99], v[76:79]
    v_mfma_f32_16x16x32_bf16 v[84:87], v[196:199], a[160:163], v[84:87]
    s_waitcnt vmcnt(6)
    v_mfma_f32_16x16x32_bf16 v[64:67], a[36:39], v[200:203], v[64:67]
    v_mfma_f32_16x16x32_bf16 v[72:75], v[200:203], a[100:103], v[72:75]
    v_mfma_f32_16x16x32_bf16 v[80:83], v[200:203], a[164:167], v[80:83]
    v_mfma_f32_16x16x32_bf16 v[68:71], a[36:39], v[204:207], v[68:71]
    v_mfma_f32_16x16x32_bf16 v[76:79], v[204:207], a[100:103], v[76:79]
    v_mfma_f32_16x16x32_bf16 v[84:87], v[204:207], a[164:167], v[84:87]
    s_waitcnt vmcnt(5)
    v_mfma_f32_16x16x32_bf16 v[64:67], a[40:43], v[208:211], v[64:67]
    v_mfma_f32_16x16x32_bf16 v[72:75], v[208:211], a[104:107], v[72:75]
    v_mfma_f32_16x16x32_bf16 v[80:83], v[208:211], a[168:171], v[80:83]
    v_mfma_f32_16x16x32_bf16 v[68:71], a[40:43], v[212:215], v[68:71]
    v_mfma_f32_16x16x32_bf16 v[76:79], v[212:215], a[104:107], v[76:79]
    v_mfma_f32_16x16x32_bf16 v[84:87], v[212:215], a[168:171], v[84:87]
    s_waitcnt vmcnt(4)
    v_mfma_f32_16x16x32_bf16 v[64:67], a[44:47], v[216:219], v[64:67]
    v_mfma_f32_16x16x32_bf16 v[72:75], v[216:219], a[108:111], v[72:75]
    v_mfma_f32_16x16x32_bf16 v[80:83], v[216:219], a[172:175], v[80:83]
    v_mfma_f32_16x16x32_bf16 v[68:71], a[44:47], v[220:223], v[68:71]
    v_mfma_f32_16x16x32_bf16 v[76:79], v[220:223], a[108:111], v[76:79]
    v_mfma_f32_16x16x32_bf16 v[84:87], v[220:223], a[172:175], v[84:87]
    s_waitcnt vmcnt(3)
    v_mfma_f32_16x16x32_bf16 v[64:67], a[48:51], v[224:227], v[64:67]
    v_mfma_f32_16x16x32_bf16 v[72:75], v[224:227], a[112:115], v[72:75]
    v_mfma_f32_16x16x32_bf16 v[80:83], v[224:227], a[176:179], v[80:83]
    v_mfma_f32_16x16x32_bf16 v[68:71], a[48:51], v[228:231], v[68:71]
    v_mfma_f32_16x16x32_bf16 v[76:79], v[228:231], a[112:115], v[76:79]
    v_mfma_f32_16x16x32_bf16 v[84:87], v[228:231], a[176:179], v[84:87]
    s_waitcnt vmcnt(2)
    v_mfma_f32_16x16x32_bf16 v[64:67], a[52:55], v[232:235], v[64:67]
    v_mfma_f32_16x16x32_bf16 v[72:75], v[232:235], a[116:119], v[72:75]
    v_mfma_f32_16x16x32_bf16 v[80:83], v[232:235], a[180:183], v[80:83]
    v_mfma_f32_16x16x32_bf16 v[68:71], a[52:55], v[236:239], v[68:71]
    v_mfma_f32_16x16x32_bf16 v[76:79], v[236:239], a[116:119], v[76:79]
    v_mfma_f32_16x16x32_bf16 v[84:87], v[236:239], a[180:183], v[84:87]
    s_waitcnt vmcnt(1)
    v_mfma_f32_16x16x32_bf16 v[64:67], a[56:59], v[240:243], v[64:67]
    v_mfma_f32_16x16x32_bf16 v[72:75], v[240:243], a[120:123], v[72:75]
    v_mfma_f32_16x16x32_bf16 v[80:83], v[240:243], a[184:187], v[80:83]
    v_mfma_f32_16x16x32_bf16 v[68:71], a[56:59], v[244:247], v[68:71]
    v_mfma_f32_16x16x32_bf16 v[76:79], v[244:247], a[120:123], v[76:79]
    v_mfma_f32_16x16x32_bf16 v[84:87], v[244:247], a[184:187], v[84:87]
    s_waitcnt vmcnt(0)
    v_mfma_f32_16x16x32_bf16 v[64:67], a[60:63], v[248:251], v[64:67]
    v_mfma_f32_16x16x32_bf16 v[72:75], v[248:251], a[124:127], v[72:75]
    v_mfma_f32_16x16x32_bf16 v[80:83], v[248:251], a[188:191], v[80:83]
    v_mfma_f32_16x16x32_bf16 v[68:71], a[60:63], v[252:255], v[68:71]
    v_mfma_f32_16x16x32_bf16 v[76:79], v[252:255], a[124:127], v[76:79]
    v_mfma_f32_16x16x32_bf16 v[84:87], v[252:255], a[188:191], v[84:87]
    s_nop 2
    v_cvt_pk_bf16_f32 v16, v64, v64
    v_lshlrev_b32 v64, 16, v16
    v_add_f32 v16, 1.0, v64
    v_mul_f32 v17, 0x3fb8aa3b, v64
    v_exp_f32 v17, v17
    v_cmp_lt_f32 vcc, 0, v64
    s_nop 1
    v_cndmask_b32 v64, v17, v16, vcc
    v_cvt_pk_bf16_f32 v16, v64, v64
    v_lshlrev_b32 v64, 16, v16
    v_add_f32 v64, 0x358637bd, v64
    v_cvt_pk_bf16_f32 v16, v64, v64
    v_lshlrev_b32 v64, 16, v16
    v_cvt_pk_bf16_f32 v18, v65, v65
    v_lshlrev_b32 v65, 16, v18
    v_add_f32 v18, 1.0, v65
    v_mul_f32 v19, 0x3fb8aa3b, v65
    v_exp_f32 v19, v19
    v_cmp_lt_f32 vcc, 0, v65
    s_nop 1
    v_cndmask_b32 v65, v19, v18, vcc
    v_cvt_pk_bf16_f32 v18, v65, v65
    v_lshlrev_b32 v65, 16, v18
    v_add_f32 v65, 0x358637bd, v65
    v_cvt_pk_bf16_f32 v18, v65, v65
    v_lshlrev_b32 v65, 16, v18
    v_cvt_pk_bf16_f32 v16, v66, v66
    v_lshlrev_b32 v66, 16, v16
    v_add_f32 v16, 1.0, v66
    v_mul_f32 v17, 0x3fb8aa3b, v66
    v_exp_f32 v17, v17
    v_cmp_lt_f32 vcc, 0, v66
    s_nop 1
    v_cndmask_b32 v66, v17, v16, vcc
    v_cvt_pk_bf16_f32 v16, v66, v66
    v_lshlrev_b32 v66, 16, v16
    v_add_f32 v66, 0x358637bd, v66
    v_cvt_pk_bf16_f32 v16, v66, v66
    v_lshlrev_b32 v66, 16, v16
    v_cvt_pk_bf16_f32 v18, v67, v67
    v_lshlrev_b32 v67, 16, v18
    v_add_f32 v18, 1.0, v67
    v_mul_f32 v19, 0x3fb8aa3b, v67
    v_exp_f32 v19, v19
    v_cmp_lt_f32 vcc, 0, v67
    s_nop 1
    v_cndmask_b32 v67, v19, v18, vcc
    v_cvt_pk_bf16_f32 v18, v67, v67
    v_lshlrev_b32 v67, 16, v18
    v_add_f32 v67, 0x358637bd, v67
    v_cvt_pk_bf16_f32 v18, v67, v67
    v_lshlrev_b32 v67, 16, v18
    v_cvt_pk_bf16_f32 v16, v68, v68
    v_lshlrev_b32 v68, 16, v16
    v_add_f32 v16, 1.0, v68
    v_mul_f32 v17, 0x3fb8aa3b, v68
    v_exp_f32 v17, v17
    v_cmp_lt_f32 vcc, 0, v68
    s_nop 1
    v_cndmask_b32 v68, v17, v16, vcc
    v_cvt_pk_bf16_f32 v16, v68, v68
    v_lshlrev_b32 v68, 16, v16
    v_add_f32 v68, 0x358637bd, v68
    v_cvt_pk_bf16_f32 v16, v68, v68
    v_lshlrev_b32 v68, 16, v16
    v_cvt_pk_bf16_f32 v18, v69, v69
    v_lshlrev_b32 v69, 16, v18
    v_add_f32 v18, 1.0, v69
    v_mul_f32 v19, 0x3fb8aa3b, v69
    v_exp_f32 v19, v19
    v_cmp_lt_f32 vcc, 0, v69
    s_nop 1
    v_cndmask_b32 v69, v19, v18, vcc
    v_cvt_pk_bf16_f32 v18, v69, v69
    v_lshlrev_b32 v69, 16, v18
    v_add_f32 v69, 0x358637bd, v69
    v_cvt_pk_bf16_f32 v18, v69, v69
    v_lshlrev_b32 v69, 16, v18
    v_cvt_pk_bf16_f32 v16, v70, v70
    v_lshlrev_b32 v70, 16, v16
    v_add_f32 v16, 1.0, v70
    v_mul_f32 v17, 0x3fb8aa3b, v70
    v_exp_f32 v17, v17
    v_cmp_lt_f32 vcc, 0, v70
    s_nop 1
    v_cndmask_b32 v70, v17, v16, vcc
    v_cvt_pk_bf16_f32 v16, v70, v70
    v_lshlrev_b32 v70, 16, v16
    v_add_f32 v70, 0x358637bd, v70
    v_cvt_pk_bf16_f32 v16, v70, v70
    v_lshlrev_b32 v70, 16, v16
    v_cvt_pk_bf16_f32 v18, v71, v71
    v_lshlrev_b32 v71, 16, v18
    v_add_f32 v18, 1.0, v71
    v_mul_f32 v19, 0x3fb8aa3b, v71
    v_exp_f32 v19, v19
    v_cmp_lt_f32 vcc, 0, v71
    s_nop 1
    v_cndmask_b32 v71, v19, v18, vcc
    v_cvt_pk_bf16_f32 v18, v71, v71
    v_lshlrev_b32 v71, 16, v18
    v_add_f32 v71, 0x358637bd, v71
    v_cvt_pk_bf16_f32 v18, v71, v71
    v_lshlrev_b32 v71, 16, v18
    v_cvt_pk_bf16_f32 v16, v72, v72
    v_lshlrev_b32 v72, 16, v16
    v_add_f32 v16, 1.0, v72
    v_mul_f32 v17, 0x3fb8aa3b, v72
    v_exp_f32 v17, v17
    v_cmp_lt_f32 vcc, 0, v72
    s_nop 1
    v_cndmask_b32 v72, v17, v16, vcc
    v_cvt_pk_bf16_f32 v16, v72, v72
    v_lshlrev_b32 v72, 16, v16
    v_add_f32 v72, 0x358637bd, v72
    v_cvt_pk_bf16_f32 v16, v72, v72
    v_lshlrev_b32 v72, 16, v16
    v_cvt_pk_bf16_f32 v18, v73, v73
    v_lshlrev_b32 v73, 16, v18
    v_add_f32 v18, 1.0, v73
    v_mul_f32 v19, 0x3fb8aa3b, v73
    v_exp_f32 v19, v19
    v_cmp_lt_f32 vcc, 0, v73
    s_nop 1
    v_cndmask_b32 v73, v19, v18, vcc
    v_cvt_pk_bf16_f32 v18, v73, v73
    v_lshlrev_b32 v73, 16, v18
    v_add_f32 v73, 0x358637bd, v73
    v_cvt_pk_bf16_f32 v18, v73, v73
    v_lshlrev_b32 v73, 16, v18
    v_cvt_pk_bf16_f32 v16, v74, v74
    v_lshlrev_b32 v74, 16, v16
    v_add_f32 v16, 1.0, v74
    v_mul_f32 v17, 0x3fb8aa3b, v74
    v_exp_f32 v17, v17
    v_cmp_lt_f32 vcc, 0, v74
    s_nop 1
    v_cndmask_b32 v74, v17, v16, vcc
    v_cvt_pk_bf16_f32 v16, v74, v74
    v_lshlrev_b32 v74, 16, v16
    v_add_f32 v74, 0x358637bd, v74
    v_cvt_pk_bf16_f32 v16, v74, v74
    v_lshlrev_b32 v74, 16, v16
    v_cvt_pk_bf16_f32 v18, v75, v75
    v_lshlrev_b32 v75, 16, v18
    v_add_f32 v18, 1.0, v75
    v_mul_f32 v19, 0x3fb8aa3b, v75
    v_exp_f32 v19, v19
    v_cmp_lt_f32 vcc, 0, v75
    s_nop 1
    v_cndmask_b32 v75, v19, v18, vcc
    v_cvt_pk_bf16_f32 v18, v75, v75
    v_lshlrev_b32 v75, 16, v18
    v_add_f32 v75, 0x358637bd, v75
    v_cvt_pk_bf16_f32 v18, v75, v75
    v_lshlrev_b32 v75, 16, v18
    v_cvt_pk_bf16_f32 v16, v76, v76
    v_lshlrev_b32 v76, 16, v16
    v_add_f32 v16, 1.0, v76
    v_mul_f32 v17, 0x3fb8aa3b, v76
    v_exp_f32 v17, v17
    v_cmp_lt_f32 vcc, 0, v76
    s_nop 1
    v_cndmask_b32 v76, v17, v16, vcc
    v_cvt_pk_bf16_f32 v16, v76, v76
    v_lshlrev_b32 v76, 16, v16
    v_add_f32 v76, 0x358637bd, v76
    v_cvt_pk_bf16_f32 v16, v76, v76
    v_lshlrev_b32 v76, 16, v16
    v_cvt_pk_bf16_f32 v18, v77, v77
    v_lshlrev_b32 v77, 16, v18
    v_add_f32 v18, 1.0, v77
    v_mul_f32 v19, 0x3fb8aa3b, v77
    v_exp_f32 v19, v19
    v_cmp_lt_f32 vcc, 0, v77
    s_nop 1
    v_cndmask_b32 v77, v19, v18, vcc
    v_cvt_pk_bf16_f32 v18, v77, v77
    v_lshlrev_b32 v77, 16, v18
    v_add_f32 v77, 0x358637bd, v77
    v_cvt_pk_bf16_f32 v18, v77, v77
    v_lshlrev_b32 v77, 16, v18
    v_cvt_pk_bf16_f32 v16, v78, v78
    v_lshlrev_b32 v78, 16, v16
    v_add_f32 v16, 1.0, v78
    v_mul_f32 v17, 0x3fb8aa3b, v78
    v_exp_f32 v17, v17
    v_cmp_lt_f32 vcc, 0, v78
    s_nop 1
    v_cndmask_b32 v78, v17, v16, vcc
    v_cvt_pk_bf16_f32 v16, v78, v78
    v_lshlrev_b32 v78, 16, v16
    v_add_f32 v78, 0x358637bd, v78
    v_cvt_pk_bf16_f32 v16, v78, v78
    v_lshlrev_b32 v78, 16, v16
    v_cvt_pk_bf16_f32 v18, v79, v79
    v_lshlrev_b32 v79, 16, v18
    v_add_f32 v18, 1.0, v79
    v_mul_f32 v19, 0x3fb8aa3b, v79
    v_exp_f32 v19, v19
    v_cmp_lt_f32 vcc, 0, v79
    s_nop 1
    v_cndmask_b32 v79, v19, v18, vcc
    v_cvt_pk_bf16_f32 v18, v79, v79
    v_lshlrev_b32 v79, 16, v18
    v_add_f32 v79, 0x358637bd, v79
    v_cvt_pk_bf16_f32 v18, v79, v79
    v_lshlrev_b32 v79, 16, v18
    v_lshlrev_b32 v14, 3, v1
    s_lshl_b32 s46, s44, 14
    s_lshl_b32 s47, s42, 9
    s_add_u32 s46, s46, s47
    s_add_u32 s46, s46, 29360128
    s_add_u32 s46, s46, s88
    s_add_u32 s47, s46, 16384
    v_cvt_pk_bf16_f32 v24, v64, v65
    v_cvt_pk_bf16_f32 v25, v66, v67
    buffer_store_dwordx2 v[24:25], v14, s[4:7], s46 offen sc1
    v_cvt_pk_bf16_f32 v26, v68, v69
    v_cvt_pk_bf16_f32 v27, v70, v71
    buffer_store_dwordx2 v[26:27], v14, s[4:7], s47 offen sc1
    v_cvt_pk_bf16_f32 v32, v72, v73
    v_cvt_pk_bf16_f32 v33, v74, v75
    v_cvt_pk_bf16_f32 v34, v76, v77
    v_cvt_pk_bf16_f32 v35, v78, v79
    v_cvt_pk_bf16_f32 v36, v80, v81
    v_cvt_pk_bf16_f32 v37, v82, v83
    v_cvt_pk_bf16_f32 v38, v84, v85
    v_cvt_pk_bf16_f32 v39, v86, v87
    v_mov_b32 v48, 0x3f803f80
    v_mov_b32 v49, 0x3f803f80
    v_mov_b32 v50, 0x3f803f80
    v_mov_b32 v51, 0x3f803f80
    v_mfma_f32_16x16x32_bf16 v[96:99], v[32:35], v[36:39], 0
    s_nop 0
    v_mfma_f32_16x16x32_bf16 v[100:103], v[32:35], v[48:51], 0
    s_lshl_b32 s46, s43, 11
    v_add_u32 v15, s46, v5
    s_nop 3
    ds_write_b128 v15, v[96:99] offset:0
    s_nop 0
    ds_write_b128 v15, v[100:103] offset:1024
    s_waitcnt lgkmcnt(0)
    s_barrier
    s_cmp_ge_u32 s43, 2
    s_cbranch_scc1 b1e_16
    s_lshl_b32 s46, s43, 10
    v_add_u32 v15, s46, v5
    ds_read_b128 v[104:107], v15 offset:0
    ds_read_b128 v[108:111], v15 offset:2048
    ds_read_b128 v[112:115], v15 offset:4096
    ds_read_b128 v[116:119], v15 offset:6144
    s_waitcnt lgkmcnt(0)
    v_add_f32 v104, v104, v108
    v_add_f32 v112, v112, v116
    v_add_f32 v104, v104, v112
    v_add_f32 v105, v105, v109
    v_add_f32 v113, v113, v117
    v_add_f32 v105, v105, v113
    v_add_f32 v106, v106, v110
    v_add_f32 v114, v114, v118
    v_add_f32 v106, v106, v114
    v_add_f32 v107, v107, v111
    v_add_f32 v115, v115, v119
    v_add_f32 v107, v107, v115
    v_mul_u32_u24 v6, 272, v4
    v_lshl_add_u32 v7, v3, 2, v6
    v_add_u32 v6, 64, v6
    v_mov_b32 v8, 0x7fffff00
    v_cmp_eq_u32 vcc, 0, v3
    s_nop 1
    v_cndmask_b32 v6, v8, v6, vcc
    s_cmp_eq_u32 s43, 1
    s_cselect_b64 vcc, -1, 0
    v_cndmask_b32 v6, v7, v6, vcc
    s_mul_i32 s46, s42, 1088
    s_add_u32 s46, s46, 104857600
    s_lshl_b32 s47, s89, 16
    s_add_u32 s46, s46, s47
    buffer_atomic_add_f32 v104, v6, s[4:7], s46 offen offset:0
    buffer_atomic_add_f32 v105, v6, s[4:7], s46 offen offset:68
    buffer_atomic_add_f32 v106, v6, s[4:7], s46 offen offset:136
    buffer_atomic_add_f32 v107, v6, s[4:7], s46 offen offset:204
b1e_16:
    s_mov_b32 s82, 1152
    s_waitcnt vmcnt(0)
    s_barrier
    s_cmp_lg_u32 s14, 0
    s_cbranch_scc1 sig_17
    s_mov_b64 exec, 1
    v_mov_b32 v2, s82
    v_mov_b32 v3, 1
    buffer_atomic_add v3, v2, s[4:7], s80 offen
    s_mov_b64 exec, -1
sig_17:
    s_branch mega_kernel_next
mega_kernel_b2:
    s_sub_u32 s40, s81, 2048
    s_mov_b32 s41, s40
    v_and_b32 v1, 63, v0
    v_lshrrev_b32 v2, 6, v0
    s_nop 0
    v_readfirstlane_b32 s43, v2
    v_and_b32 v3, 15, v1
    v_lshrrev_b32 v4, 4, v1
    v_lshlrev_b32 v5, 4, v1
    s_lshl_b32 s46, s43, 17
    s_add_u32 s46, s46, 18350080
    s_add_u32 s48, s46, 0
    buffer_load_dwordx4 a[0:3], v5, s[4:7], s48 offen offset:0
    buffer_load_dwordx4 a[32:35], v5, s[4:7], s48 offen offset:1024
    buffer_load_dwordx4 a[64:67], v5, s[4:7], s48 offen offset:2048
    buffer_load_dwordx4 a[96:99], v5, s[4:7], s48 offen offset:3072
    s_add_u32 s48, s46, 4096
    buffer_load_dwordx4 a[128:131], v5, s[4:7], s48 offen offset:0
    buffer_load_dwordx4 a[160:163], v5, s[4:7], s48 offen offset:1024
    buffer_load_dwordx4 a[192:195], v5, s[4:7], s48 offen offset:2048
    buffer_load_dwordx4 a[224:227], v5, s[4:7], s48 offen offset:3072
    s_add_u32 s48, s46, 16384
    buffer_load_dwordx4 a[4:7], v5, s[4:7], s48 offen offset:0
    buffer_load_dwordx4 a[36:39], v5, s[4:7], s48 offen offset:1024
    buffer_load_dwordx4 a[68:71], v5, s[4:7], s48 offen offset:2048
    buffer_load_dwordx4 a[100:103], v5, s[4:7], s48 offen offset:3072
    s_add_u32 s48, s46, 20480
    buffer_load_dwordx4 a[132:135], v5, s[4:7], s48 offen offset:0
    buffer_load_dwordx4 a[164:167], v5, s[4:7], s48 offen offset:1024
    buffer_load_dwordx4 a[196:199], v5, s[4:7], s48 offen offset:2048
    buffer_load_dwordx4 a[228:231], v5, s[4:7], s48 offen offset:3072
    s_add_u32 s48, s46, 32768
    buffer_load_dwordx4 a[8:11], v5, s[4:7], s48 offen offset:0
    buffer_load_dwordx4 a[40:43], v5, s[4:7], s48 offen offset:1024
    buffer_load_dwordx4 a[72:75], v5, s[4:7], s48 offen offset:2048
    buffer_load_dwordx4 a[104:107], v5, s[4:7], s48 offen offset:3072
    s_add_u32 s48, s46, 36864
    buffer_load_dwordx4 a[136:139], v5, s[4:7], s48 offen offset:0
    buffer_load_dwordx4 a[168:171], v5, s[4:7], s48 offen offset:1024
    buffer_load_dwordx4 a[200:203], v5, s[4:7], s48 offen offset:2048
    buffer_load_dwordx4 a[232:235], v5, s[4:7], s48 offen offset:3072
    s_add_u32 s48, s46, 49152
    buffer_load_dwordx4 a[12:15], v5, s[4:7], s48 offen offset:0
    buffer_load_dwordx4 a[44:47], v5, s[4:7], s48 offen offset:1024
    buffer_load_dwordx4 a[76:79], v5, s[4:7], s48 offen offset:2048
    buffer_load_dwordx4 a[108:111], v5, s[4:7], s48 offen offset:3072
    s_add_u32 s48, s46, 53248
    buffer_load_dwordx4 a[140:143], v5, s[4:7], s48 offen offset:0
    buffer_load_dwordx4 a[172:175], v5, s[4:7], s48 offen offset:1024
    buffer_load_dwordx4 a[204:207], v5, s[4:7], s48 offen offset:2048
    buffer_load_dwordx4 a[236:239], v5, s[4:7], s48 offen offset:3072
    s_add_u32 s48, s46, 65536
    buffer_load_dwordx4 a[16:19], v5, s[4:7], s48 offen offset:0
    buffer_load_dwordx4 a[48:51], v5, s[4:7], s48 offen offset:1024
    buffer_load_dwordx4 a[80:83], v5, s[4:7], s48 offen offset:2048
    buffer_load_dwordx4 a[112:115], v5, s[4:7], s48 offen offset:3072
    s_add_u32 s48, s46, 69632
    buffer_load_dwordx4 a[144:147], v5, s[4:7], s48 offen offset:0
    buffer_load_dwordx4 a[176:179], v5, s[4:7], s48 offen offset:1024
    buffer_load_dwordx4 a[208:211], v5, s[4:7], s48 offen offset:2048
    buffer_load_dwordx4 a[240:243], v5, s[4:7], s48 offen offset:3072
    s_add_u32 s48, s46, 81920
    buffer_load_dwordx4 a[20:23], v5, s[4:7], s48 offen offset:0
    buffer_load_dwordx4 a[52:55], v5, s[4:7], s48 offen offset:1024
    buffer_load_dwordx4 a[84:87], v5, s[4:7], s48 offen offset:2048
    buffer_load_dwordx4 a[116:119], v5, s[4:7], s48 offen offset:3072
    s_add_u32 s48, s46, 86016
    buffer_load_dwordx4 a[148:151], v5, s[4:7], s48 offen offset:0
    buffer_load_dwordx4 a[180:183], v5, s[4:7], s48 offen offset:1024
    buffer_load_dwordx4 a[212:215], v5, s[4:7], s48 offen offset:2048
    buffer_load_dwordx4 a[244:247], v5, s[4:7], s48 offen offset:3072
    s_add_u32 s48, s46, 98304
    buffer_load_dwordx4 a[24:27], v5, s[4:7], s48 offen offset:0
    buffer_load_dwordx4 a[56:59], v5, s[4:7], s48 offen offset:1024
    buffer_load_dwordx4 a[88:91], v5, s[4:7], s48 offen offset:2048
    buffer_load_dwordx4 a[120:123], v5, s[4:7], s48 offen offset:3072
    s_add_u32 s48, s46, 102400
    buffer_load_dwordx4 a[152:155], v5, s[4:7], s48 offen offset:0
    buffer_load_dwordx4 a[184:187], v5, s[4:7], s48 offen offset:1024
    buffer_load_dwordx4 a[216:219], v5, s[4:7], s48 offen offset:2048
    buffer_load_dwordx4 a[248:251], v5, s[4:7], s48 offen offset:3072
    s_add_u32 s48, s46, 114688
    buffer_load_dwordx4 a[28:31], v5, s[4:7], s48 offen offset:0
    buffer_load_dwordx4 a[60:63], v5, s[4:7], s48 offen offset:1024
    buffer_load_dwordx4 a[92:95], v5, s[4:7], s48 offen offset:2048
    buffer_load_dwordx4 a[124:127], v5, s[4:7], s48 offen offset:3072
    s_add_u32 s48, s46, 118784
    buffer_load_dwordx4 a[156:159], v5, s[4:7], s48 offen offset:0
    buffer_load_dwordx4 a[188:191], v5, s[4:7], s48 offen offset:1024
    buffer_load_dwordx4 a[220:223], v5, s[4:7], s48 offen offset:2048
    buffer_load_dwordx4 a[252:255], v5, s[4:7], s48 offen offset:3072
    s_mov_b32 s85, 0
poll_19:
    v_mov_b32 v254, 1152
    buffer_load_dword v254, v254, s[4:7], s80 offen sc1
    s_waitcnt vmcnt(0)
    v_readfirstlane_b32 s84, v254
    s_cmp_ge_u32 s84, 512
    s_cbranch_scc1 poll_19_ok
    s_sleep 8
    s_add_u32 s85, s85, 1
    s_cmp_le_u32 s85, 262144
    s_cbranch_scc1 poll_19
poll_19_ok:
    v_mul_u32_u24 v6, 272, v4
    v_lshl_add_u32 v7, v3, 2, v6
    s_mul_i32 s46, s43, 8704
    s_add_u32 s46, s46, 104857600
    s_lshl_b32 s47, s89, 16
    s_add_u32 s46, s46, s47
    buffer_load_dword v192, v7, s[4:7], s46 offen offset:0 sc1
    buffer_load_dword v196, v6, s[4:7], s46 offen offset:64 sc1
    buffer_load_dword v193, v7, s[4:7], s46 offen offset:68 sc1
    buffer_load_dword v197, v6, s[4:7], s46 offen offset:132 sc1
    buffer_load_dword v194, v7, s[4:7], s46 offen offset:136 sc1
    buffer_load_dword v198, v6, s[4:7], s46 offen offset:200 sc1
    buffer_load_dword v195, v7, s[4:7], s46 offen offset:204 sc1
    buffer_load_dword v199, v6, s[4:7], s46 offen offset:268 sc1
    buffer_load_dword v200, v7, s[4:7], s46 offen offset:1088 sc1
    buffer_load_dword v204, v6, s[4:7], s46 offen offset:1152 sc1
    buffer_load_dword v201, v7, s[4:7], s46 offen offset:1156 sc1
    buffer_load_dword v205, v6, s[4:7], s46 offen offset:1220 sc1
    buffer_load_dword v202, v7, s[4:7], s46 offen offset:1224 sc1
    buffer_load_dword v206, v6, s[4:7], s46 offen offset:1288 sc1
    buffer_load_dword v203, v7, s[4:7], s46 offen offset:1292 sc1
    buffer_load_dword v207, v6, s[4:7], s46 offen offset:1356 sc1
    buffer_load_dword v208, v7, s[4:7], s46 offen offset:2176 sc1
    buffer_load_dword v212, v6, s[4:7], s46 offen offset:2240 sc1
    buffer_load_dword v209, v7, s[4:7], s46 offen offset:2244 sc1
    buffer_load_dword v213, v6, s[4:7], s46 offen offset:2308 sc1
    buffer_load_dword v210, v7, s[4:7], s46 offen offset:2312 sc1
    buffer_load_dword v214, v6, s[4:7], s46 offen offset:2376 sc1
    buffer_load_dword v211, v7, s[4:7], s46 offen offset:2380 sc1
    buffer_load_dword v215, v6, s[4:7], s46 offen offset:2444 sc1
    s_add_u32 s46, s46, 3264
    buffer_load_dword v216, v7, s[4:7], s46 offen offset:0 sc1
    buffer_load_dword v220, v6, s[4:7], s46 offen offset:64 sc1
    buffer_load_dword v217, v7, s[4:7], s46 offen offset:68 sc1
    buffer_load_dword v221, v6, s[4:7], s46 offen offset:132 sc1
    buffer_load_dword v218, v7, s[4:7], s46 offen offset:136 sc1
    buffer_load_dword v222, v6, s[4:7], s46 offen offset:200 sc1
    buffer_load_dword v219, v7, s[4:7], s46 offen offset:204 sc1
    buffer_load_dword v223, v6, s[4:7], s46 offen offset:268 sc1
    buffer_load_dword v224, v7, s[4:7], s46 offen offset:1088 sc1
    buffer_load_dword v228, v6, s[4:7], s46 offen offset:1152 sc1
    buffer_load_dword v225, v7, s[4:7], s46 offen offset:1156 sc1
    buffer_load_dword v229, v6, s[4:7], s46 offen offset:1220 sc1
    buffer_load_dword v226, v7, s[4:7], s46 offen offset:1224 sc1
    buffer_load_dword v230, v6, s[4:7], s46 offen offset:1288 sc1
    buffer_load_dword v227, v7, s[4:7], s46 offen offset:1292 sc1
    buffer_load_dword v231, v6, s[4:7], s46 offen offset:1356 sc1
    buffer_load_dword v232, v7, s[4:7], s46 offen offset:2176 sc1
    buffer_load_dword v236, v6, s[4:7], s46 offen offset:2240 sc1
    buffer_load_dword v233, v7, s[4:7], s46 offen offset:2244 sc1
    buffer_load_dword v237, v6, s[4:7], s46 offen offset:2308 sc1
    buffer_load_dword v234, v7, s[4:7], s46 offen offset:2312 sc1
    buffer_load_dword v238, v6, s[4:7], s46 offen offset:2376 sc1
    buffer_load_dword v235, v7, s[4:7], s46 offen offset:2380 sc1
    buffer_load_dword v239, v6, s[4:7], s46 offen offset:2444 sc1
    s_add_u32 s46, s46, 3264
    buffer_load_dword v240, v7, s[4:7], s46 offen offset:0 sc1
    buffer_load_dword v244, v6, s[4:7], s46 offen offset:64 sc1
    buffer_load_dword v241, v7, s[4:7], s46 offen offset:68 sc1
    buffer_load_dword v245, v6, s[4:7], s46 offen offset:132 sc1
    buffer_load_dword v242, v7, s[4:7], s46 offen offset:136 sc1
    buffer_load_dword v246, v6, s[4:7], s46 offen offset:200 sc1
    buffer_load_dword v243, v7, s[4:7], s46 offen offset:204 sc1
    buffer_load_dword v247, v6, s[4:7], s46 offen offset:268 sc1
    buffer_load_dword v248, v7, s[4:7], s46 offen offset:1088 sc1
    buffer_load_dword v252, v6, s[4:7], s46 offen offset:1152 sc1
    buffer_load_dword v249, v7, s[4:7], s46 offen offset:1156 sc1
    buffer_load_dword v253, v6, s[4:7], s46 offen offset:1220 sc1
    buffer_load_dword v250, v7, s[4:7], s46 offen offset:1224 sc1
    buffer_load_dword v254, v6, s[4:7], s46 offen offset:1288 sc1
    buffer_load_dword v251, v7, s[4:7], s46 offen offset:1292 sc1
    buffer_load_dword v255, v6, s[4:7], s46 offen offset:1356 sc1
    v_lshlrev_b32 v8, 3, v1
    s_lshl_b32 s46, s41, 14
    s_lshl_b32 s47, s43, 12
    s_add_u32 s46, s46, s47
    s_add_u32 s46, s46, 29360128
    s_add_u32 s46, s46, s88
    buffer_load_dwordx2 v[16:17], v8, s[4:7], s46 offen offset:0 sc1
    buffer_load_dwordx2 v[18:19], v8, s[4:7], s46 offen offset:512 sc1
    buffer_load_dwordx2 v[20:21], v8, s[4:7], s46 offen offset:1024 sc1
    buffer_load_dwordx2 v[22:23], v8, s[4:7], s46 offen offset:1536 sc1
    buffer_load_dwordx2 v[24:25], v8, s[4:7], s46 offen offset:2048 sc1
    buffer_load_dwordx2 v[26:27], v8, s[4:7], s46 offen offset:2560 sc1
    buffer_load_dwordx2 v[28:29], v8, s[4:7], s46 offen offset:3072 sc1
    buffer_load_dwordx2 v[30:31], v8, s[4:7], s46 offen offset:3584 sc1
    v_lshlrev_b32 v9, 10, v3
    v_lshl_add_u32 v9, v4, 3, v9
    s_lshl_b32 s46, s41, 14
    s_lshl_b32 s47, s43, 8
    s_add_u32 s48, s46, s47
    s_lshl_b32 s47, s89, 22
    s_add_u32 s46, s48, s47
    s_add_u32 s46, s46, 23068672
    buffer_load_dwordx2 v[32:33], v9, s[4:7], s46 offen offset:0 sc1
    buffer_load_dwordx2 v[34:35], v9, s[4:7], s46 offen offset:32 sc1
    buffer_load_dwordx2 v[36:37], v9, s[4:7], s46 offen offset:64 sc1
    buffer_load_dwordx2 v[38:39], v9, s[4:7], s46 offen offset:96 sc1
    buffer_load_dwordx2 v[40:41], v9, s[4:7], s46 offen offset:128 sc1
    buffer_load_dwordx2 v[42:43], v9, s[4:7], s46 offen offset:160 sc1
    buffer_load_dwordx2 v[44:45], v9, s[4:7], s46 offen offset:192 sc1
    buffer_load_dwordx2 v[46:47], v9, s[4:7], s46 offen offset:224 sc1
    s_lshl_b32 s46, s43, 17
    s_add_u32 s46, s46, 18350080
    v_add_u32 v48, s46, v5
    s_add_u32 s46, s46, 16384
    v_add_u32 v49, s46, v5
    s_add_u32 s46, s46, 16384
    v_add_u32 v50, s46, v5
    s_add_u32 s46, s46, 16384
    v_add_u32 v51, s46, v5
    s_add_u32 s46, s46, 16384
    v_add_u32 v52, s46, v5
    s_add_u32 s46, s46, 16384
    v_add_u32 v53, s46, v5
    s_add_u32 s46, s46, 16384
    v_add_u32 v54, s46, v5
    s_add_u32 s46, s46, 16384
    v_add_u32 v55, s46, v5
    s_waitcnt vmcnt(8)
    v_cvt_pk_bf16_f32 v96, v192, v193
    v_cvt_pk_bf16_f32 v97, v194, v195
    v_cvt_pk_bf16_f32 v98, v196, v197
    v_cvt_pk_bf16_f32 v99, v198, v199
    v_cvt_pk_bf16_f32 v100, v200, v201
    v_cvt_pk_bf16_f32 v101, v202, v203
    v_cvt_pk_bf16_f32 v102, v204, v205
    v_cvt_pk_bf16_f32 v103, v206, v207
    v_cvt_pk_bf16_f32 v104, v208, v209
    v_cvt_pk_bf16_f32 v105, v210, v211
    v_cvt_pk_bf16_f32 v106, v212, v213
    v_cvt_pk_bf16_f32 v107, v214, v215
    v_cvt_pk_bf16_f32 v108, v216, v217
    v_cvt_pk_bf16_f32 v109, v218, v219
    v_cvt_pk_bf16_f32 v110, v220, v221
    v_cvt_pk_bf16_f32 v111, v222, v223
    v_cvt_pk_bf16_f32 v112, v224, v225
    v_cvt_pk_bf16_f32 v113, v226, v227
    v_cvt_pk_bf16_f32 v114, v228, v229
    v_cvt_pk_bf16_f32 v115, v230, v231
    v_cvt_pk_bf16_f32 v116, v232, v233
    v_cvt_pk_bf16_f32 v117, v234, v235
    v_cvt_pk_bf16_f32 v118, v236, v237
    v_cvt_pk_bf16_f32 v119, v238, v239
    v_cvt_pk_bf16_f32 v120, v240, v241
    v_cvt_pk_bf16_f32 v121, v242, v243
    v_cvt_pk_bf16_f32 v122, v244, v245
    v_cvt_pk_bf16_f32 v123, v246, v247
    v_cvt_pk_bf16_f32 v124, v248, v249
    v_cvt_pk_bf16_f32 v125, v250, v251
    v_cvt_pk_bf16_f32 v126, v252, v253
    v_cvt_pk_bf16_f32 v127, v254, v255
    v_mfma_f32_16x16x16_bf16 v[192:195], v[96:97], v[16:17], 0
    v_mfma_f32_16x16x16_bf16 v[128:131], v[98:99], v[16:17], 0
    v_mfma_f32_16x16x16_bf16 v[196:199], v[100:101], v[18:19], 0
    v_mfma_f32_16x16x16_bf16 v[132:135], v[102:103], v[18:19], 0
    v_mfma_f32_16x16x16_bf16 v[200:203], v[104:105], v[20:21], 0
    v_mfma_f32_16x16x16_bf16 v[136:139], v[106:107], v[20:21], 0
    v_mfma_f32_16x16x16_bf16 v[204:207], v[108:109], v[22:23], 0
    v_mfma_f32_16x16x16_bf16 v[140:143], v[110:111], v[22:23], 0
    v_mfma_f32_16x16x16_bf16 v[208:211], v[112:113], v[24:25], 0
    v_mfma_f32_16x16x16_bf16 v[144:147], v[114:115], v[24:25], 0
    v_mfma_f32_16x16x16_bf16 v[212:215], v[116:117], v[26:27], 0
    v_mfma_f32_16x16x16_bf16 v[148:151], v[118:119], v[26:27], 0
    v_mfma_f32_16x16x16_bf16 v[216:219], v[120:121], v[28:29], 0
    v_mfma_f32_16x16x16_bf16 v[152:155], v[122:123], v[28:29], 0
    v_mfma_f32_16x16x16_bf16 v[220:223], v[124:125], v[30:31], 0
    v_mfma_f32_16x16x16_bf16 v[156:159], v[126:127], v[30:31], 0
    v_cvt_pk_bf16_f32 v10, v128, v128
    v_lshlrev_b32 v128, 16, v10
    v_add_f32 v128, 0x358637bd, v128
    v_cvt_pk_bf16_f32 v10, v128, v128
    v_lshlrev_b32 v128, 16, v10
    v_rcp_f32 v11, v128
    v_cvt_pk_bf16_f32 v10, v192, v193
    v_lshlrev_b32 v192, 16, v10
    v_and_b32 v193, 0xffff0000, v10
    v_cvt_pk_bf16_f32 v10, v194, v195
    v_lshlrev_b32 v194, 16, v10
    v_and_b32 v195, 0xffff0000, v10
    v_mul_f32 v10, v192, v11
    v_fma_f32 v12, -v10, v128, v192
    v_fma_f32 v192, v12, v11, v10
    v_mul_f32 v10, v193, v11
    v_fma_f32 v12, -v10, v128, v193
    v_fma_f32 v193, v12, v11, v10
    v_mul_f32 v10, v194, v11
    v_fma_f32 v12, -v10, v128, v194
    v_fma_f32 v194, v12, v11, v10
    v_mul_f32 v10, v195, v11
    v_fma_f32 v12, -v10, v128, v195
    v_fma_f32 v195, v12, v11, v10
    v_cvt_pk_bf16_f32 v13, v132, v132
    v_lshlrev_b32 v132, 16, v13
    v_add_f32 v132, 0x358637bd, v132
    v_cvt_pk_bf16_f32 v13, v132, v132
    v_lshlrev_b32 v132, 16, v13
    v_rcp_f32 v14, v132
    v_cvt_pk_bf16_f32 v13, v196, v197
    v_lshlrev_b32 v196, 16, v13
    v_and_b32 v197, 0xffff0000, v13
    v_cvt_pk_bf16_f32 v13, v198, v199
    v_lshlrev_b32 v198, 16, v13
    v_and_b32 v199, 0xffff0000, v13
    v_mul_f32 v13, v196, v14
    v_fma_f32 v15, -v13, v132, v196
    v_fma_f32 v196, v15, v14, v13
    v_mul_f32 v13, v197, v14
    v_fma_f32 v15, -v13, v132, v197
    v_fma_f32 v197, v15, v14, v13
    v_mul_f32 v13, v198, v14
    v_fma_f32 v15, -v13, v132, v198
    v_fma_f32 v198, v15, v14, v13
    v_mul_f32 v13, v199, v14
    v_fma_f32 v15, -v13, v132, v199
    v_fma_f32 v199, v15, v14, v13
    v_cvt_pk_bf16_f32 v10, v136, v136
    v_lshlrev_b32 v136, 16, v10
    v_add_f32 v136, 0x358637bd, v136
    v_cvt_pk_bf16_f32 v10, v136, v136
    v_lshlrev_b32 v136, 16, v10
    v_rcp_f32 v11, v136
    v_cvt_pk_bf16_f32 v10, v200, v201
    v_lshlrev_b32 v200, 16, v10
    v_and_b32 v201, 0xffff0000, v10
    v_cvt_pk_bf16_f32 v10, v202, v203
    v_lshlrev_b32 v202, 16, v10
    v_and_b32 v203, 0xffff0000, v10
    v_mul_f32 v10, v200, v11
    v_fma_f32 v12, -v10, v136, v200
    v_fma_f32 v200, v12, v11, v10
    v_mul_f32 v10, v201, v11
    v_fma_f32 v12, -v10, v136, v201
    v_fma_f32 v201, v12, v11, v10
    v_mul_f32 v10, v202, v11
    v_fma_f32 v12, -v10, v136, v202
    v_fma_f32 v202, v12, v11, v10
    v_mul_f32 v10, v203, v11
    v_fma_f32 v12, -v10, v136, v203
    v_fma_f32 v203, v12, v11, v10
    v_cvt_pk_bf16_f32 v13, v140, v140
    v_lshlrev_b32 v140, 16, v13
    v_add_f32 v140, 0x358637bd, v140
    v_cvt_pk_bf16_f32 v13, v140, v140
    v_lshlrev_b32 v140, 16, v13
    v_rcp_f32 v14, v140
    v_cvt_pk_bf16_f32 v13, v204, v205
    v_lshlrev_b32 v204, 16, v13
    v_and_b32 v205, 0xffff0000, v13
    v_cvt_pk_bf16_f32 v13, v206, v207
    v_lshlrev_b32 v206, 16, v13
    v_and_b32 v207, 0xffff0000, v13
    v_mul_f32 v13, v204, v14
    v_fma_f32 v15, -v13, v140, v204
    v_fma_f32 v204, v15, v14, v13
    v_mul_f32 v13, v205, v14
    v_fma_f32 v15, -v13, v140, v205
    v_fma_f32 v205, v15, v14, v13
    v_mul_f32 v13, v206, v14
    v_fma_f32 v15, -v13, v140, v206
    v_fma_f32 v206, v15, v14, v13
    v_mul_f32 v13, v207, v14
    v_fma_f32 v15, -v13, v140, v207
    v_fma_f32 v207, v15, v14, v13
    v_cvt_pk_bf16_f32 v10, v144, v144
    v_lshlrev_b32 v144, 16, v10
    v_add_f32 v144, 0x358637bd, v144
    v_cvt_pk_bf16_f32 v10, v144, v144
    v_lshlrev_b32 v144, 16, v10
    v_rcp_f32 v11, v144
    v_cvt_pk_bf16_f32 v10, v208, v209
    v_lshlrev_b32 v208, 16, v10
    v_and_b32 v209, 0xffff0000, v10
    v_cvt_pk_bf16_f32 v10, v210, v211
    v_lshlrev_b32 v210, 16, v10
    v_and_b32 v211, 0xffff0000, v10
    v_mul_f32 v10, v208, v11
    v_fma_f32 v12, -v10, v144, v208
    v_fma_f32 v208, v12, v11, v10
    v_mul_f32 v10, v209, v11
    v_fma_f32 v12, -v10, v144, v209
    v_fma_f32 v209, v12, v11, v10
    v_mul_f32 v10, v210, v11
    v_fma_f32 v12, -v10, v144, v210
    v_fma_f32 v210, v12, v11, v10
    v_mul_f32 v10, v211, v11
    v_fma_f32 v12, -v10, v144, v211
    v_fma_f32 v211, v12, v11, v10
    v_cvt_pk_bf16_f32 v13, v148, v148
    v_lshlrev_b32 v148, 16, v13
    v_add_f32 v148, 0x358637bd, v148
    v_cvt_pk_bf16_f32 v13, v148, v148
    v_lshlrev_b32 v148, 16, v13
    v_rcp_f32 v14, v148
    v_cvt_pk_bf16_f32 v13, v212, v213
    v_lshlrev_b32 v212, 16, v13
    v_and_b32 v213, 0xffff0000, v13
    v_cvt_pk_bf16_f32 v13, v214, v215
    v_lshlrev_b32 v214, 16, v13
    v_and_b32 v215, 0xffff0000, v13
    v_mul_f32 v13, v212, v14
    v_fma_f32 v15, -v13, v148, v212
    v_fma_f32 v212, v15, v14, v13
    v_mul_f32 v13, v213, v14
    v_fma_f32 v15, -v13, v148, v213
    v_fma_f32 v213, v15, v14, v13
    v_mul_f32 v13, v214, v14
    v_fma_f32 v15, -v13, v148, v214
    v_fma_f32 v214, v15, v14, v13
    v_mul_f32 v13, v215, v14
    v_fma_f32 v15, -v13, v148, v215
    v_fma_f32 v215, v15, v14, v13
    v_cvt_pk_bf16_f32 v10, v152, v152
    v_lshlrev_b32 v152, 16, v10
    v_add_f32 v152, 0x358637bd, v152
    v_cvt_pk_bf16_f32 v10, v152, v152
    v_lshlrev_b32 v152, 16, v10
    v_rcp_f32 v11, v152
    v_cvt_pk_bf16_f32 v10, v216, v217
    v_lshlrev_b32 v216, 16, v10
    v_and_b32 v217, 0xffff0000, v10
    v_cvt_pk_bf16_f32 v10, v218, v219
    v_lshlrev_b32 v218, 16, v10
    v_and_b32 v219, 0xffff0000, v10
    v_mul_f32 v10, v216, v11
    v_fma_f32 v12, -v10, v152, v216
    v_fma_f32 v216, v12, v11, v10
    v_mul_f32 v10, v217, v11
    v_fma_f32 v12, -v10, v152, v217
    v_fma_f32 v217, v12, v11, v10
    v_mul_f32 v10, v218, v11
    v_fma_f32 v12, -v10, v152, v218
    v_fma_f32 v218, v12, v11, v10
    v_mul_f32 v10, v219, v11
    v_fma_f32 v12, -v10, v152, v219
    v_fma_f32 v219, v12, v11, v10
    v_cvt_pk_bf16_f32 v13, v156, v156
    v_lshlrev_b32 v156, 16, v13
    v_add_f32 v156, 0x358637bd, v156
    v_cvt_pk_bf16_f32 v13, v156, v156
    v_lshlrev_b32 v156, 16, v13
    v_rcp_f32 v14, v156
    v_cvt_pk_bf16_f32 v13, v220, v221
    v_lshlrev_b32 v220, 16, v13
    v_and_b32 v221, 0xffff0000, v13
    v_cvt_pk_bf16_f32 v13, v222, v223
    v_lshlrev_b32 v222, 16, v13
    v_and_b32 v223, 0xffff0000, v13
    v_mul_f32 v13, v220, v14
    v_fma_f32 v15, -v13, v156, v220
    v_fma_f32 v220, v15, v14, v13
    v_mul_f32 v13, v221, v14
    v_fma_f32 v15, -v13, v156, v221
    v_fma_f32 v221, v15, v14, v13
    v_mul_f32 v13, v222, v14
    v_fma_f32 v15, -v13, v156, v222
    v_fma_f32 v222, v15, v14, v13
    v_mul_f32 v13, v223, v14
    v_fma_f32 v15, -v13, v156, v223
    v_fma_f32 v223, v15, v14, v13
    s_lshl_b32 s44, s43, 12
    v_add_u32 v6, s44, v5
    v_cvt_pk_bf16_f32 v16, v192, v193
    v_cvt_pk_bf16_f32 v17, v194, v195
    v_cvt_pk_bf16_f32 v18, v196, v197
    v_cvt_pk_bf16_f32 v19, v198, v199
    ds_write_b128 v6, v[16:19] offset:0
    v_cvt_pk_bf16_f32 v20, v200, v201
    v_cvt_pk_bf16_f32 v21, v202, v203
    v_cvt_pk_bf16_f32 v22, v204, v205
    v_cvt_pk_bf16_f32 v23, v206, v207
    ds_write_b128 v6, v[20:23] offset:1024
    v_cvt_pk_bf16_f32 v24, v208, v209
    v_cvt_pk_bf16_f32 v25, v210, v211
    v_cvt_pk_bf16_f32 v26, v212, v213
    v_cvt_pk_bf16_f32 v27, v214, v215
    ds_write_b128 v6, v[24:27] offset:2048
    v_cvt_pk_bf16_f32 v28, v216, v217
    v_cvt_pk_bf16_f32 v29, v218, v219
    v_cvt_pk_bf16_f32 v30, v220, v221
    v_cvt_pk_bf16_f32 v31, v222, v223
    ds_write_b128 v6, v[28:31] offset:3072
    s_waitcnt lgkmcnt(0)
    s_barrier
    ds_read_b128 v[192:195], v5 offset:0
    ds_read_b128 v[196:199], v5 offset:1024
    ds_read_b128 v[200:203], v5 offset:2048
    ds_read_b128 v[204:207], v5 offset:3072
    ds_read_b128 v[208:211], v5 offset:4096
    ds_read_b128 v[212:215], v5 offset:5120
    ds_read_b128 v[216:219], v5 offset:6144
    ds_read_b128 v[220:223], v5 offset:7168
    ds_read_b128 v[224:227], v5 offset:8192
    ds_read_b128 v[228:231], v5 offset:9216
    ds_read_b128 v[232:235], v5 offset:10240
    ds_read_b128 v[236:239], v5 offset:11264
    ds_read_b128 v[240:243], v5 offset:12288
    ds_read_b128 v[244:247], v5 offset:13312
    ds_read_b128 v[248:251], v5 offset:14336
    ds_read_b128 v[252:255], v5 offset:15360
    v_mov_b32 v64, 0
    v_mov_b32 v65, 0
    v_mov_b32 v66, 0
    v_mov_b32 v67, 0
    v_mov_b32 v68, 0
    v_mov_b32 v69, 0
    v_mov_b32 v70, 0
    v_mov_b32 v71, 0
    v_mov_b32 v72, 0
    v_mov_b32 v73, 0
    v_mov_b32 v74, 0
    v_mov_b32 v75, 0
    v_mov_b32 v76, 0
    v_mov_b32 v77, 0
    v_mov_b32 v78, 0
    v_mov_b32 v79, 0
    v_mov_b32 v80, 0
    v_mov_b32 v81, 0
    v_mov_b32 v82, 0
    v_mov_b32 v83, 0
    v_mov_b32 v84, 0
    v_mov_b32 v85, 0
    v_mov_b32 v86, 0
    v_mov_b32 v87, 0
    v_mov_b32 v88, 0
    v_mov_b32 v89, 0
    v_mov_b32 v90, 0
    v_mov_b32 v91, 0
    v_mov_b32 v92, 0
    v_mov_b32 v93, 0
    v_mov_b32 v94, 0
    v_mov_b32 v95, 0
    s_mov_b32 s98, 8192
    buffer_load_dwordx4 v[160:163], v48, s[4:7], s98 offen
    buffer_load_dwordx4 v[164:167], v49, s[4:7], s98 offen
    buffer_load_dwordx4 v[168:171], v50, s[4:7], s98 offen
    buffer_load_dwordx4 v[172:175], v51, s[4:7], s98 offen
    buffer_load_dwordx4 v[176:179], v52, s[4:7], s98 offen
    buffer_load_dwordx4 v[180:183], v53, s[4:7], s98 offen
    buffer_load_dwordx4 v[184:187], v54, s[4:7], s98 offen
    buffer_load_dwordx4 v[188:191], v55, s[4:7], s98 offen
    s_mov_b32 s98, 9216
    buffer_load_dwordx4 v[96:99], v48, s[4:7], s98 offen
    buffer_load_dwordx4 v[100:103], v49, s[4:7], s98 offen
    buffer_load_dwordx4 v[104:107], v50, s[4:7], s98 offen
    buffer_load_dwordx4 v[108:111], v51, s[4:7], s98 offen
    buffer_load_dwordx4 v[112:115], v52, s[4:7], s98 offen
    buffer_load_dwordx4 v[116:119], v53, s[4:7], s98 offen
    buffer_load_dwordx4 v[120:123], v54, s[4:7], s98 offen
    buffer_load_dwordx4 v[124:127], v55, s[4:7], s98 offen
    s_mov_b32 s98, 10240
    buffer_load_dwordx4 v[128:131], v48, s[4:7], s98 offen
    buffer_load_dwordx4 v[132:135], v49, s[4:7], s98 offen
    buffer_load_dwordx4 v[136:139], v50, s[4:7], s98 offen
    buffer_load_dwordx4 v[140:143], v51, s[4:7], s98 offen
    buffer_load_dwordx4 v[144:147], v52, s[4:7], s98 offen
    buffer_load_dwordx4 v[148:151], v53, s[4:7], s98 offen
    buffer_load_dwordx4 v[152:155], v54, s[4:7], s98 offen
    buffer_load_dwordx4 v[156:159], v55, s[4:7], s98 offen
    s_waitcnt lgkmcnt(0)
    v_mfma_f32_16x16x32_bf16 v[64:67], a[0:3], v[192:195], v[64:67]
    v_mfma_f32_16x16x32_bf16 v[68:71], a[4:7], v[192:195], v[68:71]
    v_mfma_f32_16x16x32_bf16 v[72:75], a[8:11], v[192:195], v[72:75]
    v_mfma_f32_16x16x32_bf16 v[76:79], a[12:15], v[192:195], v[76:79]
    v_mfma_f32_16x16x32_bf16 v[80:83], a[16:19], v[192:195], v[80:83]
    v_mfma_f32_16x16x32_bf16 v[84:87], a[20:23], v[192:195], v[84:87]
    v_mfma_f32_16x16x32_bf16 v[88:91], a[24:27], v[192:195], v[88:91]
    v_mfma_f32_16x16x32_bf16 v[92:95], a[28:31], v[192:195], v[92:95]
    v_mfma_f32_16x16x32_bf16 v[64:67], a[32:35], v[196:199], v[64:67]
    v_mfma_f32_16x16x32_bf16 v[68:71], a[36:39], v[196:199], v[68:71]
    v_mfma_f32_16x16x32_bf16 v[72:75], a[40:43], v[196:199], v[72:75]
    v_mfma_f32_16x16x32_bf16 v[76:79], a[44:47], v[196:199], v[76:79]
    v_mfma_f32_16x16x32_bf16 v[80:83], a[48:51], v[196:199], v[80:83]
    v_mfma_f32_16x16x32_bf16 v[84:87], a[52:55], v[196:199], v[84:87]
    v_mfma_f32_16x16x32_bf16 v[88:91], a[56:59], v[196:199], v[88:91]
    v_mfma_f32_16x16x32_bf16 v[92:95], a[60:63], v[196:199], v[92:95]
    v_mfma_f32_16x16x32_bf16 v[64:67], a[64:67], v[200:203], v[64:67]
    v_mfma_f32_16x16x32_bf16 v[68:71], a[68:71], v[200:203], v[68:71]
    v_mfma_f32_16x16x32_bf16 v[72:75], a[72:75], v[200:203], v[72:75]
    v_mfma_f32_16x16x32_bf16 v[76:79], a[76:79], v[200:203], v[76:79]
    v_mfma_f32_16x16x32_bf16 v[80:83], a[80:83], v[200:203], v[80:83]
    v_mfma_f32_16x16x32_bf16 v[84:87], a[84:87], v[200:203], v[84:87]
    v_mfma_f32_16x16x32_bf16 v[88:91], a[88:91], v[200:203], v[88:91]
    v_mfma_f32_16x16x32_bf16 v[92:95], a[92:95], v[200:203], v[92:95]
    v_mfma_f32_16x16x32_bf16 v[64:67], a[96:99], v[204:207], v[64:67]
    v_mfma_f32_16x16x32_bf16 v[68:71], a[100:103], v[204:207], v[68:71]
    v_mfma_f32_16x16x32_bf16 v[72:75], a[104:107], v[204:207], v[72:75]
    v_mfma_f32_16x16x32_bf16 v[76:79], a[108:111], v[204:207], v[76:79]
    v_mfma_f32_16x16x32_bf16 v[80:83], a[112:115], v[204:207], v[80:83]
    v_mfma_f32_16x16x32_bf16 v[84:87], a[116:119], v[204:207], v[84:87]
    v_mfma_f32_16x16x32_bf16 v[88:91], a[120:123], v[204:207], v[88:91]
    v_mfma_f32_16x16x32_bf16 v[92:95], a[124:127], v[204:207], v[92:95]
    v_mfma_f32_16x16x32_bf16 v[64:67], a[128:131], v[208:211], v[64:67]
    v_mfma_f32_16x16x32_bf16 v[68:71], a[132:135], v[208:211], v[68:71]
    v_mfma_f32_16x16x32_bf16 v[72:75], a[136:139], v[208:211], v[72:75]
    v_mfma_f32_16x16x32_bf16 v[76:79], a[140:143], v[208:211], v[76:79]
    v_mfma_f32_16x16x32_bf16 v[80:83], a[144:147], v[208:211], v[80:83]
    v_mfma_f32_16x16x32_bf16 v[84:87], a[148:151], v[208:211], v[84:87]
    v_mfma_f32_16x16x32_bf16 v[88:91], a[152:155], v[208:211], v[88:91]
    v_mfma_f32_16x16x32_bf16 v[92:95], a[156:159], v[208:211], v[92:95]
    v_mfma_f32_16x16x32_bf16 v[64:67], a[160:163], v[212:215], v[64:67]
    v_mfma_f32_16x16x32_bf16 v[68:71], a[164:167], v[212:215], v[68:71]
    v_mfma_f32_16x16x32_bf16 v[72:75], a[168:171], v[212:215], v[72:75]
    v_mfma_f32_16x16x32_bf16 v[76:79], a[172:175], v[212:215], v[76:79]
    v_mfma_f32_16x16x32_bf16 v[80:83], a[176:179], v[212:215], v[80:83]
    v_mfma_f32_16x16x32_bf16 v[84:87], a[180:183], v[212:215], v[84:87]
    v_mfma_f32_16x16x32_bf16 v[88:91], a[184:187], v[212:215], v[88:91]
    v_mfma_f32_16x16x32_bf16 v[92:95], a[188:191], v[212:215], v[92:95]
    v_mfma_f32_16x16x32_bf16 v[64:67], a[192:195], v[216:219], v[64:67]
    v_mfma_f32_16x16x32_bf16 v[68:71], a[196:199], v[216:219], v[68:71]
    v_mfma_f32_16x16x32_bf16 v[72:75], a[200:203], v[216:219], v[72:75]
    v_mfma_f32_16x16x32_bf16 v[76:79], a[204:207], v[216:219], v[76:79]
    v_mfma_f32_16x16x32_bf16 v[80:83], a[208:211], v[216:219], v[80:83]
    v_mfma_f32_16x16x32_bf16 v[84:87], a[212:215], v[216:219], v[84:87]
    v_mfma_f32_16x16x32_bf16 v[88:91], a[216:219], v[216:219], v[88:91]
    v_mfma_f32_16x16x32_bf16 v[92:95], a[220:223], v[216:219], v[92:95]
    v_mfma_f32_16x16x32_bf16 v[64:67], a[224:227], v[220:223], v[64:67]
    v_mfma_f32_16x16x32_bf16 v[68:71], a[228:231], v[220:223], v[68:71]
    v_mfma_f32_16x16x32_bf16 v[72:75], a[232:235], v[220:223], v[72:75]
    v_mfma_f32_16x16x32_bf16 v[76:79], a[236:239], v[220:223], v[76:79]
    v_mfma_f32_16x16x32_bf16 v[80:83], a[240:243], v[220:223], v[80:83]
    v_mfma_f32_16x16x32_bf16 v[84:87], a[244:247], v[220:223], v[84:87]
    v_mfma_f32_16x16x32_bf16 v[88:91], a[248:251], v[220:223], v[88:91]
    v_mfma_f32_16x16x32_bf16 v[92:95], a[252:255], v[220:223], v[92:95]
    s_waitcnt vmcnt(16)
    v_mfma_f32_16x16x32_bf16 v[64:67], v[160:163], v[224:227], v[64:67]
    v_mfma_f32_16x16x32_bf16 v[68:71], v[164:167], v[224:227], v[68:71]
    v_mfma_f32_16x16x32_bf16 v[72:75], v[168:171], v[224:227], v[72:75]
    v_mfma_f32_16x16x32_bf16 v[76:79], v[172:175], v[224:227], v[76:79]
    v_mfma_f32_16x16x32_bf16 v[80:83], v[176:179], v[224:227], v[80:83]
    v_mfma_f32_16x16x32_bf16 v[84:87], v[180:183], v[224:227], v[84:87]
    v_mfma_f32_16x16x32_bf16 v[88:91], v[184:187], v[224:227], v[88:91]
    v_mfma_f32_16x16x32_bf16 v[92:95], v[188:191], v[224:227], v[92:95]
    s_mov_b32 s98, 11264
    buffer_load_dwordx4 v[160:163], v48, s[4:7], s98 offen
    buffer_load_dwordx4 v[164:167], v49, s[4:7], s98 offen
    buffer_load_dwordx4 v[168:171], v50, s[4:7], s98 offen
    buffer_load_dwordx4 v[172:175], v51, s[4:7], s98 offen
    buffer_load_dwordx4 v[176:179], v52, s[4:7], s98 offen
    buffer_load_dwordx4 v[180:183], v53, s[4:7], s98 offen
    buffer_load_dwordx4 v[184:187], v54, s[4:7], s98 offen
    buffer_load_dwordx4 v[188:191], v55, s[4:7], s98 offen
    s_waitcnt vmcnt(16)
    v_mfma_f32_16x16x32_bf16 v[64:67], v[96:99], v[228:231], v[64:67]
    v_mfma_f32_16x16x32_bf16 v[68:71], v[100:103], v[228:231], v[68:71]
    v_mfma_f32_16x16x32_bf16 v[72:75], v[104:107], v[228:231], v[72:75]
    v_mfma_f32_16x16x32_bf16 v[76:79], v[108:111], v[228:231], v[76:79]
    v_mfma_f32_16x16x32_bf16 v[80:83], v[112:115], v[228:231], v[80:83]
    v_mfma_f32_16x16x32_bf16 v[84:87], v[116:119], v[228:231], v[84:87]
    v_mfma_f32_16x16x32_bf16 v[88:91], v[120:123], v[228:231], v[88:91]
    v_mfma_f32_16x16x32_bf16 v[92:95], v[124:127], v[228:231], v[92:95]
    s_mov_b32 s98, 12288
    buffer_load_dwordx4 v[96:99], v48, s[4:7], s98 offen
    buffer_load_dwordx4 v[100:103], v49, s[4:7], s98 offen
    buffer_load_dwordx4 v[104:107], v50, s[4:7], s98 offen
    buffer_load_dwordx4 v[108:111], v51, s[4:7], s98 offen
    buffer_load_dwordx4 v[112:115], v52, s[4:7], s98 offen
    buffer_load_dwordx4 v[116:119], v53, s[4:7], s98 offen
    buffer_load_dwordx4 v[120:123], v54, s[4:7], s98 offen
    buffer_load_dwordx4 v[124:127], v55, s[4:7], s98 offen
    s_waitcnt vmcnt(16)
    v_mfma_f32_16x16x32_bf16 v[64:67], v[128:131], v[232:235], v[64:67]
    v_mfma_f32_16x16x32_bf16 v[68:71], v[132:135], v[232:235], v[68:71]
    v_mfma_f32_16x16x32_bf16 v[72:75], v[136:139], v[232:235], v[72:75]
    v_mfma_f32_16x16x32_bf16 v[76:79], v[140:143], v[232:235], v[76:79]
    v_mfma_f32_16x16x32_bf16 v[80:83], v[144:147], v[232:235], v[80:83]
    v_mfma_f32_16x16x32_bf16 v[84:87], v[148:151], v[232:235], v[84:87]
    v_mfma_f32_16x16x32_bf16 v[88:91], v[152:155], v[232:235], v[88:91]
    v_mfma_f32_16x16x32_bf16 v[92:95], v[156:159], v[232:235], v[92:95]
    s_mov_b32 s98, 13312
    buffer_load_dwordx4 v[128:131], v48, s[4:7], s98 offen
    buffer_load_dwordx4 v[132:135], v49, s[4:7], s98 offen
    buffer_load_dwordx4 v[136:139], v50, s[4:7], s98 offen
    buffer_load_dwordx4 v[140:143], v51, s[4:7], s98 offen
    buffer_load_dwordx4 v[144:147], v52, s[4:7], s98 offen
    buffer_load_dwordx4 v[148:151], v53, s[4:7], s98 offen
    buffer_load_dwordx4 v[152:155], v54, s[4:7], s98 offen
    buffer_load_dwordx4 v[156:159], v55, s[4:7], s98 offen
    s_waitcnt vmcnt(16)
    v_mfma_f32_16x16x32_bf16 v[64:67], v[160:163], v[236:239], v[64:67]
    v_mfma_f32_16x16x32_bf16 v[68:71], v[164:167], v[236:239], v[68:71]
    v_mfma_f32_16x16x32_bf16 v[72:75], v[168:171], v[236:239], v[72:75]
    v_mfma_f32_16x16x32_bf16 v[76:79], v[172:175], v[236:239], v[76:79]
    v_mfma_f32_16x16x32_bf16 v[80:83], v[176:179], v[236:239], v[80:83]
    v_mfma_f32_16x16x32_bf16 v[84:87], v[180:183], v[236:239], v[84:87]
    v_mfma_f32_16x16x32_bf16 v[88:91], v[184:187], v[236:239], v[88:91]
    v_mfma_f32_16x16x32_bf16 v[92:95], v[188:191], v[236:239], v[92:95]
    s_mov_b32 s98, 14336
    buffer_load_dwordx4 v[160:163], v48, s[4:7], s98 offen
    buffer_load_dwordx4 v[164:167], v49, s[4:7], s98 offen
    buffer_load_dwordx4 v[168:171], v50, s[4:7], s98 offen
    buffer_load_dwordx4 v[172:175], v51, s[4:7], s98 offen
    buffer_load_dwordx4 v[176:179], v52, s[4:7], s98 offen
    buffer_load_dwordx4 v[180:183], v53, s[4:7], s98 offen
    buffer_load_dwordx4 v[184:187], v54, s[4:7], s98 offen
    buffer_load_dwordx4 v[188:191], v55, s[4:7], s98 offen
    s_waitcnt vmcnt(16)
    v_mfma_f32_16x16x32_bf16 v[64:67], v[96:99], v[240:243], v[64:67]
    v_mfma_f32_16x16x32_bf16 v[68:71], v[100:103], v[240:243], v[68:71]
    v_mfma_f32_16x16x32_bf16 v[72:75], v[104:107], v[240:243], v[72:75]
    v_mfma_f32_16x16x32_bf16 v[76:79], v[108:111], v[240:243], v[76:79]
    v_mfma_f32_16x16x32_bf16 v[80:83], v[112:115], v[240:243], v[80:83]
    v_mfma_f32_16x16x32_bf16 v[84:87], v[116:119], v[240:243], v[84:87]
    v_mfma_f32_16x16x32_bf16 v[88:91], v[120:123], v[240:243], v[88:91]
    v_mfma_f32_16x16x32_bf16 v[92:95], v[124:127], v[240:243], v[92:95]
    s_mov_b32 s98, 15360
    buffer_load_dwordx4 v[96:99], v48, s[4:7], s98 offen
    buffer_load_dwordx4 v[100:103], v49, s[4:7], s98 offen
    buffer_load_dwordx4 v[104:107], v50, s[4:7], s98 offen
    buffer_load_dwordx4 v[108:111], v51, s[4:7], s98 offen
    buffer_load_dwordx4 v[112:115], v52, s[4:7], s98 offen
    buffer_load_dwordx4 v[116:119], v53, s[4:7], s98 offen
    buffer_load_dwordx4 v[120:123], v54, s[4:7], s98 offen
    buffer_load_dwordx4 v[124:127], v55, s[4:7], s98 offen
    s_waitcnt vmcnt(16)
    v_mfma_f32_16x16x32_bf16 v[64:67], v[128:131], v[244:247], v[64:67]
    v_mfma_f32_16x16x32_bf16 v[68:71], v[132:135], v[244:247], v[68:71]
    v_mfma_f32_16x16x32_bf16 v[72:75], v[136:139], v[244:247], v[72:75]
    v_mfma_f32_16x16x32_bf16 v[76:79], v[140:143], v[244:247], v[76:79]
    v_mfma_f32_16x16x32_bf16 v[80:83], v[144:147], v[244:247], v[80:83]
    v_mfma_f32_16x16x32_bf16 v[84:87], v[148:151], v[244:247], v[84:87]
    v_mfma_f32_16x16x32_bf16 v[88:91], v[152:155], v[244:247], v[88:91]
    v_mfma_f32_16x16x32_bf16 v[92:95], v[156:159], v[244:247], v[92:95]
    s_waitcnt vmcnt(8)
    v_mfma_f32_16x16x32_bf16 v[64:67], v[160:163], v[248:251], v[64:67]
    v_mfma_f32_16x16x32_bf16 v[68:71], v[164:167], v[248:251], v[68:71]
    v_mfma_f32_16x16x32_bf16 v[72:75], v[168:171], v[248:251], v[72:75]
    v_mfma_f32_16x16x32_bf16 v[76:79], v[172:175], v[248:251], v[76:79]
    v_mfma_f32_16x16x32_bf16 v[80:83], v[176:179], v[248:251], v[80:83]
    v_mfma_f32_16x16x32_bf16 v[84:87], v[180:183], v[248:251], v[84:87]
    v_mfma_f32_16x16x32_bf16 v[88:91], v[184:187], v[248:251], v[88:91]
    v_mfma_f32_16x16x32_bf16 v[92:95], v[188:191], v[248:251], v[92:95]
    s_waitcnt vmcnt(0)
    v_mfma_f32_16x16x32_bf16 v[64:67], v[96:99], v[252:255], v[64:67]
    v_mfma_f32_16x16x32_bf16 v[68:71], v[100:103], v[252:255], v[68:71]
    v_mfma_f32_16x16x32_bf16 v[72:75], v[104:107], v[252:255], v[72:75]
    v_mfma_f32_16x16x32_bf16 v[76:79], v[108:111], v[252:255], v[76:79]
    v_mfma_f32_16x16x32_bf16 v[80:83], v[112:115], v[252:255], v[80:83]
    v_mfma_f32_16x16x32_bf16 v[84:87], v[116:119], v[252:255], v[84:87]
    v_mfma_f32_16x16x32_bf16 v[88:91], v[120:123], v[252:255], v[88:91]
    v_mfma_f32_16x16x32_bf16 v[92:95], v[124:127], v[252:255], v[92:95]
    s_cmp_lg_u32 s89, 0
    s_cbranch_scc1 b2_18_last
    s_add_u32 s62, s48, 25165824
    v_cvt_pk_bf16_f32 v10, v64, v65
    v_lshlrev_b32 v64, 16, v10
    v_and_b32 v65, 0xffff0000, v10
    v_cvt_pk_bf16_f32 v10, v66, v67
    v_lshlrev_b32 v66, 16, v10
    v_and_b32 v67, 0xffff0000, v10
    v_lshlrev_b32 v10, 16, v32
    v_add_f32 v64, v64, v10
    v_and_b32 v10, 0xffff0000, v32
    v_add_f32 v65, v65, v10
    v_lshlrev_b32 v10, 16, v33
    v_add_f32 v66, v66, v10
    v_and_b32 v10, 0xffff0000, v33
    v_add_f32 v67, v67, v10
    v_cvt_pk_bf16_f32 v32, v64, v65
    v_cvt_pk_bf16_f32 v33, v66, v67
    buffer_store_dwordx2 v[32:33], v9, s[4:7], s62 offen offset:0 sc1
    v_cvt_pk_bf16_f32 v10, v68, v69
    v_lshlrev_b32 v68, 16, v10
    v_and_b32 v69, 0xffff0000, v10
    v_cvt_pk_bf16_f32 v10, v70, v71
    v_lshlrev_b32 v70, 16, v10
    v_and_b32 v71, 0xffff0000, v10
    v_lshlrev_b32 v10, 16, v34
    v_add_f32 v68, v68, v10
    v_and_b32 v10, 0xffff0000, v34
    v_add_f32 v69, v69, v10
    v_lshlrev_b32 v10, 16, v35
    v_add_f32 v70, v70, v10
    v_and_b32 v10, 0xffff0000, v35
    v_add_f32 v71, v71, v10
    v_cvt_pk_bf16_f32 v34, v68, v69
    v_cvt_pk_bf16_f32 v35, v70, v71
    buffer_store_dwordx2 v[34:35], v9, s[4:7], s62 offen offset:32 sc1
    v_cvt_pk_bf16_f32 v10, v72, v73
    v_lshlrev_b32 v72, 16, v10
    v_and_b32 v73, 0xffff0000, v10
    v_cvt_pk_bf16_f32 v10, v74, v75
    v_lshlrev_b32 v74, 16, v10
    v_and_b32 v75, 0xffff0000, v10
    v_lshlrev_b32 v10, 16, v36
    v_add_f32 v72, v72, v10
    v_and_b32 v10, 0xffff0000, v36
    v_add_f32 v73, v73, v10
    v_lshlrev_b32 v10, 16, v37
    v_add_f32 v74, v74, v10
    v_and_b32 v10, 0xffff0000, v37
    v_add_f32 v75, v75, v10
    v_cvt_pk_bf16_f32 v36, v72, v73
    v_cvt_pk_bf16_f32 v37, v74, v75
    buffer_store_dwordx2 v[36:37], v9, s[4:7], s62 offen offset:64 sc1
    v_cvt_pk_bf16_f32 v10, v76, v77
    v_lshlrev_b32 v76, 16, v10
    v_and_b32 v77, 0xffff0000, v10
    v_cvt_pk_bf16_f32 v10, v78, v79
    v_lshlrev_b32 v78, 16, v10
    v_and_b32 v79, 0xffff0000, v10
    v_lshlrev_b32 v10, 16, v38
    v_add_f32 v76, v76, v10
    v_and_b32 v10, 0xffff0000, v38
    v_add_f32 v77, v77, v10
    v_lshlrev_b32 v10, 16, v39
    v_add_f32 v78, v78, v10
    v_and_b32 v10, 0xffff0000, v39
    v_add_f32 v79, v79, v10
    v_cvt_pk_bf16_f32 v38, v76, v77
    v_cvt_pk_bf16_f32 v39, v78, v79
    buffer_store_dwordx2 v[38:39], v9, s[4:7], s62 offen offset:96 sc1
    v_cvt_pk_bf16_f32 v10, v80, v81
    v_lshlrev_b32 v80, 16, v10
    v_and_b32 v81, 0xffff0000, v10
    v_cvt_pk_bf16_f32 v10, v82, v83
    v_lshlrev_b32 v82, 16, v10
    v_and_b32 v83, 0xffff0000, v10
    v_lshlrev_b32 v10, 16, v40
    v_add_f32 v80, v80, v10
    v_and_b32 v10, 0xffff0000, v40
    v_add_f32 v81, v81, v10
    v_lshlrev_b32 v10, 16, v41
    v_add_f32 v82, v82, v10
    v_and_b32 v10, 0xffff0000, v41
    v_add_f32 v83, v83, v10
    v_cvt_pk_bf16_f32 v40, v80, v81
    v_cvt_pk_bf16_f32 v41, v82, v83
    buffer_store_dwordx2 v[40:41], v9, s[4:7], s62 offen offset:128 sc1
    v_cvt_pk_bf16_f32 v10, v84, v85
    v_lshlrev_b32 v84, 16, v10
    v_and_b32 v85, 0xffff0000, v10
    v_cvt_pk_bf16_f32 v10, v86, v87
    v_lshlrev_b32 v86, 16, v10
    v_and_b32 v87, 0xffff0000, v10
    v_lshlrev_b32 v10, 16, v42
    v_add_f32 v84, v84, v10
    v_and_b32 v10, 0xffff0000, v42
    v_add_f32 v85, v85, v10
    v_lshlrev_b32 v10, 16, v43
    v_add_f32 v86, v86, v10
    v_and_b32 v10, 0xffff0000, v43
    v_add_f32 v87, v87, v10
    v_cvt_pk_bf16_f32 v42, v84, v85
    v_cvt_pk_bf16_f32 v43, v86, v87
    buffer_store_dwordx2 v[42:43], v9, s[4:7], s62 offen offset:160 sc1
    v_cvt_pk_bf16_f32 v10, v88, v89
    v_lshlrev_b32 v88, 16, v10
    v_and_b32 v89, 0xffff0000, v10
    v_cvt_pk_bf16_f32 v10, v90, v91
    v_lshlrev_b32 v90, 16, v10
    v_and_b32 v91, 0xffff0000, v10
    v_lshlrev_b32 v10, 16, v44
    v_add_f32 v88, v88, v10
    v_and_b32 v10, 0xffff0000, v44
    v_add_f32 v89, v89, v10
    v_lshlrev_b32 v10, 16, v45
    v_add_f32 v90, v90, v10
    v_and_b32 v10, 0xffff0000, v45
    v_add_f32 v91, v91, v10
    v_cvt_pk_bf16_f32 v44, v88, v89
    v_cvt_pk_bf16_f32 v45, v90, v91
    buffer_store_dwordx2 v[44:45], v9, s[4:7], s62 offen offset:192 sc1
    v_cvt_pk_bf16_f32 v10, v92, v93
    v_lshlrev_b32 v92, 16, v10
    v_and_b32 v93, 0xffff0000, v10
    v_cvt_pk_bf16_f32 v10, v94, v95
    v_lshlrev_b32 v94, 16, v10
    v_and_b32 v95, 0xffff0000, v10
    v_lshlrev_b32 v10, 16, v46
    v_add_f32 v92, v92, v10
    v_and_b32 v10, 0xffff0000, v46
    v_add_f32 v93, v93, v10
    v_lshlrev_b32 v10, 16, v47
    v_add_f32 v94, v94, v10
    v_and_b32 v10, 0xffff0000, v47
    v_add_f32 v95, v95, v10
    v_cvt_pk_bf16_f32 v46, v92, v93
    v_cvt_pk_bf16_f32 v47, v94, v95
    buffer_store_dwordx2 v[46:47], v9, s[4:7], s62 offen offset:224 sc1
    v_lshlrev_b32 v64, 16, v32
    v_and_b32 v65, 0xffff0000, v32
    v_lshlrev_b32 v66, 16, v33
    v_and_b32 v67, 0xffff0000, v33
    v_lshlrev_b32 v68, 16, v34
    v_and_b32 v69, 0xffff0000, v34
    v_lshlrev_b32 v70, 16, v35
    v_and_b32 v71, 0xffff0000, v35
    v_lshlrev_b32 v72, 16, v36
    v_and_b32 v73, 0xffff0000, v36
    v_lshlrev_b32 v74, 16, v37
    v_and_b32 v75, 0xffff0000, v37
    v_lshlrev_b32 v76, 16, v38
    v_and_b32 v77, 0xffff0000, v38
    v_lshlrev_b32 v78, 16, v39
    v_and_b32 v79, 0xffff0000, v39
    v_lshlrev_b32 v80, 16, v40
    v_and_b32 v81, 0xffff0000, v40
    v_lshlrev_b32 v82, 16, v41
    v_and_b32 v83, 0xffff0000, v41
    v_lshlrev_b32 v84, 16, v42
    v_and_b32 v85, 0xffff0000, v42
    v_lshlrev_b32 v86, 16, v43
    v_and_b32 v87, 0xffff0000, v43
    v_lshlrev_b32 v88, 16, v44
    v_and_b32 v89, 0xffff0000, v44
    v_lshlrev_b32 v90, 16, v45
    v_and_b32 v91, 0xffff0000, v45
    v_lshlrev_b32 v92, 16, v46
    v_and_b32 v93, 0xffff0000, v46
    v_lshlrev_b32 v94, 16, v47
    v_and_b32 v95, 0xffff0000, v47
    v_add_f32 v10, v64, v65
    v_add_f32 v10, v10, v66
    v_add_f32 v10, v10, v67
    v_add_f32 v10, v10, v68
    v_add_f32 v10, v10, v69
    v_add_f32 v10, v10, v70
    v_add_f32 v10, v10, v71
    v_add_f32 v10, v10, v72
    v_add_f32 v10, v10, v73
    v_add_f32 v10, v10, v74
    v_add_f32 v10, v10, v75
    v_add_f32 v10, v10, v76
    v_add_f32 v10, v10, v77
    v_add_f32 v10, v10, v78
    v_add_f32 v10, v10, v79
    v_add_f32 v10, v10, v80
    v_add_f32 v10, v10, v81
    v_add_f32 v10, v10, v82
    v_add_f32 v10, v10, v83
    v_add_f32 v10, v10, v84
    v_add_f32 v10, v10, v85
    v_add_f32 v10, v10, v86
    v_add_f32 v10, v10, v87
    v_add_f32 v10, v10, v88
    v_add_f32 v10, v10, v89
    v_add_f32 v10, v10, v90
    v_add_f32 v10, v10, v91
    v_add_f32 v10, v10, v92
    v_add_f32 v10, v10, v93
    v_add_f32 v10, v10, v94
    v_add_f32 v10, v10, v95
    v_mov_b32 v11, v10
    s_nop 1
    v_permlane16_swap_b32 v10, v11
    v_add_f32 v10, v10, v11
    v_mov_b32 v11, v10
    s_nop 1
    v_permlane32_swap_b32 v10, v11
    v_add_f32 v10, v10, v11
    s_lshl_b32 s44, s43, 8
    v_lshlrev_b32 v12, 2, v1
    v_add_u32 v13, s44, v12
    ds_write_b32 v13, v10 offset:16384
    s_waitcnt lgkmcnt(0)
    s_barrier
    ds_read_b32 v100, v12 offset:16384
    ds_read_b32 v101, v12 offset:16640
    ds_read_b32 v102, v12 offset:16896
    ds_read_b32 v103, v12 offset:17152
    s_waitcnt lgkmcnt(0)
    v_add_f32 v100, v100, v101
    v_add_f32 v102, v102, v103
    v_add_f32 v10, v100, v102
    v_mul_f32 v10, 0x3b000000, v10
    v_mov_b32 v14, 0
    v_sub_f32 v15, v64, v10
    v_fmac_f32 v14, v15, v15
    v_sub_f32 v15, v65, v10
    v_fmac_f32 v14, v15, v15
    v_sub_f32 v15, v66, v10
    v_fmac_f32 v14, v15, v15
    v_sub_f32 v15, v67, v10
    v_fmac_f32 v14, v15, v15
    v_sub_f32 v15, v68, v10
    v_fmac_f32 v14, v15, v15
    v_sub_f32 v15, v69, v10
    v_fmac_f32 v14, v15, v15
    v_sub_f32 v15, v70, v10
    v_fmac_f32 v14, v15, v15
    v_sub_f32 v15, v71, v10
    v_fmac_f32 v14, v15, v15
    v_sub_f32 v15, v72, v10
    v_fmac_f32 v14, v15, v15
    v_sub_f32 v15, v73, v10
    v_fmac_f32 v14, v15, v15
    v_sub_f32 v15, v74, v10
    v_fmac_f32 v14, v15, v15
    v_sub_f32 v15, v75, v10
    v_fmac_f32 v14, v15, v15
    v_sub_f32 v15, v76, v10
    v_fmac_f32 v14, v15, v15
    v_sub_f32 v15, v77, v10
    v_fmac_f32 v14, v15, v15
    v_sub_f32 v15, v78, v10
    v_fmac_f32 v14, v15, v15
    v_sub_f32 v15, v79, v10
    v_fmac_f32 v14, v15, v15
    v_sub_f32 v15, v80, v10
    v_fmac_f32 v14, v15, v15
    v_sub_f32 v15, v81, v10
    v_fmac_f32 v14, v15, v15
    v_sub_f32 v15, v82, v10
    v_fmac_f32 v14, v15, v15
    v_sub_f32 v15, v83, v10
    v_fmac_f32 v14, v15, v15
    v_sub_f32 v15, v84, v10
    v_fmac_f32 v14, v15, v15
    v_sub_f32 v15, v85, v10
    v_fmac_f32 v14, v15, v15
    v_sub_f32 v15, v86, v10
    v_fmac_f32 v14, v15, v15
    v_sub_f32 v15, v87, v10
    v_fmac_f32 v14, v15, v15
    v_sub_f32 v15, v88, v10
    v_fmac_f32 v14, v15, v15
    v_sub_f32 v15, v89, v10
    v_fmac_f32 v14, v15, v15
    v_sub_f32 v15, v90, v10
    v_fmac_f32 v14, v15, v15
    v_sub_f32 v15, v91, v10
    v_fmac_f32 v14, v15, v15
    v_sub_f32 v15, v92, v10
    v_fmac_f32 v14, v15, v15
    v_sub_f32 v15, v93, v10
    v_fmac_f32 v14, v15, v15
    v_sub_f32 v15, v94, v10
    v_fmac_f32 v14, v15, v15
    v_sub_f32 v15, v95, v10
    v_fmac_f32 v14, v15, v15
    v_mov_b32 v11, v14
    s_nop 1
    v_permlane16_swap_b32 v14, v11
    v_add_f32 v14, v14, v11
    v_mov_b32 v11, v14
    s_nop 1
    v_permlane32_swap_b32 v14, v11
    v_add_f32 v14, v14, v11
    s_lshl_b32 s44, s43, 8
    v_lshlrev_b32 v12, 2, v1
    v_add_u32 v13, s44, v12
    ds_write_b32 v13, v14 offset:17408
    s_waitcnt lgkmcnt(0)
    s_barrier
    ds_read_b32 v100, v12 offset:17408
    ds_read_b32 v101, v12 offset:17664
    ds_read_b32 v102, v12 offset:17920
    ds_read_b32 v103, v12 offset:18176
    s_waitcnt lgkmcnt(0)
    v_add_f32 v100, v100, v101
    v_add_f32 v102, v102, v103
    v_add_f32 v14, v100, v102
    v_mul_f32 v14, 0x3b000000, v14
    v_cvt_pk_bf16_f32 v15, v14, v14
    v_lshlrev_b32 v14, 16, v15
    v_add_f32 v14, 0x3727c5ac, v14
    v_cvt_pk_bf16_f32 v15, v14, v14
    v_lshlrev_b32 v14, 16, v15
    v_sqrt_f32 v14, v14
    s_nop 0
    v_cvt_pk_bf16_f32 v15, v14, v14
    v_lshlrev_b32 v14, 16, v15
    v_cvt_pk_bf16_f32 v15, v10, v10
    v_lshlrev_b32 v10, 16, v15
    v_rcp_f32 v16, v14
    v_lshrrev_b32 v17, 1, v4
    v_lshlrev_b32 v17, 8, v17
    v_lshl_add_u32 v17, v3, 4, v17
    v_and_b32 v18, 1, v4
    v_lshl_add_u32 v17, v18, 3, v17
    s_lshl_b32 s46, s41, 14
    s_lshl_b32 s47, s43, 12
    s_add_u32 s46, s46, s47
    s_add_u32 s46, s46, 119537664
    v_sub_f32 v64, v64, v10
    v_sub_f32 v65, v65, v10
    v_cvt_pk_bf16_f32 v15, v64, v65
    v_lshlrev_b32 v64, 16, v15
    v_and_b32 v65, 0xffff0000, v15
    v_mul_f32 v19, v64, v16
    v_fma_f32 v20, -v19, v14, v64
    v_fma_f32 v64, v20, v16, v19
    v_mul_f32 v19, v65, v16
    v_fma_f32 v20, -v19, v14, v65
    v_fma_f32 v65, v20, v16, v19
    v_cvt_pk_bf16_f32 v104, v64, v65
    v_sub_f32 v66, v66, v10
    v_sub_f32 v67, v67, v10
    v_cvt_pk_bf16_f32 v15, v66, v67
    v_lshlrev_b32 v66, 16, v15
    v_and_b32 v67, 0xffff0000, v15
    v_mul_f32 v19, v66, v16
    v_fma_f32 v20, -v19, v14, v66
    v_fma_f32 v66, v20, v16, v19
    v_mul_f32 v19, v67, v16
    v_fma_f32 v20, -v19, v14, v67
    v_fma_f32 v67, v20, v16, v19
    v_cvt_pk_bf16_f32 v105, v66, v67
    buffer_store_dwordx2 v[104:105], v17, s[4:7], s46 offen offset:0 sc1
    v_sub_f32 v68, v68, v10
    v_sub_f32 v69, v69, v10
    v_cvt_pk_bf16_f32 v15, v68, v69
    v_lshlrev_b32 v68, 16, v15
    v_and_b32 v69, 0xffff0000, v15
    v_mul_f32 v19, v68, v16
    v_fma_f32 v20, -v19, v14, v68
    v_fma_f32 v68, v20, v16, v19
    v_mul_f32 v19, v69, v16
    v_fma_f32 v20, -v19, v14, v69
    v_fma_f32 v69, v20, v16, v19
    v_cvt_pk_bf16_f32 v106, v68, v69
    v_sub_f32 v70, v70, v10
    v_sub_f32 v71, v71, v10
    v_cvt_pk_bf16_f32 v15, v70, v71
    v_lshlrev_b32 v70, 16, v15
    v_and_b32 v71, 0xffff0000, v15
    v_mul_f32 v19, v70, v16
    v_fma_f32 v20, -v19, v14, v70
    v_fma_f32 v70, v20, v16, v19
    v_mul_f32 v19, v71, v16
    v_fma_f32 v20, -v19, v14, v71
    v_fma_f32 v71, v20, v16, v19
    v_cvt_pk_bf16_f32 v107, v70, v71
    buffer_store_dwordx2 v[106:107], v17, s[4:7], s46 offen offset:512 sc1
    v_sub_f32 v72, v72, v10
    v_sub_f32 v73, v73, v10
    v_cvt_pk_bf16_f32 v15, v72, v73
    v_lshlrev_b32 v72, 16, v15
    v_and_b32 v73, 0xffff0000, v15
    v_mul_f32 v19, v72, v16
    v_fma_f32 v20, -v19, v14, v72
    v_fma_f32 v72, v20, v16, v19
    v_mul_f32 v19, v73, v16
    v_fma_f32 v20, -v19, v14, v73
    v_fma_f32 v73, v20, v16, v19
    v_cvt_pk_bf16_f32 v108, v72, v73
    v_sub_f32 v74, v74, v10
    v_sub_f32 v75, v75, v10
    v_cvt_pk_bf16_f32 v15, v74, v75
    v_lshlrev_b32 v74, 16, v15
    v_and_b32 v75, 0xffff0000, v15
    v_mul_f32 v19, v74, v16
    v_fma_f32 v20, -v19, v14, v74
    v_fma_f32 v74, v20, v16, v19
    v_mul_f32 v19, v75, v16
    v_fma_f32 v20, -v19, v14, v75
    v_fma_f32 v75, v20, v16, v19
    v_cvt_pk_bf16_f32 v109, v74, v75
    buffer_store_dwordx2 v[108:109], v17, s[4:7], s46 offen offset:1024 sc1
    v_sub_f32 v76, v76, v10
    v_sub_f32 v77, v77, v10
    v_cvt_pk_bf16_f32 v15, v76, v77
    v_lshlrev_b32 v76, 16, v15
    v_and_b32 v77, 0xffff0000, v15
    v_mul_f32 v19, v76, v16
    v_fma_f32 v20, -v19, v14, v76
    v_fma_f32 v76, v20, v16, v19
    v_mul_f32 v19, v77, v16
    v_fma_f32 v20, -v19, v14, v77
    v_fma_f32 v77, v20, v16, v19
    v_cvt_pk_bf16_f32 v110, v76, v77
    v_sub_f32 v78, v78, v10
    v_sub_f32 v79, v79, v10
    v_cvt_pk_bf16_f32 v15, v78, v79
    v_lshlrev_b32 v78, 16, v15
    v_and_b32 v79, 0xffff0000, v15
    v_mul_f32 v19, v78, v16
    v_fma_f32 v20, -v19, v14, v78
    v_fma_f32 v78, v20, v16, v19
    v_mul_f32 v19, v79, v16
    v_fma_f32 v20, -v19, v14, v79
    v_fma_f32 v79, v20, v16, v19
    v_cvt_pk_bf16_f32 v111, v78, v79
    buffer_store_dwordx2 v[110:111], v17, s[4:7], s46 offen offset:1536 sc1
    v_sub_f32 v80, v80, v10
    v_sub_f32 v81, v81, v10
    v_cvt_pk_bf16_f32 v15, v80, v81
    v_lshlrev_b32 v80, 16, v15
    v_and_b32 v81, 0xffff0000, v15
    v_mul_f32 v19, v80, v16
    v_fma_f32 v20, -v19, v14, v80
    v_fma_f32 v80, v20, v16, v19
    v_mul_f32 v19, v81, v16
    v_fma_f32 v20, -v19, v14, v81
    v_fma_f32 v81, v20, v16, v19
    v_cvt_pk_bf16_f32 v112, v80, v81
    v_sub_f32 v82, v82, v10
    v_sub_f32 v83, v83, v10
    v_cvt_pk_bf16_f32 v15, v82, v83
    v_lshlrev_b32 v82, 16, v15
    v_and_b32 v83, 0xffff0000, v15
    v_mul_f32 v19, v82, v16
    v_fma_f32 v20, -v19, v14, v82
    v_fma_f32 v82, v20, v16, v19
    v_mul_f32 v19, v83, v16
    v_fma_f32 v20, -v19, v14, v83
    v_fma_f32 v83, v20, v16, v19
    v_cvt_pk_bf16_f32 v113, v82, v83
    buffer_store_dwordx2 v[112:113], v17, s[4:7], s46 offen offset:2048 sc1
    v_sub_f32 v84, v84, v10
    v_sub_f32 v85, v85, v10
    v_cvt_pk_bf16_f32 v15, v84, v85
    v_lshlrev_b32 v84, 16, v15
    v_and_b32 v85, 0xffff0000, v15
    v_mul_f32 v19, v84, v16
    v_fma_f32 v20, -v19, v14, v84
    v_fma_f32 v84, v20, v16, v19
    v_mul_f32 v19, v85, v16
    v_fma_f32 v20, -v19, v14, v85
    v_fma_f32 v85, v20, v16, v19
    v_cvt_pk_bf16_f32 v114, v84, v85
    v_sub_f32 v86, v86, v10
    v_sub_f32 v87, v87, v10
    v_cvt_pk_bf16_f32 v15, v86, v87
    v_lshlrev_b32 v86, 16, v15
    v_and_b32 v87, 0xffff0000, v15
    v_mul_f32 v19, v86, v16
    v_fma_f32 v20, -v19, v14, v86
    v_fma_f32 v86, v20, v16, v19
    v_mul_f32 v19, v87, v16
    v_fma_f32 v20, -v19, v14, v87
    v_fma_f32 v87, v20, v16, v19
    v_cvt_pk_bf16_f32 v115, v86, v87
    buffer_store_dwordx2 v[114:115], v17, s[4:7], s46 offen offset:2560 sc1
    v_sub_f32 v88, v88, v10
    v_sub_f32 v89, v89, v10
    v_cvt_pk_bf16_f32 v15, v88, v89
    v_lshlrev_b32 v88, 16, v15
    v_and_b32 v89, 0xffff0000, v15
    v_mul_f32 v19, v88, v16
    v_fma_f32 v20, -v19, v14, v88
    v_fma_f32 v88, v20, v16, v19
    v_mul_f32 v19, v89, v16
    v_fma_f32 v20, -v19, v14, v89
    v_fma_f32 v89, v20, v16, v19
    v_cvt_pk_bf16_f32 v116, v88, v89
    v_sub_f32 v90, v90, v10
    v_sub_f32 v91, v91, v10
    v_cvt_pk_bf16_f32 v15, v90, v91
    v_lshlrev_b32 v90, 16, v15
    v_and_b32 v91, 0xffff0000, v15
    v_mul_f32 v19, v90, v16
    v_fma_f32 v20, -v19, v14, v90
    v_fma_f32 v90, v20, v16, v19
    v_mul_f32 v19, v91, v16
    v_fma_f32 v20, -v19, v14, v91
    v_fma_f32 v91, v20, v16, v19
    v_cvt_pk_bf16_f32 v117, v90, v91
    buffer_store_dwordx2 v[116:117], v17, s[4:7], s46 offen offset:3072 sc1
    v_sub_f32 v92, v92, v10
    v_sub_f32 v93, v93, v10
    v_cvt_pk_bf16_f32 v15, v92, v93
    v_lshlrev_b32 v92, 16, v15
    v_and_b32 v93, 0xffff0000, v15
    v_mul_f32 v19, v92, v16
    v_fma_f32 v20, -v19, v14, v92
    v_fma_f32 v92, v20, v16, v19
    v_mul_f32 v19, v93, v16
    v_fma_f32 v20, -v19, v14, v93
    v_fma_f32 v93, v20, v16, v19
    v_cvt_pk_bf16_f32 v118, v92, v93
    v_sub_f32 v94, v94, v10
    v_sub_f32 v95, v95, v10
    v_cvt_pk_bf16_f32 v15, v94, v95
    v_lshlrev_b32 v94, 16, v15
    v_and_b32 v95, 0xffff0000, v15
    v_mul_f32 v19, v94, v16
    v_fma_f32 v20, -v19, v14, v94
    v_fma_f32 v94, v20, v16, v19
    v_mul_f32 v19, v95, v16
    v_fma_f32 v20, -v19, v14, v95
    v_fma_f32 v95, v20, v16, v19
    v_cvt_pk_bf16_f32 v119, v94, v95
    buffer_store_dwordx2 v[118:119], v17, s[4:7], s46 offen offset:3584 sc1
    s_branch b2_18_done
b2_18_last:
    s_mov_b32 s62, s48
    v_cvt_pk_bf16_f32 v10, v64, v65
    v_lshlrev_b32 v64, 16, v10
    v_and_b32 v65, 0xffff0000, v10
    v_cvt_pk_bf16_f32 v10, v66, v67
    v_lshlrev_b32 v66, 16, v10
    v_and_b32 v67, 0xffff0000, v10
    v_lshlrev_b32 v10, 16, v32
    v_add_f32 v64, v64, v10
    v_and_b32 v10, 0xffff0000, v32
    v_add_f32 v65, v65, v10
    v_lshlrev_b32 v10, 16, v33
    v_add_f32 v66, v66, v10
    v_and_b32 v10, 0xffff0000, v33
    v_add_f32 v67, v67, v10
    v_cvt_pk_bf16_f32 v32, v64, v65
    v_cvt_pk_bf16_f32 v33, v66, v67
    buffer_store_dwordx2 v[32:33], v9, s[76:79], s62 offen offset:0
    v_cvt_pk_bf16_f32 v10, v68, v69
    v_lshlrev_b32 v68, 16, v10
    v_and_b32 v69, 0xffff0000, v10
    v_cvt_pk_bf16_f32 v10, v70, v71
    v_lshlrev_b32 v70, 16, v10
    v_and_b32 v71, 0xffff0000, v10
    v_lshlrev_b32 v10, 16, v34
    v_add_f32 v68, v68, v10
    v_and_b32 v10, 0xffff0000, v34
    v_add_f32 v69, v69, v10
    v_lshlrev_b32 v10, 16, v35
    v_add_f32 v70, v70, v10
    v_and_b32 v10, 0xffff0000, v35
    v_add_f32 v71, v71, v10
    v_cvt_pk_bf16_f32 v34, v68, v69
    v_cvt_pk_bf16_f32 v35, v70, v71
    buffer_store_dwordx2 v[34:35], v9, s[76:79], s62 offen offset:32
    v_cvt_pk_bf16_f32 v10, v72, v73
    v_lshlrev_b32 v72, 16, v10
    v_and_b32 v73, 0xffff0000, v10
    v_cvt_pk_bf16_f32 v10, v74, v75
    v_lshlrev_b32 v74, 16, v10
    v_and_b32 v75, 0xffff0000, v10
    v_lshlrev_b32 v10, 16, v36
    v_add_f32 v72, v72, v10
    v_and_b32 v10, 0xffff0000, v36
    v_add_f32 v73, v73, v10
    v_lshlrev_b32 v10, 16, v37
    v_add_f32 v74, v74, v10
    v_and_b32 v10, 0xffff0000, v37
    v_add_f32 v75, v75, v10
    v_cvt_pk_bf16_f32 v36, v72, v73
    v_cvt_pk_bf16_f32 v37, v74, v75
    buffer_store_dwordx2 v[36:37], v9, s[76:79], s62 offen offset:64
    v_cvt_pk_bf16_f32 v10, v76, v77
    v_lshlrev_b32 v76, 16, v10
    v_and_b32 v77, 0xffff0000, v10
    v_cvt_pk_bf16_f32 v10, v78, v79
    v_lshlrev_b32 v78, 16, v10
    v_and_b32 v79, 0xffff0000, v10
    v_lshlrev_b32 v10, 16, v38
    v_add_f32 v76, v76, v10
    v_and_b32 v10, 0xffff0000, v38
    v_add_f32 v77, v77, v10
    v_lshlrev_b32 v10, 16, v39
    v_add_f32 v78, v78, v10
    v_and_b32 v10, 0xffff0000, v39
    v_add_f32 v79, v79, v10
    v_cvt_pk_bf16_f32 v38, v76, v77
    v_cvt_pk_bf16_f32 v39, v78, v79
    buffer_store_dwordx2 v[38:39], v9, s[76:79], s62 offen offset:96
    v_cvt_pk_bf16_f32 v10, v80, v81
    v_lshlrev_b32 v80, 16, v10
    v_and_b32 v81, 0xffff0000, v10
    v_cvt_pk_bf16_f32 v10, v82, v83
    v_lshlrev_b32 v82, 16, v10
    v_and_b32 v83, 0xffff0000, v10
    v_lshlrev_b32 v10, 16, v40
    v_add_f32 v80, v80, v10
    v_and_b32 v10, 0xffff0000, v40
    v_add_f32 v81, v81, v10
    v_lshlrev_b32 v10, 16, v41
    v_add_f32 v82, v82, v10
    v_and_b32 v10, 0xffff0000, v41
    v_add_f32 v83, v83, v10
    v_cvt_pk_bf16_f32 v40, v80, v81
    v_cvt_pk_bf16_f32 v41, v82, v83
    buffer_store_dwordx2 v[40:41], v9, s[76:79], s62 offen offset:128
    v_cvt_pk_bf16_f32 v10, v84, v85
    v_lshlrev_b32 v84, 16, v10
    v_and_b32 v85, 0xffff0000, v10
    v_cvt_pk_bf16_f32 v10, v86, v87
    v_lshlrev_b32 v86, 16, v10
    v_and_b32 v87, 0xffff0000, v10
    v_lshlrev_b32 v10, 16, v42
    v_add_f32 v84, v84, v10
    v_and_b32 v10, 0xffff0000, v42
    v_add_f32 v85, v85, v10
    v_lshlrev_b32 v10, 16, v43
    v_add_f32 v86, v86, v10
    v_and_b32 v10, 0xffff0000, v43
    v_add_f32 v87, v87, v10
    v_cvt_pk_bf16_f32 v42, v84, v85
    v_cvt_pk_bf16_f32 v43, v86, v87
    buffer_store_dwordx2 v[42:43], v9, s[76:79], s62 offen offset:160
    v_cvt_pk_bf16_f32 v10, v88, v89
    v_lshlrev_b32 v88, 16, v10
    v_and_b32 v89, 0xffff0000, v10
    v_cvt_pk_bf16_f32 v10, v90, v91
    v_lshlrev_b32 v90, 16, v10
    v_and_b32 v91, 0xffff0000, v10
    v_lshlrev_b32 v10, 16, v44
    v_add_f32 v88, v88, v10
    v_and_b32 v10, 0xffff0000, v44
    v_add_f32 v89, v89, v10
    v_lshlrev_b32 v10, 16, v45
    v_add_f32 v90, v90, v10
    v_and_b32 v10, 0xffff0000, v45
    v_add_f32 v91, v91, v10
    v_cvt_pk_bf16_f32 v44, v88, v89
    v_cvt_pk_bf16_f32 v45, v90, v91
    buffer_store_dwordx2 v[44:45], v9, s[76:79], s62 offen offset:192
    v_cvt_pk_bf16_f32 v10, v92, v93
    v_lshlrev_b32 v92, 16, v10
    v_and_b32 v93, 0xffff0000, v10
    v_cvt_pk_bf16_f32 v10, v94, v95
    v_lshlrev_b32 v94, 16, v10
    v_and_b32 v95, 0xffff0000, v10
    v_lshlrev_b32 v10, 16, v46
    v_add_f32 v92, v92, v10
    v_and_b32 v10, 0xffff0000, v46
    v_add_f32 v93, v93, v10
    v_lshlrev_b32 v10, 16, v47
    v_add_f32 v94, v94, v10
    v_and_b32 v10, 0xffff0000, v47
    v_add_f32 v95, v95, v10
    v_cvt_pk_bf16_f32 v46, v92, v93
    v_cvt_pk_bf16_f32 v47, v94, v95
    buffer_store_dwordx2 v[46:47], v9, s[76:79], s62 offen offset:224
b2_18_done:
    s_lshr_b32 s82, s41, 3
    s_lshl_b32 s82, s82, 2
    s_add_u32 s82, s82, 1280
    s_waitcnt vmcnt(0)
    s_barrier
    s_cmp_lg_u32 s14, 0
    s_cbranch_scc1 sig_20
    s_mov_b64 exec, 1
    v_mov_b32 v2, s82
    v_mov_b32 v3, 1
    buffer_atomic_add v3, v2, s[4:7], s80 offen
    s_mov_b64 exec, -1
sig_20:
    s_branch mega_kernel_next
mega_kernel_end:
    s_endpgm
.section .rodata,"a"
.p2align 6
.amdhsa_kernel prep_kernel
  .amdhsa_next_free_vgpr 32
  .amdhsa_next_free_sgpr 102
  .amdhsa_accum_offset 32
  .amdhsa_group_segment_fixed_size 0
  .amdhsa_kernarg_size 104
  .amdhsa_user_sgpr_count 2
  .amdhsa_user_sgpr_kernarg_segment_ptr 1
  .amdhsa_system_sgpr_workgroup_id_x 1
.end_amdhsa_kernel
.p2align 6
.amdhsa_kernel mega_kernel
  .amdhsa_next_free_vgpr 512
  .amdhsa_next_free_sgpr 102
  .amdhsa_accum_offset 256
  .amdhsa_group_segment_fixed_size 0
  .amdhsa_kernarg_size 104
  .amdhsa_user_sgpr_count 2
  .amdhsa_user_sgpr_kernarg_segment_ptr 1
  .amdhsa_system_sgpr_workgroup_id_x 1
.end_amdhsa_kernel
```
